```python
import torch

def _softmax(x, axis=-1):
    return torch.softmax(x, dim=axis)
def _gelu(x):
    return torch.nn.functional.gelu(x, approximate="tanh")
def _silu(x):
    return torch.nn.functional.silu(x)
def _sigmoid(x):
    return torch.sigmoid(x)
def _layernorm(x, axis=-1, eps=1e-5):
    m = x.mean(dim=axis, keepdim=True)
    v = x.var(dim=axis, keepdim=True, unbiased=False)
    return (x - m) / torch.sqrt(v + eps)
def _scatter_add(tgt, idx, src, axis=0):
    return tgt.clone().index_add_(axis, idx, src)
def _segment_sum(src, seg, n):
    out = torch.zeros((n,) + src.shape[1:], dtype=src.dtype)
    return out.index_add_(0, seg, src)
def _pad(x, pw):
    flat = tuple(v for pair in reversed(pw) for v in pair)
    return torch.nn.functional.pad(x, flat)

kernel_name = 'standalone__deep_cross_pnn__recsys'

def setup_inputs():

    _w = (lambda a: (lambda t: t.to(torch.bfloat16) if t.is_floating_point() else t)(torch.as_tensor(a)))
    B, F, D, V = 16384, 100, 64, min(100000, 100000)
    H = 4 * D
    return {
        "idx": _w((lambda lo, hi, *s: torch.randint(lo, hi, s))(0, V, B, F).to(torch.int64)),
        "table": _w((lambda *s: torch.randn(*s, dtype=torch.bfloat16) * 1.6)(V, D) * (D ** -0.5)),
        "w_p": _w((lambda *s: torch.randn(*s, dtype=torch.bfloat16) * 0.05)(F * F) * ((F * F) ** -0.5)),
        "w1": _w((lambda *s: torch.randn(*s, dtype=torch.bfloat16) * 1.6)(F * D, H) * ((F * D) ** -0.5)),
        "b1": _w((lambda *s: torch.randn(*s, dtype=torch.bfloat16) * 12.8)(H) * 0.01),
        "w2": _w((lambda *s: torch.randn(*s, dtype=torch.bfloat16) * 0.05)(H) * (H ** -0.5)),
        "b2": _w((lambda *s: torch.randn(*s, dtype=torch.bfloat16) * 1.6)(1) * 0.01),
    }

def reference(idx, table, w_p, w1, b1, w2, b2):
    emb = table[idx]
    B = emb.shape[0]; F = emb.shape[1]; D = emb.shape[2]
    ip = torch.einsum('bid,bjd->bij', emb, emb)
    ip = ip.reshape(B, F * F)
    logit_p = ip @ w_p
    z = emb.reshape(B, F * D)
    h = _gelu(z @ w1 + b1)
    logit_d = h @ w2 + b2
    return logit_p + logit_d
```

```asm
; @launch grid=(256,1,1) block=(512,1,1) lds=163136
.amdgcn_target "amdgcn-amd-amdhsa--gfx950"
.text
.globl standalone__deep_cross_pnn__recsys_kernel

.p2align 8
.type standalone__deep_cross_pnn__recsys_kernel,@function
standalone__deep_cross_pnn__recsys_kernel:
    s_cmp_ge_u32 s2, 256
    s_cbranch_scc1 L_end
    s_load_dwordx16 s[40:55], s[0:1], 0
    s_load_dwordx4 s[56:59], s[0:1], 64
    s_cmp_ge_u32 s2, 16
    s_cbranch_scc1 L_nocp
    s_getpc_b64 s[4:5]
L_cp:
    v_lshlrev_b32 v2, 7, v0
    v_min_u32 v2, L_codeend-L_cp-4, v2
    global_load_dword v47, v2, s[4:5]
L_nocp:
    v_lshrrev_b32 v1, 6, v0
    v_and_b32 v0, 63, v0
    s_nop 0
    v_readfirstlane_b32 s3, v1
    s_lshr_b32 s74, s2, 4
    s_lshl_b32 s74, s74, 3
    s_and_b32 s75, s2, 7
    s_add_u32 s74, s74, s75
    s_lshl_b32 s72, s74, 7
    s_lshr_b32 s73, s2, 3
    s_and_b32 s73, s73, 1
    s_xor_b32 s83, s2, 8
    s_mov_b32 s33, 0xffff0000
    s_cmp_ge_u32 s3, 4
    s_cbranch_scc0 L_gemm
L_pnn:
    s_setprio 1
    s_sub_u32 s3, s3, 4
    v_lshrrev_b32 v12, 3, v0
    v_and_b32 v13, 7, v0
    s_lshr_b32 s74, s3, 1
    s_lshl_b32 s74, s74, 3
    s_and_b32 s76, s3, 1
    s_add_u32 s74, s74, s76
    s_lshl_b32 s80, s74, 10
    s_lshl_b32 s74, s74, 3
    s_lshl_b32 s75, s73, 6
    s_xor_b32 s74, s74, s75
    s_add_u32 s74, s74, s72
    s_mul_i32 s74, s74, 400
    s_mul_i32 s78, s73, 204
    v_lshl_add_u32 v14, v13, 4, s78
    s_movk_i32 s4, 400
    v_mad_u32_u24 v14, v12, s4, v14
    s_waitcnt lgkmcnt(0)
    s_mov_b32 s8, s40
    s_and_b32 s9, s41, 0xffff
    s_mov_b32 s10, 6553600
    s_mov_b32 s11, 0x20000
    s_mov_b32 s79, s74
    buffer_load_dwordx4 v[40:43], v14, s[8:11], s74 offen
    s_add_u32 s74, s74, 6400
    buffer_load_dwordx4 v[44:47], v14, s[8:11], s74 offen
    s_add_u32 s74, s74, 6400
    buffer_load_dwordx4 v[48:51], v14, s[8:11], s74 offen
    s_add_u32 s74, s74, 6400
    buffer_load_dwordx4 v[52:55], v14, s[8:11], s74 offen
    v_bfe_u32 v15, v0, 4, 1
    v_lshlrev_b32 v15, 1, v15
    v_xor_b32 v15, v15, v13
    v_lshlrev_b32 v15, 4, v15
    v_lshl_add_u32 v28, v12, 9, v15
    s_lshl_b32 s81, s3, 7
    v_add_u32 v28, s81, v28
    v_xor_b32 v29, 64, v28
    v_add_u32 v29, 3072, v29
    v_add_u32 v30, 6144, v28
    v_add_u32 v31, 6144, v29
    s_lshl_b32 s81, s3, 12
    s_add_u32 s81, s81, 49152
    s_mul_i32 s77, s73, 1671168
    s_add_u32 s78, s78, 12
    s_mov_b32 exec_lo, 0x20202020
    s_mov_b32 exec_hi, 0x20202020
    v_subrev_u32 v14, s78, v14
    s_mov_b64 exec, -1
    s_mov_b32 s16, s46
    s_and_b32 s17, s47, 0xffff
    s_mov_b32 s18, 3276800
    s_mov_b32 s19, 0x20000
    s_mov_b32 s12, s42
    s_and_b32 s13, s43, 0xffff
    s_mov_b32 s14, 12800000
    s_mov_b32 s15, 0x20000
    s_add_u32 m0, s81, 0
    s_nop 0
    buffer_load_dwordx4 v28, s[16:19], s77 offen offset:0 lds
    buffer_load_dwordx4 v29, s[16:19], s77 offen offset:1024 lds
    buffer_load_dwordx4 v30, s[16:19], s77 offen offset:2048 lds
    buffer_load_dwordx4 v31, s[16:19], s77 offen offset:3072 lds
    s_add_u32 s77, s77, 16384
    s_mov_b32 s20, s44
    s_and_b32 s21, s45, 0xffff
    s_mov_b32 s22, 20000
    s_mov_b32 s23, 0x20000
    s_sub_u32 s24, s42, 1024
    s_subb_u32 s25, s43, 0
    s_and_b32 s25, s25, 0xffff
    s_mov_b32 s26, 12801024
    s_mov_b32 s27, 0x20000
    s_sub_u32 s28, s42, 2048
    s_subb_u32 s29, s43, 0
    s_and_b32 s29, s29, 0xffff
    s_mov_b32 s30, 12802048
    s_mov_b32 s31, 0x20000
    s_add_u32 s74, s3, s75
    s_add_u32 s74, s74, s72
    s_mul_i32 s74, s74, 400
    v_lshlrev_b32 v8, 5, v13
    v_lshl_add_u32 v8, v12, 2, v8
    v_add_u32 v8, s74, v8
    v_lshrrev_b32 v15, 4, v0
    v_xor_b32 v2, v13, v15
    v_lshlrev_b32 v2, 4, v2
    v_xor_b32 v3, 64, v2
    s_lshl_b32 s76, s76, 6
    v_xor_b32 v1, s76, v2
    s_mul_i32 s82, s3, 10752
    s_add_u32 s82, s82, 114688
    v_and_b32 v16, 15, v0
    v_lshrrev_b32 v17, 1, v16
    v_xor_b32 v17, v17, v15
    v_lshlrev_b32 v17, 4, v17
    v_lshl_add_u32 v4, v16, 7, v17
    v_add_u32 v4, s82, v4
    v_xor_b32 v5, 64, v4
    v_mul_u32_u24 v6, 200, v16
    v_lshl_add_u32 v6, v15, 3, v6
    v_add_u32 v6, 114688, v6
    v_lshrrev_b32 v17, 2, v0
    v_mul_u32_u24 v7, 200, v17
    v_and_b32 v17, 3, v0
    v_lshl_add_u32 v7, v17, 3, v7
    v_add_u32 v7, 114688, v7
    v_mov_b32 v9, 0
    v_lshlrev_b32 v10, 4, v0
    v_mov_b64 v[156:157], 0
    v_mov_b64 v[158:159], 0
    v_mov_b64 v[160:161], 0
    v_mov_b64 v[162:163], 0
    s_mov_b32 s60, 0xf000f
    s_mov_b32 s61, 0xf000f
    s_mov_b32 s62, 0xf000f0
    s_mov_b32 s63, 0xf000f0
    s_mov_b32 s64, 0xf000f00
    s_mov_b32 s65, 0xf000f00
    s_mov_b32 s66, 0xf000f000
    s_mov_b32 s67, 0xf000f000
    s_not_b64 s[36:37], s[60:61]
    v_lshrrev_b32 v18, 1, v17
    v_xor_b32 v18, v18, v15
    v_lshlrev_b32 v18, 4, v18
    v_lshl_add_u32 v22, v17, 7, v18
    v_add_u32 v22, s82, v22
    v_xor_b32 v23, 64, v22
    v_mov_b32 v84, v6
    v_mov_b32 v86, 3200
    v_mov_b32 v85, v7
    v_mov_b32 v87, 32
    v_lshrrev_b32 v18, 2, v16
    v_mul_u32_u24 v88, 3200, v18
    v_mul_u32_u24 v18, 200, v17
    v_add_u32 v88, v88, v18
    v_lshl_add_u32 v88, v15, 5, v88
    v_add_u32 v88, 114688, v88
    s_mov_b64 exec, s[60:61]
    v_add_u32 v84, 19200, v84
    v_mov_b32 v86, 0
    s_mov_b32 exec_lo, 0x11111111
    s_mov_b32 exec_hi, 0x11111111
    v_add_u32 v85, 192, v85
    v_mov_b32 v87, 0
    s_mov_b64 exec, -1
    s_cmp_ge_u32 s3, 2
    s_cselect_b64 vcc, -1, 0
    s_waitcnt vmcnt(4)
    v_lshlrev_b32 v40, 7, v40
    v_lshlrev_b32 v41, 7, v41
    v_lshlrev_b32 v42, 7, v42
    v_lshlrev_b32 v43, 7, v43
    v_lshlrev_b32 v44, 7, v44
    v_lshlrev_b32 v45, 7, v45
    v_lshlrev_b32 v46, 7, v46
    v_lshlrev_b32 v47, 7, v47
    v_lshlrev_b32 v48, 7, v48
    v_lshlrev_b32 v49, 7, v49
    v_lshlrev_b32 v50, 7, v50
    v_lshlrev_b32 v51, 7, v51
    v_lshlrev_b32 v52, 7, v52
    v_lshlrev_b32 v53, 7, v53
    v_lshlrev_b32 v54, 7, v54
    v_lshlrev_b32 v55, 7, v55
    s_nop 1
    s_add_u32 m0, s80, 0
    v_add_u32_dpp v25, v40, v1 row_newbcast:0 row_mask:0xf bank_mask:0x3
    v_add_u32_dpp v25, v40, v1 row_newbcast:8 row_mask:0xf bank_mask:0xc
    buffer_load_dwordx4 v25, s[12:15], 0 offen offset:0 lds
    v_add_u32_dpp v26, v44, v1 row_newbcast:0 row_mask:0xf bank_mask:0x3
    v_add_u32_dpp v26, v44, v1 row_newbcast:8 row_mask:0xf bank_mask:0xc
    buffer_load_dwordx4 v26, s[28:31], 0 offen offset:2048 lds
    s_add_u32 m0, s80, 4096
    v_add_u32_dpp v27, v48, v1 row_newbcast:0 row_mask:0xf bank_mask:0x3
    v_add_u32_dpp v27, v48, v1 row_newbcast:8 row_mask:0xf bank_mask:0xc
    buffer_load_dwordx4 v27, s[12:15], 0 offen offset:0 lds
    v_add_u32_dpp v24, v52, v1 row_newbcast:0 row_mask:0xf bank_mask:0x3
    v_add_u32_dpp v24, v52, v1 row_newbcast:8 row_mask:0xf bank_mask:0xc
    buffer_load_dwordx4 v24, s[28:31], 0 offen offset:2048 lds
    s_add_u32 m0, s81, 16384
    s_nop 0
    buffer_load_dwordx4 v28, s[16:19], s77 offen offset:0 lds
    buffer_load_dwordx4 v29, s[16:19], s77 offen offset:1024 lds
    buffer_load_dwordx4 v30, s[16:19], s77 offen offset:2048 lds
    buffer_load_dwordx4 v31, s[16:19], s77 offen offset:3072 lds
    s_add_u32 s77, s77, 16384
    s_add_u32 m0, s80, 16384
    v_add_u32_dpp v25, v41, v1 row_newbcast:0 row_mask:0xf bank_mask:0x3
    v_add_u32_dpp v25, v41, v1 row_newbcast:8 row_mask:0xf bank_mask:0xc
    buffer_load_dwordx4 v25, s[12:15], 0 offen offset:0 lds
    v_add_u32_dpp v26, v45, v1 row_newbcast:0 row_mask:0xf bank_mask:0x3
    v_add_u32_dpp v26, v45, v1 row_newbcast:8 row_mask:0xf bank_mask:0xc
    buffer_load_dwordx4 v26, s[28:31], 0 offen offset:2048 lds
    s_add_u32 m0, s80, 20480
    v_add_u32_dpp v27, v49, v1 row_newbcast:0 row_mask:0xf bank_mask:0x3
    v_add_u32_dpp v27, v49, v1 row_newbcast:8 row_mask:0xf bank_mask:0xc
    buffer_load_dwordx4 v27, s[12:15], 0 offen offset:0 lds
    v_add_u32_dpp v24, v53, v1 row_newbcast:0 row_mask:0xf bank_mask:0x3
    v_add_u32_dpp v24, v53, v1 row_newbcast:8 row_mask:0xf bank_mask:0xc
    buffer_load_dwordx4 v24, s[28:31], 0 offen offset:2048 lds
    s_add_u32 m0, s81, 32768
    s_nop 0
    buffer_load_dwordx4 v28, s[16:19], s77 offen offset:0 lds
    buffer_load_dwordx4 v29, s[16:19], s77 offen offset:1024 lds
    buffer_load_dwordx4 v30, s[16:19], s77 offen offset:2048 lds
    buffer_load_dwordx4 v31, s[16:19], s77 offen offset:3072 lds
    s_add_u32 s77, s77, 16384
    s_lshl_b32 s74, s3, 10
    s_add_u32 m0, s74, 114688
    s_nop 0
    buffer_load_dwordx4 v10, s[20:23], s74 offen lds
    s_add_u32 s74, s74, 4096
    s_add_u32 m0, s74, 114688
    s_nop 0
    buffer_load_dwordx4 v10, s[20:23], s74 offen lds
    s_add_u32 s74, s74, 4096
    s_add_u32 m0, s74, 114688
    s_nop 0
    buffer_load_dwordx4 v10, s[20:23], s74 offen lds
    s_add_u32 s74, s74, 4096
    s_add_u32 m0, s74, 114688
    s_nop 0
    buffer_load_dwordx4 v10, s[20:23], s74 offen lds
    s_add_u32 s74, s74, 4096
    s_add_u32 m0, s74, 114688
    s_nop 0
    buffer_load_dwordx4 v10, s[20:23], s74 offen lds
    s_add_u32 s74, s74, 4096
    s_add_u32 m0, s74, 114688
    s_nop 0
    buffer_load_dwordx4 v10, s[20:23], s74 offen lds
    s_movk_i32 s74, 0
    buffer_load_dword v36, v8, s[8:11], s74 offen
    buffer_load_dword v37, v8, s[8:11], s74 offen offset:256
    v_lshlrev_b32 v16, 6, v0
    s_mul_i32 s76, s2, 12800
    s_mul_i32 s74, s3, 3200
    s_add_u32 s76, s76, s74
    s_mov_b32 exec_hi, 0x3ffff
    buffer_load_dword v17, v16, s[16:19], s76 offen
    s_mov_b32 exec_hi, -1
    buffer_load_dwordx4 v[56:59], v14, s[8:11], s79 offen offset:128
    s_add_u32 s79, s79, 6400
    buffer_load_dwordx4 v[60:63], v14, s[8:11], s79 offen offset:128
    s_add_u32 s79, s79, 6400
    buffer_load_dwordx4 v[64:67], v14, s[8:11], s79 offen offset:128
    s_add_u32 s79, s79, 6400
    buffer_load_dwordx4 v[68:71], v14, s[8:11], s79 offen offset:128
    s_movk_i32 s74, 1600
    buffer_load_dword v38, v8, s[8:11], s74 offen
    buffer_load_dword v39, v8, s[8:11], s74 offen offset:256
    s_waitcnt vmcnt(27)
    s_barrier
    s_add_u32 m0, s81, 49152
    s_nop 0
    buffer_load_dwordx4 v28, s[16:19], s77 offen offset:0 lds
    buffer_load_dwordx4 v29, s[16:19], s77 offen offset:1024 lds
    buffer_load_dwordx4 v30, s[16:19], s77 offen offset:2048 lds
    buffer_load_dwordx4 v31, s[16:19], s77 offen offset:3072 lds
    s_add_u32 s77, s77, 16384
    s_add_u32 m0, s80, 32768
    v_add_u32_dpp v25, v42, v1 row_newbcast:0 row_mask:0xf bank_mask:0x3
    v_add_u32_dpp v25, v42, v1 row_newbcast:8 row_mask:0xf bank_mask:0xc
    buffer_load_dwordx4 v25, s[12:15], 0 offen offset:0 lds
    v_add_u32_dpp v26, v46, v1 row_newbcast:0 row_mask:0xf bank_mask:0x3
    v_add_u32_dpp v26, v46, v1 row_newbcast:8 row_mask:0xf bank_mask:0xc
    buffer_load_dwordx4 v26, s[28:31], 0 offen offset:2048 lds
    s_waitcnt vmcnt(29)
    s_barrier
    s_add_u32 m0, s81, 0
    s_nop 0
    buffer_load_dwordx4 v28, s[16:19], s77 offen offset:0 lds
    buffer_load_dwordx4 v29, s[16:19], s77 offen offset:1024 lds
    buffer_load_dwordx4 v30, s[16:19], s77 offen offset:2048 lds
    buffer_load_dwordx4 v31, s[16:19], s77 offen offset:3072 lds
    s_add_u32 s77, s77, 16384
    s_add_u32 m0, s80, 36864
    v_add_u32_dpp v27, v50, v1 row_newbcast:0 row_mask:0xf bank_mask:0x3
    v_add_u32_dpp v27, v50, v1 row_newbcast:8 row_mask:0xf bank_mask:0xc
    buffer_load_dwordx4 v27, s[12:15], 0 offen offset:0 lds
    v_add_u32_dpp v24, v54, v1 row_newbcast:0 row_mask:0xf bank_mask:0x3
    v_add_u32_dpp v24, v54, v1 row_newbcast:8 row_mask:0xf bank_mask:0xc
    buffer_load_dwordx4 v24, s[28:31], 0 offen offset:2048 lds
    s_waitcnt vmcnt(21)
    s_barrier
    s_add_u32 m0, s81, 16384
    s_nop 0
    buffer_load_dwordx4 v28, s[16:19], s77 offen offset:0 lds
    buffer_load_dwordx4 v29, s[16:19], s77 offen offset:1024 lds
    ds_read_b64 v[164:165], v84 offset:0
    ds_read_b64_tr_b16 v[166:167], v85 offset:0
    ds_read_b64 v[168:169], v6 offset:3200
    ds_read_b64_tr_b16 v[170:171], v7 offset:32
    v_add_u32 v84, v84, v86
    v_add_u32 v85, v85, v87
    ds_read_b64 v[172:173], v84 offset:32
    ds_read_b64_tr_b16 v[174:175], v85 offset:3200
    ds_read_b64 v[176:177], v6 offset:6400
    ds_read_b64_tr_b16 v[178:179], v7 offset:64
    ds_read_b64 v[180:181], v6 offset:6432
    ds_read_b64_tr_b16 v[182:183], v7 offset:3264
    ds_read_b64 v[184:185], v6 offset:9600
    ds_read_b64_tr_b16 v[186:187], v7 offset:96
    v_add_u32 v84, v84, v86
    v_add_u32 v85, v85, v87
    ds_read_b64 v[188:189], v84 offset:64
    ds_read_b64_tr_b16 v[190:191], v85 offset:6400
    ds_read_b64 v[192:193], v6 offset:9632
    ds_read_b64_tr_b16 v[194:195], v7 offset:3296
    v_mov_b64 v[196:197], 0
    s_mov_b32 exec_lo, 0x00f0000f
    s_mov_b32 exec_hi, 0xf0000f00
    ds_read_b64 v[196:197], v88 offset:0
    s_mov_b64 exec, -1
    ds_read_b64 v[200:201], v6 offset:12800
    ds_read_b64_tr_b16 v[202:203], v7 offset:128
    ds_read_b64 v[204:205], v6 offset:9664
    ds_read_b64_tr_b16 v[206:207], v7 offset:6496
    ds_read_b64 v[208:209], v6 offset:12832
    ds_read_b64_tr_b16 v[210:211], v7 offset:3328
    buffer_load_dwordx4 v30, s[16:19], s77 offen offset:2048 lds
    buffer_load_dwordx4 v31, s[16:19], s77 offen offset:3072 lds
    s_add_u32 s77, s77, 16384
    s_add_u32 m0, s80, 0
    v_add_u32_dpp v25, v43, v1 row_newbcast:0 row_mask:0xf bank_mask:0x3
    v_add_u32_dpp v25, v43, v1 row_newbcast:8 row_mask:0xf bank_mask:0xc
    buffer_load_dwordx4 v25, s[12:15], 0 offen offset:0 lds
    v_add_u32_dpp v26, v47, v1 row_newbcast:0 row_mask:0xf bank_mask:0x3
    v_add_u32_dpp v26, v47, v1 row_newbcast:8 row_mask:0xf bank_mask:0xc
    buffer_load_dwordx4 v26, s[28:31], 0 offen offset:2048 lds
    s_waitcnt vmcnt(14)
    s_barrier
    s_add_u32 m0, s81, 32768
    s_nop 0
    buffer_load_dwordx4 v28, s[16:19], s77 offen offset:0 lds
    buffer_load_dwordx4 v29, s[16:19], s77 offen offset:1024 lds
    ds_read_b64 v[212:213], v6 offset:16000
    ds_read_b64_tr_b16 v[214:215], v7 offset:160
    v_add_u32 v84, v84, v86
    v_add_u32 v85, v85, v87
    ds_read_b64 v[216:217], v84 offset:96
    ds_read_b64_tr_b16 v[218:219], v85 offset:9600
    ds_read_b64 v[220:221], v6 offset:16032
    ds_read_b64_tr_b16 v[222:223], v7 offset:3360
    v_mov_b64 v[224:225], 0
    s_mov_b32 exec_lo, 0x00f0000f
    s_mov_b32 exec_hi, 0xf0000f00
    ds_read_b64 v[224:225], v88 offset:12928
    s_mov_b64 exec, -1
    ds_read_b64 v[228:229], v6 offset:12864
    ds_read_b64_tr_b16 v[230:231], v7 offset:6528
    ds_read_b64 v[232:233], v6 offset:12896
    ds_read_b64_tr_b16 v[234:235], v7 offset:9728
    ds_read_b64 v[236:237], v6 offset:16064
    ds_read_b64_tr_b16 v[238:239], v7 offset:6560
    v_add_u32 v84, v84, v86
    v_add_u32 v85, v85, v87
    ds_read_b64 v[240:241], v84 offset:128
    ds_read_b64_tr_b16 v[242:243], v85 offset:12800
    ds_read_b64 v[244:245], v6 offset:16096
    ds_read_b64_tr_b16 v[246:247], v7 offset:9760
    ds_read_b64 v[248:249], v6 offset:16128
    ds_read_b64_tr_b16 v[250:251], v7 offset:12960
    v_add_u32 v84, v84, v86
    v_add_u32 v85, v85, v87
    ds_read_b64 v[252:253], v84 offset:160
    ds_read_b64_tr_b16 v[254:255], v85 offset:16000
    buffer_load_dwordx4 v30, s[16:19], s77 offen offset:2048 lds
    buffer_load_dwordx4 v31, s[16:19], s77 offen offset:3072 lds
    s_add_u32 s77, s77, 16384
    s_add_u32 m0, s80, 4096
    v_add_u32_dpp v27, v51, v1 row_newbcast:0 row_mask:0xf bank_mask:0x3
    v_add_u32_dpp v27, v51, v1 row_newbcast:8 row_mask:0xf bank_mask:0xc
    buffer_load_dwordx4 v27, s[12:15], 0 offen offset:0 lds
    v_add_u32_dpp v24, v55, v1 row_newbcast:0 row_mask:0xf bank_mask:0x3
    v_add_u32_dpp v24, v55, v1 row_newbcast:8 row_mask:0xf bank_mask:0xc
    buffer_load_dwordx4 v24, s[28:31], 0 offen offset:2048 lds
    s_waitcnt lgkmcnt(0)
    s_waitcnt vmcnt(12)
    s_barrier
    s_add_u32 m0, s81, 49152
    s_nop 0
    buffer_load_dwordx4 v28, s[16:19], s77 offen offset:0 lds
    s_mov_b32 exec_lo, 0xfff00000
    s_mov_b32 exec_hi, 0xfff0fff0
    v_mov_b64 v[166:167], 0
    s_mov_b64 exec, -1
    v_lshlrev_b32 v72, 16, v164
    v_and_b32 v73, s33, v164
    v_lshlrev_b32 v74, 16, v165
    v_and_b32 v75, s33, v165
    v_lshlrev_b32 v164, 16, v166
    v_and_b32 v165, s33, v166
    v_lshlrev_b32 v166, 16, v167
    v_and_b32 v167, s33, v167
    v_add_f32 v164, v164, v72
    v_add_f32 v165, v165, v73
    v_add_f32 v166, v166, v74
    v_add_f32 v167, v167, v75
    buffer_load_dwordx4 v29, s[16:19], s77 offen offset:1024 lds
    buffer_load_dwordx4 v30, s[16:19], s77 offen offset:2048 lds
    v_lshlrev_b32 v72, 16, v168
    v_and_b32 v73, s33, v168
    v_lshlrev_b32 v74, 16, v169
    v_and_b32 v75, s33, v169
    v_lshlrev_b32 v168, 16, v170
    v_and_b32 v169, s33, v170
    v_lshlrev_b32 v170, 16, v171
    v_and_b32 v171, s33, v171
    v_add_f32 v168, v168, v72
    v_add_f32 v169, v169, v73
    v_add_f32 v170, v170, v74
    v_add_f32 v171, v171, v75
    buffer_load_dwordx4 v31, s[16:19], s77 offen offset:3072 lds
    s_add_u32 s77, s77, 16384
    s_add_u32 m0, s80, 16384
    v_add_u32_dpp v25, v40, v1 row_newbcast:1 row_mask:0xf bank_mask:0x3
    v_add_u32_dpp v25, v40, v1 row_newbcast:9 row_mask:0xf bank_mask:0xc
    buffer_load_dwordx4 v25, s[12:15], 0 offen offset:0 lds
    s_mov_b32 exec_lo, 0xfff00000
    s_mov_b32 exec_hi, 0xfff0fff0
    v_mov_b64 v[174:175], 0
    s_mov_b64 exec, -1
    v_lshlrev_b32 v72, 16, v172
    v_and_b32 v73, s33, v172
    v_lshlrev_b32 v74, 16, v173
    v_and_b32 v75, s33, v173
    v_lshlrev_b32 v172, 16, v174
    v_and_b32 v173, s33, v174
    v_lshlrev_b32 v174, 16, v175
    v_and_b32 v175, s33, v175
    v_add_f32 v172, v172, v72
    v_add_f32 v173, v173, v73
    v_add_f32 v174, v174, v74
    v_add_f32 v175, v175, v75
    v_add_u32_dpp v26, v44, v1 row_newbcast:1 row_mask:0xf bank_mask:0x3
    v_add_u32_dpp v26, v44, v1 row_newbcast:9 row_mask:0xf bank_mask:0xc
    buffer_load_dwordx4 v26, s[28:31], 0 offen offset:2048 lds
    v_lshlrev_b32 v36, 7, v36
    v_lshlrev_b32 v37, 7, v37
    s_nop 0
    s_add_u32 m0, s82, 0
    v_add_u32_dpp v27, v36, v2 row_newbcast:0 row_mask:0xf bank_mask:0x3
    v_add_u32_dpp v27, v36, v2 row_newbcast:8 row_mask:0xf bank_mask:0xc
    buffer_load_dwordx4 v27, s[12:15], 0 offen offset:0 lds
    v_lshlrev_b32 v72, 16, v176
    v_and_b32 v73, s33, v176
    v_lshlrev_b32 v74, 16, v177
    v_and_b32 v75, s33, v177
    v_lshlrev_b32 v176, 16, v178
    v_and_b32 v177, s33, v178
    v_lshlrev_b32 v178, 16, v179
    v_and_b32 v179, s33, v179
    v_add_f32 v176, v176, v72
    v_add_f32 v177, v177, v73
    v_add_f32 v178, v178, v74
    v_add_f32 v179, v179, v75
    v_add_u32_dpp v24, v36, v3 row_newbcast:1 row_mask:0xf bank_mask:0x3
    v_add_u32_dpp v24, v36, v3 row_newbcast:9 row_mask:0xf bank_mask:0xc
    buffer_load_dwordx4 v24, s[24:27], 0 offen offset:1024 lds
    s_add_u32 m0, s82, 2048
    v_add_u32_dpp v25, v36, v2 row_newbcast:2 row_mask:0xf bank_mask:0x3
    v_add_u32_dpp v25, v36, v2 row_newbcast:10 row_mask:0xf bank_mask:0xc
    buffer_load_dwordx4 v25, s[12:15], 0 offen offset:0 lds
    v_lshlrev_b32 v72, 16, v180
    v_and_b32 v73, s33, v180
    v_lshlrev_b32 v74, 16, v181
    v_and_b32 v75, s33, v181
    v_lshlrev_b32 v180, 16, v182
    v_and_b32 v181, s33, v182
    v_lshlrev_b32 v182, 16, v183
    v_and_b32 v183, s33, v183
    v_add_f32 v180, v180, v72
    v_add_f32 v181, v181, v73
    v_add_f32 v182, v182, v74
    v_add_f32 v183, v183, v75
    v_add_u32_dpp v26, v36, v3 row_newbcast:3 row_mask:0xf bank_mask:0x3
    v_add_u32_dpp v26, v36, v3 row_newbcast:11 row_mask:0xf bank_mask:0xc
    buffer_load_dwordx4 v26, s[24:27], 0 offen offset:1024 lds
    s_waitcnt vmcnt(18)
    s_barrier
    s_add_u32 m0, s81, 0
    s_nop 0
    buffer_load_dwordx4 v28, s[16:19], s77 offen offset:0 lds
    v_lshlrev_b32 v72, 16, v184
    v_and_b32 v73, s33, v184
    v_lshlrev_b32 v74, 16, v185
    v_and_b32 v75, s33, v185
    v_lshlrev_b32 v184, 16, v186
    v_and_b32 v185, s33, v186
    v_lshlrev_b32 v186, 16, v187
    v_and_b32 v187, s33, v187
    v_add_f32 v184, v184, v72
    v_add_f32 v185, v185, v73
    v_add_f32 v186, v186, v74
    v_add_f32 v187, v187, v75
    buffer_load_dwordx4 v29, s[16:19], s77 offen offset:1024 lds
    buffer_load_dwordx4 v30, s[16:19], s77 offen offset:2048 lds
    s_mov_b32 exec_lo, 0xfff00000
    s_mov_b32 exec_hi, 0xfff0fff0
    v_mov_b64 v[190:191], 0
    s_mov_b64 exec, -1
    v_lshlrev_b32 v72, 16, v188
    v_and_b32 v73, s33, v188
    v_lshlrev_b32 v74, 16, v189
    v_and_b32 v75, s33, v189
    v_lshlrev_b32 v188, 16, v190
    v_and_b32 v189, s33, v190
    v_lshlrev_b32 v190, 16, v191
    v_and_b32 v191, s33, v191
    v_add_f32 v188, v188, v72
    v_add_f32 v189, v189, v73
    v_add_f32 v190, v190, v74
    v_add_f32 v191, v191, v75
    buffer_load_dwordx4 v31, s[16:19], s77 offen offset:3072 lds
    s_add_u32 s77, s77, 16384
    s_add_u32 m0, s80, 20480
    v_add_u32_dpp v27, v48, v1 row_newbcast:1 row_mask:0xf bank_mask:0x3
    v_add_u32_dpp v27, v48, v1 row_newbcast:9 row_mask:0xf bank_mask:0xc
    buffer_load_dwordx4 v27, s[12:15], 0 offen offset:0 lds
    v_lshlrev_b32 v72, 16, v192
    v_and_b32 v73, s33, v192
    v_lshlrev_b32 v74, 16, v193
    v_and_b32 v75, s33, v193
    v_lshlrev_b32 v192, 16, v194
    v_and_b32 v193, s33, v194
    v_lshlrev_b32 v194, 16, v195
    v_and_b32 v195, s33, v195
    v_add_f32 v192, v192, v72
    v_add_f32 v193, v193, v73
    v_add_f32 v194, v194, v74
    v_add_f32 v195, v195, v75
    v_add_u32_dpp v24, v52, v1 row_newbcast:1 row_mask:0xf bank_mask:0x3
    v_add_u32_dpp v24, v52, v1 row_newbcast:9 row_mask:0xf bank_mask:0xc
    buffer_load_dwordx4 v24, s[28:31], 0 offen offset:2048 lds
    s_add_u32 m0, s82, 4096
    v_add_u32_dpp v25, v36, v2 row_newbcast:4 row_mask:0xf bank_mask:0x3
    v_add_u32_dpp v25, v36, v2 row_newbcast:12 row_mask:0xf bank_mask:0xc
    buffer_load_dwordx4 v25, s[12:15], 0 offen offset:0 lds
    v_and_b32 v199, s33, v197
    v_lshlrev_b32 v198, 16, v197
    v_and_b32 v197, s33, v196
    v_lshlrev_b32 v196, 16, v196
    v_add_u32_dpp v26, v36, v3 row_newbcast:5 row_mask:0xf bank_mask:0x3
    v_add_u32_dpp v26, v36, v3 row_newbcast:13 row_mask:0xf bank_mask:0xc
    buffer_load_dwordx4 v26, s[24:27], 0 offen offset:1024 lds
    s_add_u32 m0, s82, 10240
    v_add_u32_dpp v27, v37, v2 row_newbcast:4 row_mask:0xf bank_mask:0x3
    v_add_u32_dpp v27, v37, v2 row_newbcast:12 row_mask:0xf bank_mask:0xc
    s_mov_b32 exec_hi, 0
    buffer_load_dwordx4 v27, s[12:15], 0 offen offset:0 lds
    s_mov_b32 exec_hi, -1
    v_lshlrev_b32 v72, 16, v200
    v_and_b32 v73, s33, v200
    v_lshlrev_b32 v74, 16, v201
    v_and_b32 v75, s33, v201
    v_lshlrev_b32 v200, 16, v202
    v_and_b32 v201, s33, v202
    v_lshlrev_b32 v202, 16, v203
    v_and_b32 v203, s33, v203
    v_add_f32 v200, v200, v72
    v_add_f32 v201, v201, v73
    v_add_f32 v202, v202, v74
    v_add_f32 v203, v203, v75
    s_add_u32 m0, s82, 6144
    v_add_u32_dpp v24, v36, v2 row_newbcast:6 row_mask:0xf bank_mask:0x3
    v_add_u32_dpp v24, v36, v2 row_newbcast:14 row_mask:0xf bank_mask:0xc
    buffer_load_dwordx4 v24, s[12:15], 0 offen offset:0 lds
    v_add_u32_dpp v25, v36, v3 row_newbcast:7 row_mask:0xf bank_mask:0x3
    v_add_u32_dpp v25, v36, v3 row_newbcast:15 row_mask:0xf bank_mask:0xc
    buffer_load_dwordx4 v25, s[24:27], 0 offen offset:1024 lds
    s_waitcnt vmcnt(21)
    s_barrier
    s_add_u32 m0, s81, 16384
    s_nop 0
    buffer_load_dwordx4 v28, s[16:19], s77 offen offset:0 lds
    v_lshlrev_b32 v72, 16, v204
    v_and_b32 v73, s33, v204
    v_lshlrev_b32 v74, 16, v205
    v_and_b32 v75, s33, v205
    v_lshlrev_b32 v204, 16, v206
    v_and_b32 v205, s33, v206
    v_lshlrev_b32 v206, 16, v207
    v_and_b32 v207, s33, v207
    v_add_f32 v204, v204, v72
    v_add_f32 v205, v205, v73
    v_add_f32 v206, v206, v74
    v_add_f32 v207, v207, v75
    buffer_load_dwordx4 v29, s[16:19], s77 offen offset:1024 lds
    buffer_load_dwordx4 v30, s[16:19], s77 offen offset:2048 lds
    v_lshlrev_b32 v72, 16, v208
    v_and_b32 v73, s33, v208
    v_lshlrev_b32 v74, 16, v209
    v_and_b32 v75, s33, v209
    v_lshlrev_b32 v208, 16, v210
    v_and_b32 v209, s33, v210
    v_lshlrev_b32 v210, 16, v211
    v_and_b32 v211, s33, v211
    v_add_f32 v208, v208, v72
    v_add_f32 v209, v209, v73
    v_add_f32 v210, v210, v74
    v_add_f32 v211, v211, v75
    buffer_load_dwordx4 v31, s[16:19], s77 offen offset:3072 lds
    s_add_u32 s77, s77, 16384
    v_lshlrev_b32 v72, 16, v212
    v_and_b32 v73, s33, v212
    v_lshlrev_b32 v74, 16, v213
    v_and_b32 v75, s33, v213
    v_lshlrev_b32 v212, 16, v214
    v_and_b32 v213, s33, v214
    v_lshlrev_b32 v214, 16, v215
    v_and_b32 v215, s33, v215
    v_add_f32 v212, v212, v72
    v_add_f32 v213, v213, v73
    v_add_f32 v214, v214, v74
    v_add_f32 v215, v215, v75
    s_add_u32 m0, s80, 32768
    v_add_u32_dpp v26, v41, v1 row_newbcast:1 row_mask:0xf bank_mask:0x3
    v_add_u32_dpp v26, v41, v1 row_newbcast:9 row_mask:0xf bank_mask:0xc
    buffer_load_dwordx4 v26, s[12:15], 0 offen offset:0 lds
    v_add_u32_dpp v27, v45, v1 row_newbcast:1 row_mask:0xf bank_mask:0x3
    v_add_u32_dpp v27, v45, v1 row_newbcast:9 row_mask:0xf bank_mask:0xc
    buffer_load_dwordx4 v27, s[28:31], 0 offen offset:2048 lds
    s_mov_b32 exec_lo, 0xfff00000
    s_mov_b32 exec_hi, 0xfff0fff0
    v_mov_b64 v[218:219], 0
    s_mov_b64 exec, -1
    v_lshlrev_b32 v72, 16, v216
    v_and_b32 v73, s33, v216
    v_lshlrev_b32 v74, 16, v217
    v_and_b32 v75, s33, v217
    v_lshlrev_b32 v216, 16, v218
    v_and_b32 v217, s33, v218
    v_lshlrev_b32 v218, 16, v219
    v_and_b32 v219, s33, v219
    v_add_f32 v216, v216, v72
    v_add_f32 v217, v217, v73
    v_add_f32 v218, v218, v74
    v_add_f32 v219, v219, v75
    s_add_u32 m0, s82, 8192
    v_add_u32_dpp v24, v37, v2 row_newbcast:0 row_mask:0xf bank_mask:0x3
    v_add_u32_dpp v24, v37, v2 row_newbcast:8 row_mask:0xf bank_mask:0xc
    buffer_load_dwordx4 v24, s[12:15], 0 offen offset:0 lds
    v_lshlrev_b32 v72, 16, v220
    v_and_b32 v73, s33, v220
    v_lshlrev_b32 v74, 16, v221
    v_and_b32 v75, s33, v221
    v_lshlrev_b32 v220, 16, v222
    v_and_b32 v221, s33, v222
    v_lshlrev_b32 v222, 16, v223
    v_and_b32 v223, s33, v223
    v_add_f32 v220, v220, v72
    v_add_f32 v221, v221, v73
    v_add_f32 v222, v222, v74
    v_add_f32 v223, v223, v75
    v_add_u32_dpp v25, v37, v3 row_newbcast:1 row_mask:0xf bank_mask:0x3
    v_add_u32_dpp v25, v37, v3 row_newbcast:9 row_mask:0xf bank_mask:0xc
    buffer_load_dwordx4 v25, s[24:27], 0 offen offset:1024 lds
    s_waitcnt vmcnt(21)
    ds_read_b128 v[84:87], v4 offset:0
    ds_read_b128 v[88:91], v5 offset:0
    s_mov_b64 exec, s[60:61]
    ds_read_b128 v[148:151], v22 offset:0
    ds_read_b128 v[152:155], v23 offset:0
    s_mov_b64 exec, -1
    s_waitcnt vmcnt(10)
    s_mov_b64 exec, s[60:61]
    ds_read_b128 v[132:135], v4 offset:10240
    ds_read_b128 v[136:139], v5 offset:10240
    s_mov_b64 exec, s[64:65]
    ds_read_b128 v[156:159], v22 offset:10240
    ds_read_b128 v[160:163], v23 offset:10240
    s_mov_b64 exec, -1
    s_barrier
    s_waitcnt lgkmcnt(0)
    s_add_u32 m0, s81, 32768
    s_nop 0
    buffer_load_dwordx4 v28, s[16:19], s77 offen offset:0 lds
    v_and_b32 v227, s33, v225
    v_lshlrev_b32 v226, 16, v225
    v_and_b32 v225, s33, v224
    v_lshlrev_b32 v224, 16, v224
    buffer_load_dwordx4 v29, s[16:19], s77 offen offset:1024 lds
    s_add_u32 m0, s82, 0
    v_add_u32_dpp v26, v37, v2 row_newbcast:2 row_mask:0xf bank_mask:0x3
    v_add_u32_dpp v26, v37, v2 row_newbcast:10 row_mask:0xf bank_mask:0xc
    buffer_load_dwordx4 v26, s[12:15], 0 offen offset:0 lds
    v_lshlrev_b32 v72, 16, v228
    v_and_b32 v73, s33, v228
    v_lshlrev_b32 v74, 16, v229
    v_and_b32 v75, s33, v229
    v_lshlrev_b32 v228, 16, v230
    v_and_b32 v229, s33, v230
    v_lshlrev_b32 v230, 16, v231
    v_and_b32 v231, s33, v231
    v_add_f32 v228, v228, v72
    v_add_f32 v229, v229, v73
    v_add_f32 v230, v230, v74
    v_add_f32 v231, v231, v75
    v_add_u32_dpp v27, v37, v3 row_newbcast:3 row_mask:0xf bank_mask:0x3
    v_add_u32_dpp v27, v37, v3 row_newbcast:11 row_mask:0xf bank_mask:0xc
    buffer_load_dwordx4 v27, s[24:27], 0 offen offset:1024 lds
    s_add_u32 m0, s81, 32768
    s_nop 0
    buffer_load_dwordx4 v30, s[16:19], s77 offen offset:2048 lds
    v_lshlrev_b32 v72, 16, v232
    v_and_b32 v73, s33, v232
    v_lshlrev_b32 v74, 16, v233
    v_and_b32 v75, s33, v233
    v_lshlrev_b32 v232, 16, v234
    v_and_b32 v233, s33, v234
    v_lshlrev_b32 v234, 16, v235
    v_and_b32 v235, s33, v235
    v_add_f32 v232, v232, v72
    v_add_f32 v233, v233, v73
    v_add_f32 v234, v234, v74
    v_add_f32 v235, v235, v75
    buffer_load_dwordx4 v31, s[16:19], s77 offen offset:3072 lds
    s_add_u32 s77, s77, 16384
    v_lshlrev_b32 v72, 16, v236
    v_and_b32 v73, s33, v236
    v_lshlrev_b32 v74, 16, v237
    v_and_b32 v75, s33, v237
    v_lshlrev_b32 v236, 16, v238
    v_and_b32 v237, s33, v238
    v_lshlrev_b32 v238, 16, v239
    v_and_b32 v239, s33, v239
    v_add_f32 v236, v236, v72
    v_add_f32 v237, v237, v73
    v_add_f32 v238, v238, v74
    v_add_f32 v239, v239, v75
    s_add_u32 m0, s80, 36864
    v_add_u32_dpp v24, v49, v1 row_newbcast:1 row_mask:0xf bank_mask:0x3
    v_add_u32_dpp v24, v49, v1 row_newbcast:9 row_mask:0xf bank_mask:0xc
    buffer_load_dwordx4 v24, s[12:15], 0 offen offset:0 lds
    v_add_u32_dpp v25, v53, v1 row_newbcast:1 row_mask:0xf bank_mask:0x3
    v_add_u32_dpp v25, v53, v1 row_newbcast:9 row_mask:0xf bank_mask:0xc
    buffer_load_dwordx4 v25, s[28:31], 0 offen offset:2048 lds
    s_mov_b32 exec_lo, 0xfff00000
    s_mov_b32 exec_hi, 0xfff0fff0
    v_mov_b64 v[242:243], 0
    s_mov_b64 exec, -1
    v_lshlrev_b32 v72, 16, v240
    v_and_b32 v73, s33, v240
    v_lshlrev_b32 v74, 16, v241
    v_and_b32 v75, s33, v241
    v_lshlrev_b32 v240, 16, v242
    v_and_b32 v241, s33, v242
    v_lshlrev_b32 v242, 16, v243
    v_and_b32 v243, s33, v243
    v_add_f32 v240, v240, v72
    v_add_f32 v241, v241, v73
    v_add_f32 v242, v242, v74
    v_add_f32 v243, v243, v75
    s_movk_i32 s74, 3200
    buffer_load_dword v36, v8, s[8:11], s74 offen
    buffer_load_dword v37, v8, s[8:11], s74 offen offset:256
    ds_read_b128 v[92:95], v4 offset:2048
    ds_read_b128 v[96:99], v5 offset:2048
    s_mov_b64 exec, s[62:63]
    ds_read_b128 v[148:151], v22 offset:2048
    ds_read_b128 v[152:155], v23 offset:2048
    s_mov_b64 exec, -1
    s_barrier
    s_waitcnt lgkmcnt(0)
    s_add_u32 m0, s81, 49152
    s_nop 0
    buffer_load_dwordx4 v28, s[16:19], s77 offen offset:0 lds
    v_lshlrev_b32 v72, 16, v244
    v_and_b32 v73, s33, v244
    v_lshlrev_b32 v74, 16, v245
    v_and_b32 v75, s33, v245
    v_lshlrev_b32 v244, 16, v246
    v_and_b32 v245, s33, v246
    v_lshlrev_b32 v246, 16, v247
    v_and_b32 v247, s33, v247
    v_add_f32 v244, v244, v72
    v_add_f32 v245, v245, v73
    v_add_f32 v246, v246, v74
    v_add_f32 v247, v247, v75
    buffer_load_dwordx4 v29, s[16:19], s77 offen offset:1024 lds
    v_lshlrev_b32 v38, 7, v38
    v_lshlrev_b32 v39, 7, v39
    s_nop 0
    s_add_u32 m0, s82, 2048
    v_add_u32_dpp v26, v38, v2 row_newbcast:0 row_mask:0xf bank_mask:0x3
    v_add_u32_dpp v26, v38, v2 row_newbcast:8 row_mask:0xf bank_mask:0xc
    buffer_load_dwordx4 v26, s[12:15], 0 offen offset:0 lds
    v_lshlrev_b32 v72, 16, v248
    v_and_b32 v73, s33, v248
    v_lshlrev_b32 v74, 16, v249
    v_and_b32 v75, s33, v249
    v_lshlrev_b32 v248, 16, v250
    v_and_b32 v249, s33, v250
    v_lshlrev_b32 v250, 16, v251
    v_and_b32 v251, s33, v251
    v_add_f32 v248, v248, v72
    v_add_f32 v249, v249, v73
    v_add_f32 v250, v250, v74
    v_add_f32 v251, v251, v75
    v_add_u32_dpp v27, v38, v3 row_newbcast:1 row_mask:0xf bank_mask:0x3
    v_add_u32_dpp v27, v38, v3 row_newbcast:9 row_mask:0xf bank_mask:0xc
    buffer_load_dwordx4 v27, s[24:27], 0 offen offset:1024 lds
    s_add_u32 m0, s81, 49152
    s_nop 0
    buffer_load_dwordx4 v30, s[16:19], s77 offen offset:2048 lds
    s_mov_b32 exec_lo, 0xfff00000
    s_mov_b32 exec_hi, 0xfff0fff0
    v_mov_b64 v[254:255], 0
    s_mov_b64 exec, -1
    v_lshlrev_b32 v72, 16, v252
    v_and_b32 v73, s33, v252
    v_lshlrev_b32 v74, 16, v253
    v_and_b32 v75, s33, v253
    v_lshlrev_b32 v252, 16, v254
    v_and_b32 v253, s33, v254
    v_lshlrev_b32 v254, 16, v255
    v_and_b32 v255, s33, v255
    v_add_f32 v252, v252, v72
    v_add_f32 v253, v253, v73
    v_add_f32 v254, v254, v74
    v_add_f32 v255, v255, v75
    buffer_load_dwordx4 v31, s[16:19], s77 offen offset:3072 lds
    s_add_u32 s77, s77, 16384
    s_add_u32 m0, s80, 0
    v_add_u32_dpp v24, v42, v1 row_newbcast:1 row_mask:0xf bank_mask:0x3
    v_add_u32_dpp v24, v42, v1 row_newbcast:9 row_mask:0xf bank_mask:0xc
    buffer_load_dwordx4 v24, s[12:15], 0 offen offset:0 lds
    s_mov_b64 exec, s[36:37]
    v_mov_b64 v[132:133], v[84:85]
    v_mov_b64 v[134:135], v[86:87]
    v_mov_b64 v[136:137], v[88:89]
    v_mov_b64 v[138:139], v[90:91]
    s_mov_b64 exec, -1
    v_add_u32_dpp v25, v46, v1 row_newbcast:1 row_mask:0xf bank_mask:0x3
    v_add_u32_dpp v25, v46, v1 row_newbcast:9 row_mask:0xf bank_mask:0xc
    buffer_load_dwordx4 v25, s[28:31], 0 offen offset:2048 lds
    ds_read_b128 v[100:103], v4 offset:4096
    ds_read_b128 v[104:107], v5 offset:4096
    s_mov_b64 exec, s[64:65]
    ds_read_b128 v[148:151], v22 offset:4096
    ds_read_b128 v[152:155], v23 offset:4096
    s_mov_b64 exec, -1
    s_waitcnt vmcnt(22)
    s_barrier
    s_waitcnt lgkmcnt(0)
    s_add_u32 m0, s81, 0
    s_nop 0
    buffer_load_dwordx4 v28, s[16:19], s77 offen offset:0 lds
    v_mfma_f32_16x16x32_bf16 v[72:75], v[84:87], v[132:135], 0
    v_mfma_f32_16x16x32_bf16 v[72:75], v[88:91], v[136:139], v[72:75]
    buffer_load_dwordx4 v29, s[16:19], s77 offen offset:1024 lds
    s_nop 3
    s_add_u32 m0, s82, 4096
    v_add_u32_dpp v26, v38, v2 row_newbcast:2 row_mask:0xf bank_mask:0x3
    v_add_u32_dpp v26, v38, v2 row_newbcast:10 row_mask:0xf bank_mask:0xc
    buffer_load_dwordx4 v26, s[12:15], 0 offen offset:0 lds
    s_mov_b64 exec, s[36:37]
    v_mov_b64 v[132:133], v[92:93]
    v_mov_b64 v[134:135], v[94:95]
    v_mov_b64 v[136:137], v[96:97]
    v_mov_b64 v[138:139], v[98:99]
    s_mov_b64 exec, -1
    v_add_u32_dpp v27, v38, v3 row_newbcast:3 row_mask:0xf bank_mask:0x3
    v_add_u32_dpp v27, v38, v3 row_newbcast:11 row_mask:0xf bank_mask:0xc
    buffer_load_dwordx4 v27, s[24:27], 0 offen offset:1024 lds
    v_mfma_f32_16x16x32_bf16 v[76:79], v[84:87], v[92:95], 0
    v_mfma_f32_16x16x32_bf16 v[76:79], v[88:91], v[96:99], v[76:79]
    s_add_u32 m0, s81, 0
    s_nop 0
    buffer_load_dwordx4 v30, s[16:19], s77 offen offset:2048 lds
    s_nop 3
    v_mfma_f32_16x16x32_bf16 v[80:83], v[92:95], v[132:135], 0
    v_mfma_f32_16x16x32_bf16 v[80:83], v[96:99], v[136:139], v[80:83]
    buffer_load_dwordx4 v31, s[16:19], s77 offen offset:3072 lds
    s_add_u32 s77, s77, 16384
    v_mul_f32 v32, v72, v164
    v_mul_f32 v33, v73, v165
    v_mul_f32 v34, v74, v166
    v_mul_f32 v35, v75, v167
    s_add_u32 m0, s80, 4096
    v_add_u32_dpp v24, v50, v1 row_newbcast:1 row_mask:0xf bank_mask:0x3
    v_add_u32_dpp v24, v50, v1 row_newbcast:9 row_mask:0xf bank_mask:0xc
    buffer_load_dwordx4 v24, s[12:15], 0 offen offset:0 lds
    v_mfma_f32_16x16x32_bf16 v[72:75], v[84:87], v[100:103], 0
    v_mfma_f32_16x16x32_bf16 v[72:75], v[88:91], v[104:107], v[72:75]
    v_add_u32_dpp v25, v54, v1 row_newbcast:1 row_mask:0xf bank_mask:0x3
    v_add_u32_dpp v25, v54, v1 row_newbcast:9 row_mask:0xf bank_mask:0xc
    buffer_load_dwordx4 v25, s[28:31], 0 offen offset:2048 lds
    v_fmac_f32 v32, v76, v168
    v_fmac_f32 v33, v77, v169
    v_fmac_f32 v34, v78, v170
    v_fmac_f32 v35, v79, v171
    ds_read_b128 v[108:111], v4 offset:6144
    ds_read_b128 v[112:115], v5 offset:6144
    s_mov_b64 exec, s[66:67]
    ds_read_b128 v[148:151], v22 offset:6144
    ds_read_b128 v[152:155], v23 offset:6144
    s_mov_b64 exec, -1
    s_waitcnt vmcnt(18)
    s_barrier
    s_waitcnt lgkmcnt(0)
    s_add_u32 m0, s81, 16384
    s_nop 0
    buffer_load_dwordx4 v28, s[16:19], s77 offen offset:0 lds
    s_mov_b64 exec, s[36:37]
    v_mov_b64 v[132:133], v[100:101]
    v_mov_b64 v[134:135], v[102:103]
    v_mov_b64 v[136:137], v[104:105]
    v_mov_b64 v[138:139], v[106:107]
    s_mov_b64 exec, -1
    buffer_load_dwordx4 v29, s[16:19], s77 offen offset:1024 lds
    v_mfma_f32_16x16x32_bf16 v[76:79], v[92:95], v[100:103], 0
    v_mfma_f32_16x16x32_bf16 v[76:79], v[96:99], v[104:107], v[76:79]
    s_add_u32 m0, s82, 6144
    v_add_u32_dpp v26, v38, v2 row_newbcast:4 row_mask:0xf bank_mask:0x3
    v_add_u32_dpp v26, v38, v2 row_newbcast:12 row_mask:0xf bank_mask:0xc
    buffer_load_dwordx4 v26, s[12:15], 0 offen offset:0 lds
    v_fmac_f32 v32, v80, v172
    v_fmac_f32 v33, v81, v173
    v_fmac_f32 v34, v82, v174
    v_fmac_f32 v35, v83, v175
    v_add_u32_dpp v27, v38, v3 row_newbcast:5 row_mask:0xf bank_mask:0x3
    v_add_u32_dpp v27, v38, v3 row_newbcast:13 row_mask:0xf bank_mask:0xc
    buffer_load_dwordx4 v27, s[24:27], 0 offen offset:1024 lds
    v_mfma_f32_16x16x32_bf16 v[80:83], v[84:87], v[108:111], 0
    v_mfma_f32_16x16x32_bf16 v[80:83], v[88:91], v[112:115], v[80:83]
    s_add_u32 m0, s81, 16384
    s_nop 0
    buffer_load_dwordx4 v30, s[16:19], s77 offen offset:2048 lds
    v_fmac_f32 v32, v72, v176
    v_fmac_f32 v33, v73, v177
    v_fmac_f32 v34, v74, v178
    v_fmac_f32 v35, v75, v179
    v_mfma_f32_16x16x32_bf16 v[72:75], v[100:103], v[132:135], 0
    v_mfma_f32_16x16x32_bf16 v[72:75], v[104:107], v[136:139], v[72:75]
    buffer_load_dwordx4 v31, s[16:19], s77 offen offset:3072 lds
    s_add_u32 s77, s77, 16384
    v_fmac_f32 v32, v76, v180
    v_fmac_f32 v33, v77, v181
    v_fmac_f32 v34, v78, v182
    v_fmac_f32 v35, v79, v183
    s_add_u32 m0, s80, 16384
    v_add_u32_dpp v24, v43, v1 row_newbcast:1 row_mask:0xf bank_mask:0x3
    v_add_u32_dpp v24, v43, v1 row_newbcast:9 row_mask:0xf bank_mask:0xc
    buffer_load_dwordx4 v24, s[12:15], 0 offen offset:0 lds
    v_mfma_f32_16x16x32_bf16 v[76:79], v[92:95], v[108:111], 0
    v_mfma_f32_16x16x32_bf16 v[76:79], v[96:99], v[112:115], v[76:79]
    v_add_u32_dpp v25, v47, v1 row_newbcast:1 row_mask:0xf bank_mask:0x3
    v_add_u32_dpp v25, v47, v1 row_newbcast:9 row_mask:0xf bank_mask:0xc
    buffer_load_dwordx4 v25, s[28:31], 0 offen offset:2048 lds
    v_fmac_f32 v32, v80, v184
    v_fmac_f32 v33, v81, v185
    v_fmac_f32 v34, v82, v186
    v_fmac_f32 v35, v83, v187
    ds_read_b128 v[116:119], v4 offset:8192
    ds_read_b128 v[120:123], v5 offset:8192
    s_mov_b64 exec, s[60:61]
    ds_read_b128 v[156:159], v22 offset:8192
    ds_read_b128 v[160:163], v23 offset:8192
    s_mov_b64 exec, -1
    s_waitcnt vmcnt(18)
    s_barrier
    s_waitcnt lgkmcnt(0)
    s_add_u32 m0, s81, 32768
    s_nop 0
    buffer_load_dwordx4 v28, s[16:19], s77 offen offset:0 lds
    v_mfma_f32_16x16x32_bf16 v[80:83], v[148:151], v[148:151], 0
    v_mfma_f32_16x16x32_bf16 v[80:83], v[152:155], v[152:155], v[80:83]
    buffer_load_dwordx4 v29, s[16:19], s77 offen offset:1024 lds
    v_fmac_f32 v32, v72, v188
    v_fmac_f32 v33, v73, v189
    v_fmac_f32 v34, v74, v190
    v_fmac_f32 v35, v75, v191
    s_add_u32 m0, s82, 8192
    v_add_u32_dpp v26, v38, v2 row_newbcast:6 row_mask:0xf bank_mask:0x3
    v_add_u32_dpp v26, v38, v2 row_newbcast:14 row_mask:0xf bank_mask:0xc
    buffer_load_dwordx4 v26, s[12:15], 0 offen offset:0 lds
    v_mfma_f32_16x16x32_bf16 v[72:75], v[84:87], v[116:119], 0
    v_mfma_f32_16x16x32_bf16 v[72:75], v[88:91], v[120:123], v[72:75]
    v_add_u32_dpp v27, v38, v3 row_newbcast:7 row_mask:0xf bank_mask:0x3
    v_add_u32_dpp v27, v38, v3 row_newbcast:15 row_mask:0xf bank_mask:0xc
    buffer_load_dwordx4 v27, s[24:27], 0 offen offset:1024 lds
    v_fmac_f32 v32, v76, v192
    v_fmac_f32 v33, v77, v193
    v_fmac_f32 v34, v78, v194
    v_fmac_f32 v35, v79, v195
    s_add_u32 m0, s81, 32768
    s_nop 0
    buffer_load_dwordx4 v30, s[16:19], s77 offen offset:2048 lds
    s_mov_b64 exec, s[36:37]
    v_mov_b64 v[132:133], v[108:109]
    v_mov_b64 v[134:135], v[110:111]
    v_mov_b64 v[136:137], v[112:113]
    v_mov_b64 v[138:139], v[114:115]
    s_mov_b64 exec, -1
    buffer_load_dwordx4 v31, s[16:19], s77 offen offset:3072 lds
    s_add_u32 s77, s77, 16384
    v_mfma_f32_16x16x32_bf16 v[76:79], v[100:103], v[108:111], 0
    v_mfma_f32_16x16x32_bf16 v[76:79], v[104:107], v[112:115], v[76:79]
    s_add_u32 m0, s80, 20480
    v_add_u32_dpp v24, v51, v1 row_newbcast:1 row_mask:0xf bank_mask:0x3
    v_add_u32_dpp v24, v51, v1 row_newbcast:9 row_mask:0xf bank_mask:0xc
    buffer_load_dwordx4 v24, s[12:15], 0 offen offset:0 lds
    v_fmac_f32 v32, v80, v196
    v_fmac_f32 v33, v81, v197
    v_fmac_f32 v34, v82, v198
    v_fmac_f32 v35, v83, v199
    v_add_u32_dpp v25, v55, v1 row_newbcast:1 row_mask:0xf bank_mask:0x3
    v_add_u32_dpp v25, v55, v1 row_newbcast:9 row_mask:0xf bank_mask:0xc
    buffer_load_dwordx4 v25, s[28:31], 0 offen offset:2048 lds
    v_mfma_f32_16x16x32_bf16 v[80:83], v[92:95], v[116:119], 0
    v_mfma_f32_16x16x32_bf16 v[80:83], v[96:99], v[120:123], v[80:83]
    s_add_u32 m0, s82, 10240
    v_add_u32_dpp v26, v39, v2 row_newbcast:4 row_mask:0xf bank_mask:0x3
    v_add_u32_dpp v26, v39, v2 row_newbcast:12 row_mask:0xf bank_mask:0xc
    s_mov_b32 exec_hi, 0
    buffer_load_dwordx4 v26, s[12:15], 0 offen offset:0 lds
    s_mov_b32 exec_hi, -1
    v_fmac_f32 v32, v72, v200
    v_fmac_f32 v33, v73, v201
    v_fmac_f32 v34, v74, v202
    v_fmac_f32 v35, v75, v203
    ds_read_b128 v[124:127], v4 offset:0
    ds_read_b128 v[128:131], v5 offset:0
    s_mov_b64 exec, s[62:63]
    ds_read_b128 v[156:159], v22 offset:0
    ds_read_b128 v[160:163], v23 offset:0
    s_mov_b64 exec, -1
    s_waitcnt vmcnt(17)
    s_barrier
    s_waitcnt lgkmcnt(0)
    s_add_u32 m0, s81, 49152
    s_nop 0
    buffer_load_dwordx4 v28, s[16:19], s77 offen offset:0 lds
    v_mfma_f32_16x16x32_bf16 v[72:75], v[84:87], v[124:127], 0
    v_mfma_f32_16x16x32_bf16 v[72:75], v[88:91], v[128:131], v[72:75]
    buffer_load_dwordx4 v29, s[16:19], s77 offen offset:1024 lds
    v_fmac_f32 v32, v76, v204
    v_fmac_f32 v33, v77, v205
    v_fmac_f32 v34, v78, v206
    v_fmac_f32 v35, v79, v207
    s_add_u32 m0, s82, 0
    v_add_u32_dpp v27, v39, v2 row_newbcast:0 row_mask:0xf bank_mask:0x3
    v_add_u32_dpp v27, v39, v2 row_newbcast:8 row_mask:0xf bank_mask:0xc
    buffer_load_dwordx4 v27, s[12:15], 0 offen offset:0 lds
    v_mfma_f32_16x16x32_bf16 v[76:79], v[108:111], v[132:135], 0
    v_mfma_f32_16x16x32_bf16 v[76:79], v[112:115], v[136:139], v[76:79]
    v_add_u32_dpp v24, v39, v3 row_newbcast:1 row_mask:0xf bank_mask:0x3
    v_add_u32_dpp v24, v39, v3 row_newbcast:9 row_mask:0xf bank_mask:0xc
    buffer_load_dwordx4 v24, s[24:27], 0 offen offset:1024 lds
    v_fmac_f32 v32, v80, v208
    v_fmac_f32 v33, v81, v209
    v_fmac_f32 v34, v82, v210
    v_fmac_f32 v35, v83, v211
    s_add_u32 m0, s81, 49152
    s_nop 0
    buffer_load_dwordx4 v30, s[16:19], s77 offen offset:2048 lds
    v_mfma_f32_16x16x32_bf16 v[80:83], v[92:95], v[124:127], 0
    v_mfma_f32_16x16x32_bf16 v[80:83], v[96:99], v[128:131], v[80:83]
    buffer_load_dwordx4 v31, s[16:19], s77 offen offset:3072 lds
    s_add_u32 s77, s77, 16384
    v_fmac_f32 v32, v72, v212
    v_fmac_f32 v33, v73, v213
    v_fmac_f32 v34, v74, v214
    v_fmac_f32 v35, v75, v215
    s_add_u32 m0, s80, 32768
    v_add_u32_dpp v25, v40, v1 row_newbcast:2 row_mask:0xf bank_mask:0x3
    v_add_u32_dpp v25, v40, v1 row_newbcast:10 row_mask:0xf bank_mask:0xc
    buffer_load_dwordx4 v25, s[12:15], 0 offen offset:0 lds
    v_mfma_f32_16x16x32_bf16 v[72:75], v[156:159], v[156:159], 0
    v_mfma_f32_16x16x32_bf16 v[72:75], v[160:163], v[160:163], v[72:75]
    v_add_u32_dpp v26, v44, v1 row_newbcast:2 row_mask:0xf bank_mask:0x3
    v_add_u32_dpp v26, v44, v1 row_newbcast:10 row_mask:0xf bank_mask:0xc
    buffer_load_dwordx4 v26, s[28:31], 0 offen offset:2048 lds
    v_fmac_f32 v32, v76, v216
    v_fmac_f32 v33, v77, v217
    v_fmac_f32 v34, v78, v218
    v_fmac_f32 v35, v79, v219
    ds_read_b128 v[84:87], v4 offset:2048
    ds_read_b128 v[88:91], v5 offset:2048
    s_mov_b64 exec, s[60:61]
    ds_read_b128 v[148:151], v22 offset:2048
    ds_read_b128 v[152:155], v23 offset:2048
    s_mov_b64 exec, -1
    s_waitcnt vmcnt(8)
    s_mov_b64 exec, s[60:61]
    ds_read_b128 v[140:143], v4 offset:10240
    ds_read_b128 v[144:147], v5 offset:10240
    s_mov_b64 exec, s[64:65]
    ds_read_b128 v[156:159], v22 offset:10240
    ds_read_b128 v[160:163], v23 offset:10240
    s_mov_b64 exec, -1
    s_barrier
    s_waitcnt lgkmcnt(0)
    s_add_u32 m0, s81, 0
    s_nop 0
    buffer_load_dwordx4 v28, s[16:19], s77 offen offset:0 lds
    v_mfma_f32_16x16x32_bf16 v[76:79], v[100:103], v[116:119], 0
    v_mfma_f32_16x16x32_bf16 v[76:79], v[104:107], v[120:123], v[76:79]
    buffer_load_dwordx4 v29, s[16:19], s77 offen offset:1024 lds
    v_fmac_f32 v32, v80, v220
    v_fmac_f32 v33, v81, v221
    v_fmac_f32 v34, v82, v222
    v_fmac_f32 v35, v83, v223
    s_add_u32 m0, s82, 2048
    v_add_u32_dpp v27, v39, v2 row_newbcast:2 row_mask:0xf bank_mask:0x3
    v_add_u32_dpp v27, v39, v2 row_newbcast:10 row_mask:0xf bank_mask:0xc
    buffer_load_dwordx4 v27, s[12:15], 0 offen offset:0 lds
    s_mov_b64 exec, s[36:37]
    v_mov_b64 v[132:133], v[116:117]
    v_mov_b64 v[134:135], v[118:119]
    v_mov_b64 v[136:137], v[120:121]
    v_mov_b64 v[138:139], v[122:123]
    s_mov_b64 exec, -1
    v_add_u32_dpp v24, v39, v3 row_newbcast:3 row_mask:0xf bank_mask:0x3
    v_add_u32_dpp v24, v39, v3 row_newbcast:11 row_mask:0xf bank_mask:0xc
    buffer_load_dwordx4 v24, s[24:27], 0 offen offset:1024 lds
    v_mfma_f32_16x16x32_bf16 v[80:83], v[108:111], v[116:119], 0
    v_mfma_f32_16x16x32_bf16 v[80:83], v[112:115], v[120:123], v[80:83]
    s_add_u32 m0, s81, 0
    s_nop 0
    buffer_load_dwordx4 v30, s[16:19], s77 offen offset:2048 lds
    v_fmac_f32 v32, v72, v224
    v_fmac_f32 v33, v73, v225
    v_fmac_f32 v34, v74, v226
    v_fmac_f32 v35, v75, v227
    buffer_load_dwordx4 v31, s[16:19], s77 offen offset:3072 lds
    s_add_u32 s77, s77, 16384
    v_mfma_f32_16x16x32_bf16 v[72:75], v[100:103], v[124:127], 0
    v_mfma_f32_16x16x32_bf16 v[72:75], v[104:107], v[128:131], v[72:75]
    s_add_u32 m0, s80, 36864
    v_add_u32_dpp v25, v48, v1 row_newbcast:2 row_mask:0xf bank_mask:0x3
    v_add_u32_dpp v25, v48, v1 row_newbcast:10 row_mask:0xf bank_mask:0xc
    buffer_load_dwordx4 v25, s[12:15], 0 offen offset:0 lds
    v_fmac_f32 v32, v76, v228
    v_fmac_f32 v33, v77, v229
    v_fmac_f32 v34, v78, v230
    v_fmac_f32 v35, v79, v231
    v_add_u32_dpp v26, v52, v1 row_newbcast:2 row_mask:0xf bank_mask:0x3
    v_add_u32_dpp v26, v52, v1 row_newbcast:10 row_mask:0xf bank_mask:0xc
    buffer_load_dwordx4 v26, s[28:31], 0 offen offset:2048 lds
    v_mfma_f32_16x16x32_bf16 v[76:79], v[116:119], v[132:135], 0
    v_mfma_f32_16x16x32_bf16 v[76:79], v[120:123], v[136:139], v[76:79]
    s_movk_i32 s74, 4800
    buffer_load_dword v38, v8, s[8:11], s74 offen
    buffer_load_dword v39, v8, s[8:11], s74 offen offset:256
    v_fmac_f32 v32, v80, v232
    v_fmac_f32 v33, v81, v233
    v_fmac_f32 v34, v82, v234
    v_fmac_f32 v35, v83, v235
    ds_read_b128 v[92:95], v4 offset:4096
    ds_read_b128 v[96:99], v5 offset:4096
    s_mov_b64 exec, s[62:63]
    ds_read_b128 v[148:151], v22 offset:4096
    ds_read_b128 v[152:155], v23 offset:4096
    s_mov_b64 exec, -1
    s_barrier
    s_waitcnt lgkmcnt(0)
    s_add_u32 m0, s81, 16384
    s_nop 0
    buffer_load_dwordx4 v28, s[16:19], s77 offen offset:0 lds
    v_mfma_f32_16x16x32_bf16 v[80:83], v[108:111], v[124:127], 0
    v_mfma_f32_16x16x32_bf16 v[80:83], v[112:115], v[128:131], v[80:83]
    buffer_load_dwordx4 v29, s[16:19], s77 offen offset:1024 lds
    v_fmac_f32 v32, v72, v236
    v_fmac_f32 v33, v73, v237
    v_fmac_f32 v34, v74, v238
    v_fmac_f32 v35, v75, v239
    v_lshlrev_b32 v36, 7, v36
    v_lshlrev_b32 v37, 7, v37
    s_nop 0
    s_add_u32 m0, s82, 4096
    v_add_u32_dpp v27, v36, v2 row_newbcast:0 row_mask:0xf bank_mask:0x3
    v_add_u32_dpp v27, v36, v2 row_newbcast:8 row_mask:0xf bank_mask:0xc
    buffer_load_dwordx4 v27, s[12:15], 0 offen offset:0 lds
    s_mov_b64 exec, s[36:37]
    v_mov_b64 v[132:133], v[124:125]
    v_mov_b64 v[134:135], v[126:127]
    v_mov_b64 v[136:137], v[128:129]
    v_mov_b64 v[138:139], v[130:131]
    s_mov_b64 exec, -1
    v_add_u32_dpp v24, v36, v3 row_newbcast:1 row_mask:0xf bank_mask:0x3
    v_add_u32_dpp v24, v36, v3 row_newbcast:9 row_mask:0xf bank_mask:0xc
    buffer_load_dwordx4 v24, s[24:27], 0 offen offset:1024 lds
    v_mfma_f32_16x16x32_bf16 v[72:75], v[116:119], v[124:127], 0
    v_mfma_f32_16x16x32_bf16 v[72:75], v[120:123], v[128:131], v[72:75]
    s_add_u32 m0, s81, 16384
    s_nop 0
    buffer_load_dwordx4 v30, s[16:19], s77 offen offset:2048 lds
    v_fmac_f32 v32, v76, v240
    v_fmac_f32 v33, v77, v241
    v_fmac_f32 v34, v78, v242
    v_fmac_f32 v35, v79, v243
    buffer_load_dwordx4 v31, s[16:19], s77 offen offset:3072 lds
    s_add_u32 s77, s77, 16384
    v_mfma_f32_16x16x32_bf16 v[76:79], v[124:127], v[132:135], 0
    v_mfma_f32_16x16x32_bf16 v[76:79], v[128:131], v[136:139], v[76:79]
    s_add_u32 m0, s80, 0
    v_add_u32_dpp v25, v41, v1 row_newbcast:2 row_mask:0xf bank_mask:0x3
    v_add_u32_dpp v25, v41, v1 row_newbcast:10 row_mask:0xf bank_mask:0xc
    buffer_load_dwordx4 v25, s[12:15], 0 offen offset:0 lds
    v_fmac_f32 v32, v80, v244
    v_fmac_f32 v33, v81, v245
    v_fmac_f32 v34, v82, v246
    v_fmac_f32 v35, v83, v247
    v_add_u32_dpp v26, v45, v1 row_newbcast:2 row_mask:0xf bank_mask:0x3
    v_add_u32_dpp v26, v45, v1 row_newbcast:10 row_mask:0xf bank_mask:0xc
    buffer_load_dwordx4 v26, s[28:31], 0 offen offset:2048 lds
    s_mov_b64 exec, s[36:37]
    v_mov_b64 v[140:141], v[84:85]
    v_mov_b64 v[142:143], v[86:87]
    v_mov_b64 v[144:145], v[88:89]
    v_mov_b64 v[146:147], v[90:91]
    s_mov_b64 exec, -1
    ds_read_b128 v[100:103], v4 offset:6144
    ds_read_b128 v[104:107], v5 offset:6144
    s_mov_b64 exec, s[64:65]
    ds_read_b128 v[148:151], v22 offset:6144
    ds_read_b128 v[152:155], v23 offset:6144
    s_mov_b64 exec, -1
    s_waitcnt vmcnt(20)
    s_barrier
    s_waitcnt lgkmcnt(0)
    s_add_u32 m0, s81, 32768
    s_nop 0
    buffer_load_dwordx4 v28, s[16:19], s77 offen offset:0 lds
    v_mfma_f32_16x16x32_bf16 v[80:83], v[84:87], v[140:143], 0
    v_mfma_f32_16x16x32_bf16 v[80:83], v[88:91], v[144:147], v[80:83]
    buffer_load_dwordx4 v29, s[16:19], s77 offen offset:1024 lds
    v_fmac_f32 v32, v72, v248
    v_fmac_f32 v33, v73, v249
    v_fmac_f32 v34, v74, v250
    v_fmac_f32 v35, v75, v251
    s_add_u32 m0, s82, 6144
    v_add_u32_dpp v27, v36, v2 row_newbcast:2 row_mask:0xf bank_mask:0x3
    v_add_u32_dpp v27, v36, v2 row_newbcast:10 row_mask:0xf bank_mask:0xc
    buffer_load_dwordx4 v27, s[12:15], 0 offen offset:0 lds
    s_mov_b64 exec, s[36:37]
    v_mov_b64 v[140:141], v[92:93]
    v_mov_b64 v[142:143], v[94:95]
    v_mov_b64 v[144:145], v[96:97]
    v_mov_b64 v[146:147], v[98:99]
    s_mov_b64 exec, -1
    v_add_u32_dpp v24, v36, v3 row_newbcast:3 row_mask:0xf bank_mask:0x3
    v_add_u32_dpp v24, v36, v3 row_newbcast:11 row_mask:0xf bank_mask:0xc
    buffer_load_dwordx4 v24, s[24:27], 0 offen offset:1024 lds
    v_mfma_f32_16x16x32_bf16 v[72:75], v[84:87], v[92:95], 0
    v_mfma_f32_16x16x32_bf16 v[72:75], v[88:91], v[96:99], v[72:75]
    s_add_u32 m0, s81, 32768
    s_nop 0
    buffer_load_dwordx4 v30, s[16:19], s77 offen offset:2048 lds
    v_fmac_f32 v32, v76, v252
    v_fmac_f32 v33, v77, v253
    v_fmac_f32 v34, v78, v254
    v_fmac_f32 v35, v79, v255
    v_add_f32 v12, v32, v33
    v_add_f32 v13, v34, v35
    v_add_f32 v12, v12, v13
    v_mfma_f32_16x16x32_bf16 v[76:79], v[92:95], v[140:143], 0
    v_mfma_f32_16x16x32_bf16 v[76:79], v[96:99], v[144:147], v[76:79]
    buffer_load_dwordx4 v31, s[16:19], s77 offen offset:3072 lds
    s_add_u32 s77, s77, 16384
    v_add_f32_dpp v12, v12, v12 row_shr:1 row_mask:0xf bank_mask:0xf bound_ctrl:0
    v_mul_f32 v32, v80, v164
    v_mul_f32 v33, v81, v165
    v_mul_f32 v34, v82, v166
    v_mul_f32 v35, v83, v167
    s_add_u32 m0, s80, 4096
    v_add_u32_dpp v25, v49, v1 row_newbcast:2 row_mask:0xf bank_mask:0x3
    v_add_u32_dpp v25, v49, v1 row_newbcast:10 row_mask:0xf bank_mask:0xc
    buffer_load_dwordx4 v25, s[12:15], 0 offen offset:0 lds
    v_add_f32_dpp v12, v12, v12 row_shr:2 row_mask:0xf bank_mask:0xf bound_ctrl:0
    v_mfma_f32_16x16x32_bf16 v[80:83], v[84:87], v[100:103], 0
    v_mfma_f32_16x16x32_bf16 v[80:83], v[88:91], v[104:107], v[80:83]
    v_add_u32_dpp v26, v53, v1 row_newbcast:2 row_mask:0xf bank_mask:0x3
    v_add_u32_dpp v26, v53, v1 row_newbcast:10 row_mask:0xf bank_mask:0xc
    buffer_load_dwordx4 v26, s[28:31], 0 offen offset:2048 lds
    v_add_f32_dpp v12, v12, v12 row_shr:4 row_mask:0xf bank_mask:0xf bound_ctrl:0
    v_fmac_f32 v32, v72, v168
    v_fmac_f32 v33, v73, v169
    v_fmac_f32 v34, v74, v170
    v_fmac_f32 v35, v75, v171
    v_add_f32_dpp v12, v12, v12 row_shr:8 row_mask:0xf bank_mask:0xf bound_ctrl:0
    ds_read_b128 v[108:111], v4 offset:8192
    ds_read_b128 v[112:115], v5 offset:8192
    s_mov_b64 exec, s[66:67]
    ds_read_b128 v[148:151], v22 offset:8192
    ds_read_b128 v[152:155], v23 offset:8192
    s_mov_b64 exec, -1
    s_waitcnt vmcnt(18)
    s_barrier
    s_waitcnt lgkmcnt(0)
    s_add_u32 m0, s81, 49152
    s_nop 0
    buffer_load_dwordx4 v28, s[16:19], s77 offen offset:0 lds
    s_mov_b64 exec, s[36:37]
    v_mov_b64 v[140:141], v[100:101]
    v_mov_b64 v[142:143], v[102:103]
    v_mov_b64 v[144:145], v[104:105]
    v_mov_b64 v[146:147], v[106:107]
    s_mov_b64 exec, -1
    buffer_load_dwordx4 v29, s[16:19], s77 offen offset:1024 lds
    v_add_f32_dpp v12, v12, v12 row_bcast:15 row_mask:0xa bank_mask:0xf
    v_mfma_f32_16x16x32_bf16 v[72:75], v[92:95], v[100:103], 0
    v_mfma_f32_16x16x32_bf16 v[72:75], v[96:99], v[104:107], v[72:75]
    s_add_u32 m0, s82, 8192
    v_add_u32_dpp v27, v36, v2 row_newbcast:4 row_mask:0xf bank_mask:0x3
    v_add_u32_dpp v27, v36, v2 row_newbcast:12 row_mask:0xf bank_mask:0xc
    buffer_load_dwordx4 v27, s[12:15], 0 offen offset:0 lds
    v_add_f32_dpp v12, v12, v12 row_bcast:31 row_mask:0xc bank_mask:0xf
    v_fmac_f32 v32, v76, v172
    v_fmac_f32 v33, v77, v173
    v_fmac_f32 v34, v78, v174
    v_fmac_f32 v35, v79, v175
    v_add_u32_dpp v24, v36, v3 row_newbcast:5 row_mask:0xf bank_mask:0x3
    v_add_u32_dpp v24, v36, v3 row_newbcast:13 row_mask:0xf bank_mask:0xc
    buffer_load_dwordx4 v24, s[24:27], 0 offen offset:1024 lds
    v_readlane_b32 s38, v12, 63
    v_mfma_f32_16x16x32_bf16 v[76:79], v[84:87], v[108:111], 0
    v_mfma_f32_16x16x32_bf16 v[76:79], v[88:91], v[112:115], v[76:79]
    s_add_u32 m0, s81, 49152
    s_nop 0
    buffer_load_dwordx4 v30, s[16:19], s77 offen offset:2048 lds
    v_writelane_b32 v9, s38, 0
    v_fmac_f32 v32, v80, v176
    v_fmac_f32 v33, v81, v177
    v_fmac_f32 v34, v82, v178
    v_fmac_f32 v35, v83, v179
    v_mfma_f32_16x16x32_bf16 v[80:83], v[100:103], v[140:143], 0
    v_mfma_f32_16x16x32_bf16 v[80:83], v[104:107], v[144:147], v[80:83]
    buffer_load_dwordx4 v31, s[16:19], s77 offen offset:3072 lds
    s_add_u32 s77, s77, 16384
    v_fmac_f32 v32, v72, v180
    v_fmac_f32 v33, v73, v181
    v_fmac_f32 v34, v74, v182
    v_fmac_f32 v35, v75, v183
    s_add_u32 m0, s80, 16384
    v_add_u32_dpp v25, v42, v1 row_newbcast:2 row_mask:0xf bank_mask:0x3
    v_add_u32_dpp v25, v42, v1 row_newbcast:10 row_mask:0xf bank_mask:0xc
    buffer_load_dwordx4 v25, s[12:15], 0 offen offset:0 lds
    v_mfma_f32_16x16x32_bf16 v[72:75], v[92:95], v[108:111], 0
    v_mfma_f32_16x16x32_bf16 v[72:75], v[96:99], v[112:115], v[72:75]
    v_add_u32_dpp v26, v46, v1 row_newbcast:2 row_mask:0xf bank_mask:0x3
    v_add_u32_dpp v26, v46, v1 row_newbcast:10 row_mask:0xf bank_mask:0xc
    buffer_load_dwordx4 v26, s[28:31], 0 offen offset:2048 lds
    v_fmac_f32 v32, v76, v184
    v_fmac_f32 v33, v77, v185
    v_fmac_f32 v34, v78, v186
    v_fmac_f32 v35, v79, v187
    ds_read_b128 v[116:119], v4 offset:0
    ds_read_b128 v[120:123], v5 offset:0
    s_mov_b64 exec, s[60:61]
    ds_read_b128 v[156:159], v22 offset:0
    ds_read_b128 v[160:163], v23 offset:0
    s_mov_b64 exec, -1
    s_waitcnt vmcnt(18)
    s_barrier
    s_waitcnt lgkmcnt(0)
    s_add_u32 m0, s81, 0
    s_nop 0
    buffer_load_dwordx4 v28, s[16:19], s77 offen offset:0 lds
    v_mfma_f32_16x16x32_bf16 v[76:79], v[148:151], v[148:151], 0
    v_mfma_f32_16x16x32_bf16 v[76:79], v[152:155], v[152:155], v[76:79]
    buffer_load_dwordx4 v29, s[16:19], s77 offen offset:1024 lds
    v_fmac_f32 v32, v80, v188
    v_fmac_f32 v33, v81, v189
    v_fmac_f32 v34, v82, v190
    v_fmac_f32 v35, v83, v191
    s_add_u32 m0, s82, 0
    v_add_u32_dpp v27, v36, v2 row_newbcast:6 row_mask:0xf bank_mask:0x3
    v_add_u32_dpp v27, v36, v2 row_newbcast:14 row_mask:0xf bank_mask:0xc
    buffer_load_dwordx4 v27, s[12:15], 0 offen offset:0 lds
    v_mfma_f32_16x16x32_bf16 v[80:83], v[84:87], v[116:119], 0
    v_mfma_f32_16x16x32_bf16 v[80:83], v[88:91], v[120:123], v[80:83]
    v_add_u32_dpp v24, v36, v3 row_newbcast:7 row_mask:0xf bank_mask:0x3
    v_add_u32_dpp v24, v36, v3 row_newbcast:15 row_mask:0xf bank_mask:0xc
    buffer_load_dwordx4 v24, s[24:27], 0 offen offset:1024 lds
    v_fmac_f32 v32, v72, v192
    v_fmac_f32 v33, v73, v193
    v_fmac_f32 v34, v74, v194
    v_fmac_f32 v35, v75, v195
    s_add_u32 m0, s81, 0
    s_nop 0
    buffer_load_dwordx4 v30, s[16:19], s77 offen offset:2048 lds
    s_mov_b64 exec, s[36:37]
    v_mov_b64 v[140:141], v[108:109]
    v_mov_b64 v[142:143], v[110:111]
    v_mov_b64 v[144:145], v[112:113]
    v_mov_b64 v[146:147], v[114:115]
    s_mov_b64 exec, -1
    buffer_load_dwordx4 v31, s[16:19], s77 offen offset:3072 lds
    s_add_u32 s77, s77, 16384
    v_mfma_f32_16x16x32_bf16 v[72:75], v[100:103], v[108:111], 0
    v_mfma_f32_16x16x32_bf16 v[72:75], v[104:107], v[112:115], v[72:75]
    s_add_u32 m0, s80, 20480
    v_add_u32_dpp v25, v50, v1 row_newbcast:2 row_mask:0xf bank_mask:0x3
    v_add_u32_dpp v25, v50, v1 row_newbcast:10 row_mask:0xf bank_mask:0xc
    buffer_load_dwordx4 v25, s[12:15], 0 offen offset:0 lds
    v_fmac_f32 v32, v76, v196
    v_fmac_f32 v33, v77, v197
    v_fmac_f32 v34, v78, v198
    v_fmac_f32 v35, v79, v199
    v_add_u32_dpp v26, v54, v1 row_newbcast:2 row_mask:0xf bank_mask:0x3
    v_add_u32_dpp v26, v54, v1 row_newbcast:10 row_mask:0xf bank_mask:0xc
    buffer_load_dwordx4 v26, s[28:31], 0 offen offset:2048 lds
    v_mfma_f32_16x16x32_bf16 v[76:79], v[92:95], v[116:119], 0
    v_mfma_f32_16x16x32_bf16 v[76:79], v[96:99], v[120:123], v[76:79]
    s_add_u32 m0, s82, 10240
    v_add_u32_dpp v27, v37, v2 row_newbcast:4 row_mask:0xf bank_mask:0x3
    v_add_u32_dpp v27, v37, v2 row_newbcast:12 row_mask:0xf bank_mask:0xc
    s_mov_b32 exec_hi, 0
    buffer_load_dwordx4 v27, s[12:15], 0 offen offset:0 lds
    s_mov_b32 exec_hi, -1
    v_fmac_f32 v32, v80, v200
    v_fmac_f32 v33, v81, v201
    v_fmac_f32 v34, v82, v202
    v_fmac_f32 v35, v83, v203
    ds_read_b128 v[124:127], v4 offset:2048
    ds_read_b128 v[128:131], v5 offset:2048
    s_mov_b64 exec, s[62:63]
    ds_read_b128 v[156:159], v22 offset:2048
    ds_read_b128 v[160:163], v23 offset:2048
    s_mov_b64 exec, -1
    s_waitcnt vmcnt(17)
    s_barrier
    s_waitcnt lgkmcnt(0)
    s_add_u32 m0, s81, 16384
    s_nop 0
    buffer_load_dwordx4 v28, s[16:19], s77 offen offset:0 lds
    v_mfma_f32_16x16x32_bf16 v[80:83], v[84:87], v[124:127], 0
    v_mfma_f32_16x16x32_bf16 v[80:83], v[88:91], v[128:131], v[80:83]
    buffer_load_dwordx4 v29, s[16:19], s77 offen offset:1024 lds
    v_fmac_f32 v32, v72, v204
    v_fmac_f32 v33, v73, v205
    v_fmac_f32 v34, v74, v206
    v_fmac_f32 v35, v75, v207
    s_add_u32 m0, s82, 2048
    v_add_u32_dpp v24, v37, v2 row_newbcast:0 row_mask:0xf bank_mask:0x3
    v_add_u32_dpp v24, v37, v2 row_newbcast:8 row_mask:0xf bank_mask:0xc
    buffer_load_dwordx4 v24, s[12:15], 0 offen offset:0 lds
    v_mfma_f32_16x16x32_bf16 v[72:75], v[108:111], v[140:143], 0
    v_mfma_f32_16x16x32_bf16 v[72:75], v[112:115], v[144:147], v[72:75]
    v_add_u32_dpp v25, v37, v3 row_newbcast:1 row_mask:0xf bank_mask:0x3
    v_add_u32_dpp v25, v37, v3 row_newbcast:9 row_mask:0xf bank_mask:0xc
    buffer_load_dwordx4 v25, s[24:27], 0 offen offset:1024 lds
    v_fmac_f32 v32, v76, v208
    v_fmac_f32 v33, v77, v209
    v_fmac_f32 v34, v78, v210
    v_fmac_f32 v35, v79, v211
    s_add_u32 m0, s81, 16384
    s_nop 0
    buffer_load_dwordx4 v30, s[16:19], s77 offen offset:2048 lds
    v_mfma_f32_16x16x32_bf16 v[76:79], v[92:95], v[124:127], 0
    v_mfma_f32_16x16x32_bf16 v[76:79], v[96:99], v[128:131], v[76:79]
    buffer_load_dwordx4 v31, s[16:19], s77 offen offset:3072 lds
    s_add_u32 s77, s77, 16384
    v_fmac_f32 v32, v80, v212
    v_fmac_f32 v33, v81, v213
    v_fmac_f32 v34, v82, v214
    v_fmac_f32 v35, v83, v215
    s_add_u32 m0, s80, 32768
    v_add_u32_dpp v26, v43, v1 row_newbcast:2 row_mask:0xf bank_mask:0x3
    v_add_u32_dpp v26, v43, v1 row_newbcast:10 row_mask:0xf bank_mask:0xc
    buffer_load_dwordx4 v26, s[12:15], 0 offen offset:0 lds
    v_mfma_f32_16x16x32_bf16 v[80:83], v[156:159], v[156:159], 0
    v_mfma_f32_16x16x32_bf16 v[80:83], v[160:163], v[160:163], v[80:83]
    v_add_u32_dpp v27, v47, v1 row_newbcast:2 row_mask:0xf bank_mask:0x3
    v_add_u32_dpp v27, v47, v1 row_newbcast:10 row_mask:0xf bank_mask:0xc
    buffer_load_dwordx4 v27, s[28:31], 0 offen offset:2048 lds
    v_fmac_f32 v32, v72, v216
    v_fmac_f32 v33, v73, v217
    v_fmac_f32 v34, v74, v218
    v_fmac_f32 v35, v75, v219
    ds_read_b128 v[84:87], v4 offset:4096
    ds_read_b128 v[88:91], v5 offset:4096
    s_mov_b64 exec, s[60:61]
    ds_read_b128 v[148:151], v22 offset:4096
    ds_read_b128 v[152:155], v23 offset:4096
    s_mov_b64 exec, -1
    s_waitcnt vmcnt(8)
    s_mov_b64 exec, s[60:61]
    ds_read_b128 v[132:135], v4 offset:10240
    ds_read_b128 v[136:139], v5 offset:10240
    s_mov_b64 exec, s[64:65]
    ds_read_b128 v[156:159], v22 offset:10240
    ds_read_b128 v[160:163], v23 offset:10240
    s_mov_b64 exec, -1
    s_barrier
    s_waitcnt lgkmcnt(0)
    s_add_u32 m0, s81, 32768
    s_nop 0
    buffer_load_dwordx4 v28, s[16:19], s77 offen offset:0 lds
    v_mfma_f32_16x16x32_bf16 v[72:75], v[100:103], v[116:119], 0
    v_mfma_f32_16x16x32_bf16 v[72:75], v[104:107], v[120:123], v[72:75]
    buffer_load_dwordx4 v29, s[16:19], s77 offen offset:1024 lds
    v_fmac_f32 v32, v76, v220
    v_fmac_f32 v33, v77, v221
    v_fmac_f32 v34, v78, v222
    v_fmac_f32 v35, v79, v223
    s_add_u32 m0, s82, 4096
    v_add_u32_dpp v24, v37, v2 row_newbcast:2 row_mask:0xf bank_mask:0x3
    v_add_u32_dpp v24, v37, v2 row_newbcast:10 row_mask:0xf bank_mask:0xc
    buffer_load_dwordx4 v24, s[12:15], 0 offen offset:0 lds
    s_mov_b64 exec, s[36:37]
    v_mov_b64 v[140:141], v[116:117]
    v_mov_b64 v[142:143], v[118:119]
    v_mov_b64 v[144:145], v[120:121]
    v_mov_b64 v[146:147], v[122:123]
    s_mov_b64 exec, -1
    v_add_u32_dpp v25, v37, v3 row_newbcast:3 row_mask:0xf bank_mask:0x3
    v_add_u32_dpp v25, v37, v3 row_newbcast:11 row_mask:0xf bank_mask:0xc
    buffer_load_dwordx4 v25, s[24:27], 0 offen offset:1024 lds
    v_mfma_f32_16x16x32_bf16 v[76:79], v[108:111], v[116:119], 0
    v_mfma_f32_16x16x32_bf16 v[76:79], v[112:115], v[120:123], v[76:79]
    s_add_u32 m0, s81, 32768
    s_nop 0
    buffer_load_dwordx4 v30, s[16:19], s77 offen offset:2048 lds
    v_fmac_f32 v32, v80, v224
    v_fmac_f32 v33, v81, v225
    v_fmac_f32 v34, v82, v226
    v_fmac_f32 v35, v83, v227
    buffer_load_dwordx4 v31, s[16:19], s77 offen offset:3072 lds
    s_add_u32 s77, s77, 16384
    v_mfma_f32_16x16x32_bf16 v[80:83], v[100:103], v[124:127], 0
    v_mfma_f32_16x16x32_bf16 v[80:83], v[104:107], v[128:131], v[80:83]
    s_add_u32 m0, s80, 36864
    v_add_u32_dpp v26, v51, v1 row_newbcast:2 row_mask:0xf bank_mask:0x3
    v_add_u32_dpp v26, v51, v1 row_newbcast:10 row_mask:0xf bank_mask:0xc
    buffer_load_dwordx4 v26, s[12:15], 0 offen offset:0 lds
    v_fmac_f32 v32, v72, v228
    v_fmac_f32 v33, v73, v229
    v_fmac_f32 v34, v74, v230
    v_fmac_f32 v35, v75, v231
    v_add_u32_dpp v27, v55, v1 row_newbcast:2 row_mask:0xf bank_mask:0x3
    v_add_u32_dpp v27, v55, v1 row_newbcast:10 row_mask:0xf bank_mask:0xc
    buffer_load_dwordx4 v27, s[28:31], 0 offen offset:2048 lds
    v_mfma_f32_16x16x32_bf16 v[72:75], v[116:119], v[140:143], 0
    v_mfma_f32_16x16x32_bf16 v[72:75], v[120:123], v[144:147], v[72:75]
    s_movk_i32 s74, 6400
    buffer_load_dword v36, v8, s[8:11], s74 offen
    buffer_load_dword v37, v8, s[8:11], s74 offen offset:256
    v_fmac_f32 v32, v76, v232
    v_fmac_f32 v33, v77, v233
    v_fmac_f32 v34, v78, v234
    v_fmac_f32 v35, v79, v235
    ds_read_b128 v[92:95], v4 offset:6144
    ds_read_b128 v[96:99], v5 offset:6144
    s_mov_b64 exec, s[62:63]
    ds_read_b128 v[148:151], v22 offset:6144
    ds_read_b128 v[152:155], v23 offset:6144
    s_mov_b64 exec, -1
    s_barrier
    s_mov_b32 s20, s50
    s_and_b32 s21, s51, 0xffff
    s_mov_b32 s22, 512
    s_mov_b32 s23, 0x20000
    s_mov_b32 exec_hi, 0
    s_mov_b32 m0, 162624
    v_mov_b32 v16, 0
    buffer_load_dwordx4 v10, s[20:23], 0 offen lds
    global_load_ushort v17, v16, s[52:53]
    s_mov_b32 exec_hi, -1
    s_waitcnt lgkmcnt(0)
    s_add_u32 m0, s81, 49152
    s_nop 0
    buffer_load_dwordx4 v28, s[16:19], s77 offen offset:0 lds
    v_mfma_f32_16x16x32_bf16 v[76:79], v[108:111], v[124:127], 0
    v_mfma_f32_16x16x32_bf16 v[76:79], v[112:115], v[128:131], v[76:79]
    buffer_load_dwordx4 v29, s[16:19], s77 offen offset:1024 lds
    v_fmac_f32 v32, v80, v236
    v_fmac_f32 v33, v81, v237
    v_fmac_f32 v34, v82, v238
    v_fmac_f32 v35, v83, v239
    v_lshlrev_b32 v38, 7, v38
    v_lshlrev_b32 v39, 7, v39
    s_nop 0
    s_add_u32 m0, s82, 6144
    v_add_u32_dpp v24, v38, v2 row_newbcast:0 row_mask:0xf bank_mask:0x3
    v_add_u32_dpp v24, v38, v2 row_newbcast:8 row_mask:0xf bank_mask:0xc
    buffer_load_dwordx4 v24, s[12:15], 0 offen offset:0 lds
    s_mov_b64 exec, s[36:37]
    v_mov_b64 v[140:141], v[124:125]
    v_mov_b64 v[142:143], v[126:127]
    v_mov_b64 v[144:145], v[128:129]
    v_mov_b64 v[146:147], v[130:131]
    s_mov_b64 exec, -1
    v_add_u32_dpp v25, v38, v3 row_newbcast:1 row_mask:0xf bank_mask:0x3
    v_add_u32_dpp v25, v38, v3 row_newbcast:9 row_mask:0xf bank_mask:0xc
    buffer_load_dwordx4 v25, s[24:27], 0 offen offset:1024 lds
    v_mfma_f32_16x16x32_bf16 v[80:83], v[116:119], v[124:127], 0
    v_mfma_f32_16x16x32_bf16 v[80:83], v[120:123], v[128:131], v[80:83]
    s_add_u32 m0, s81, 49152
    s_nop 0
    buffer_load_dwordx4 v30, s[16:19], s77 offen offset:2048 lds
    v_fmac_f32 v32, v72, v240
    v_fmac_f32 v33, v73, v241
    v_fmac_f32 v34, v74, v242
    v_fmac_f32 v35, v75, v243
    buffer_load_dwordx4 v31, s[16:19], s77 offen offset:3072 lds
    s_add_u32 s77, s77, 16384
    v_mfma_f32_16x16x32_bf16 v[72:75], v[124:127], v[140:143], 0
    v_mfma_f32_16x16x32_bf16 v[72:75], v[128:131], v[144:147], v[72:75]
    s_add_u32 m0, s80, 0
    v_add_u32_dpp v26, v40, v1 row_newbcast:3 row_mask:0xf bank_mask:0x3
    v_add_u32_dpp v26, v40, v1 row_newbcast:11 row_mask:0xf bank_mask:0xc
    buffer_load_dwordx4 v26, s[12:15], 0 offen offset:0 lds
    v_fmac_f32 v32, v76, v244
    v_fmac_f32 v33, v77, v245
    v_fmac_f32 v34, v78, v246
    v_fmac_f32 v35, v79, v247
    v_add_u32_dpp v27, v44, v1 row_newbcast:3 row_mask:0xf bank_mask:0x3
    v_add_u32_dpp v27, v44, v1 row_newbcast:11 row_mask:0xf bank_mask:0xc
    buffer_load_dwordx4 v27, s[28:31], 0 offen offset:2048 lds
    s_mov_b64 exec, s[36:37]
    v_mov_b64 v[132:133], v[84:85]
    v_mov_b64 v[134:135], v[86:87]
    v_mov_b64 v[136:137], v[88:89]
    v_mov_b64 v[138:139], v[90:91]
    s_mov_b64 exec, -1
    ds_read_b128 v[100:103], v4 offset:8192
    ds_read_b128 v[104:107], v5 offset:8192
    s_mov_b64 exec, s[64:65]
    ds_read_b128 v[148:151], v22 offset:8192
    ds_read_b128 v[152:155], v23 offset:8192
    s_mov_b64 exec, -1
    s_waitcnt vmcnt(22)
    s_barrier
    s_waitcnt lgkmcnt(0)
    s_add_u32 m0, s81, 0
    s_nop 0
    buffer_load_dwordx4 v28, s[16:19], s77 offen offset:0 lds
    v_mfma_f32_16x16x32_bf16 v[76:79], v[84:87], v[132:135], 0
    v_mfma_f32_16x16x32_bf16 v[76:79], v[88:91], v[136:139], v[76:79]
    buffer_load_dwordx4 v29, s[16:19], s77 offen offset:1024 lds
    v_fmac_f32 v32, v80, v248
    v_fmac_f32 v33, v81, v249
    v_fmac_f32 v34, v82, v250
    v_fmac_f32 v35, v83, v251
    s_add_u32 m0, s82, 8192
    v_add_u32_dpp v24, v38, v2 row_newbcast:2 row_mask:0xf bank_mask:0x3
    v_add_u32_dpp v24, v38, v2 row_newbcast:10 row_mask:0xf bank_mask:0xc
    buffer_load_dwordx4 v24, s[12:15], 0 offen offset:0 lds
    s_mov_b64 exec, s[36:37]
    v_mov_b64 v[132:133], v[92:93]
    v_mov_b64 v[134:135], v[94:95]
    v_mov_b64 v[136:137], v[96:97]
    v_mov_b64 v[138:139], v[98:99]
    s_mov_b64 exec, -1
    v_add_u32_dpp v25, v38, v3 row_newbcast:3 row_mask:0xf bank_mask:0x3
    v_add_u32_dpp v25, v38, v3 row_newbcast:11 row_mask:0xf bank_mask:0xc
    buffer_load_dwordx4 v25, s[24:27], 0 offen offset:1024 lds
    v_mfma_f32_16x16x32_bf16 v[80:83], v[84:87], v[92:95], 0
    v_mfma_f32_16x16x32_bf16 v[80:83], v[88:91], v[96:99], v[80:83]
    s_add_u32 m0, s81, 0
    s_nop 0
    buffer_load_dwordx4 v30, s[16:19], s77 offen offset:2048 lds
    v_fmac_f32 v32, v72, v252
    v_fmac_f32 v33, v73, v253
    v_fmac_f32 v34, v74, v254
    v_fmac_f32 v35, v75, v255
    v_add_f32 v12, v32, v33
    v_add_f32 v13, v34, v35
    v_add_f32 v12, v12, v13
    v_mfma_f32_16x16x32_bf16 v[72:75], v[92:95], v[132:135], 0
    v_mfma_f32_16x16x32_bf16 v[72:75], v[96:99], v[136:139], v[72:75]
    buffer_load_dwordx4 v31, s[16:19], s77 offen offset:3072 lds
    s_add_u32 s77, s77, 16384
    v_add_f32_dpp v12, v12, v12 row_shr:1 row_mask:0xf bank_mask:0xf bound_ctrl:0
    v_mul_f32 v32, v76, v164
    v_mul_f32 v33, v77, v165
    v_mul_f32 v34, v78, v166
    v_mul_f32 v35, v79, v167
    s_add_u32 m0, s80, 4096
    v_add_u32_dpp v26, v48, v1 row_newbcast:3 row_mask:0xf bank_mask:0x3
    v_add_u32_dpp v26, v48, v1 row_newbcast:11 row_mask:0xf bank_mask:0xc
    buffer_load_dwordx4 v26, s[12:15], 0 offen offset:0 lds
    v_add_f32_dpp v12, v12, v12 row_shr:2 row_mask:0xf bank_mask:0xf bound_ctrl:0
    v_mfma_f32_16x16x32_bf16 v[76:79], v[84:87], v[100:103], 0
    v_mfma_f32_16x16x32_bf16 v[76:79], v[88:91], v[104:107], v[76:79]
    v_add_u32_dpp v27, v52, v1 row_newbcast:3 row_mask:0xf bank_mask:0x3
    v_add_u32_dpp v27, v52, v1 row_newbcast:11 row_mask:0xf bank_mask:0xc
    buffer_load_dwordx4 v27, s[28:31], 0 offen offset:2048 lds
    v_add_f32_dpp v12, v12, v12 row_shr:4 row_mask:0xf bank_mask:0xf bound_ctrl:0
    v_fmac_f32 v32, v80, v168
    v_fmac_f32 v33, v81, v169
    v_fmac_f32 v34, v82, v170
    v_fmac_f32 v35, v83, v171
    v_add_f32_dpp v12, v12, v12 row_shr:8 row_mask:0xf bank_mask:0xf bound_ctrl:0
    ds_read_b128 v[108:111], v4 offset:0
    ds_read_b128 v[112:115], v5 offset:0
    s_mov_b64 exec, s[66:67]
    ds_read_b128 v[148:151], v22 offset:0
    ds_read_b128 v[152:155], v23 offset:0
    s_mov_b64 exec, -1
    s_waitcnt vmcnt(20)
    s_barrier
    s_waitcnt lgkmcnt(0)
    s_add_u32 m0, s81, 16384
    s_nop 0
    buffer_load_dwordx4 v28, s[16:19], s77 offen offset:0 lds
    s_mov_b64 exec, s[36:37]
    v_mov_b64 v[132:133], v[100:101]
    v_mov_b64 v[134:135], v[102:103]
    v_mov_b64 v[136:137], v[104:105]
    v_mov_b64 v[138:139], v[106:107]
    s_mov_b64 exec, -1
    buffer_load_dwordx4 v29, s[16:19], s77 offen offset:1024 lds
    v_add_f32_dpp v12, v12, v12 row_bcast:15 row_mask:0xa bank_mask:0xf
    v_mfma_f32_16x16x32_bf16 v[80:83], v[92:95], v[100:103], 0
    v_mfma_f32_16x16x32_bf16 v[80:83], v[96:99], v[104:107], v[80:83]
    s_add_u32 m0, s82, 0
    v_add_u32_dpp v24, v38, v2 row_newbcast:4 row_mask:0xf bank_mask:0x3
    v_add_u32_dpp v24, v38, v2 row_newbcast:12 row_mask:0xf bank_mask:0xc
    buffer_load_dwordx4 v24, s[12:15], 0 offen offset:0 lds
    v_add_f32_dpp v12, v12, v12 row_bcast:31 row_mask:0xc bank_mask:0xf
    v_fmac_f32 v32, v72, v172
    v_fmac_f32 v33, v73, v173
    v_fmac_f32 v34, v74, v174
    v_fmac_f32 v35, v75, v175
    v_add_u32_dpp v25, v38, v3 row_newbcast:5 row_mask:0xf bank_mask:0x3
    v_add_u32_dpp v25, v38, v3 row_newbcast:13 row_mask:0xf bank_mask:0xc
    buffer_load_dwordx4 v25, s[24:27], 0 offen offset:1024 lds
    v_readlane_b32 s38, v12, 63
    v_mfma_f32_16x16x32_bf16 v[72:75], v[84:87], v[108:111], 0
    v_mfma_f32_16x16x32_bf16 v[72:75], v[88:91], v[112:115], v[72:75]
    s_add_u32 m0, s81, 16384
    s_nop 0
    buffer_load_dwordx4 v30, s[16:19], s77 offen offset:2048 lds
    v_writelane_b32 v9, s38, 1
    v_fmac_f32 v32, v76, v176
    v_fmac_f32 v33, v77, v177
    v_fmac_f32 v34, v78, v178
    v_fmac_f32 v35, v79, v179
    v_mfma_f32_16x16x32_bf16 v[76:79], v[100:103], v[132:135], 0
    v_mfma_f32_16x16x32_bf16 v[76:79], v[104:107], v[136:139], v[76:79]
    buffer_load_dwordx4 v31, s[16:19], s77 offen offset:3072 lds
    s_add_u32 s77, s77, 16384
    v_fmac_f32 v32, v80, v180
    v_fmac_f32 v33, v81, v181
    v_fmac_f32 v34, v82, v182
    v_fmac_f32 v35, v83, v183
    s_add_u32 m0, s80, 16384
    v_add_u32_dpp v26, v41, v1 row_newbcast:3 row_mask:0xf bank_mask:0x3
    v_add_u32_dpp v26, v41, v1 row_newbcast:11 row_mask:0xf bank_mask:0xc
    buffer_load_dwordx4 v26, s[12:15], 0 offen offset:0 lds
    v_mfma_f32_16x16x32_bf16 v[80:83], v[92:95], v[108:111], 0
    v_mfma_f32_16x16x32_bf16 v[80:83], v[96:99], v[112:115], v[80:83]
    v_add_u32_dpp v27, v45, v1 row_newbcast:3 row_mask:0xf bank_mask:0x3
    v_add_u32_dpp v27, v45, v1 row_newbcast:11 row_mask:0xf bank_mask:0xc
    buffer_load_dwordx4 v27, s[28:31], 0 offen offset:2048 lds
    v_fmac_f32 v32, v72, v184
    v_fmac_f32 v33, v73, v185
    v_fmac_f32 v34, v74, v186
    v_fmac_f32 v35, v75, v187
    ds_read_b128 v[116:119], v4 offset:2048
    ds_read_b128 v[120:123], v5 offset:2048
    s_mov_b64 exec, s[60:61]
    ds_read_b128 v[156:159], v22 offset:2048
    ds_read_b128 v[160:163], v23 offset:2048
    s_mov_b64 exec, -1
    s_waitcnt vmcnt(18)
    s_barrier
    s_waitcnt lgkmcnt(0)
    s_add_u32 m0, s81, 32768
    s_nop 0
    buffer_load_dwordx4 v28, s[16:19], s77 offen offset:0 lds
    v_mfma_f32_16x16x32_bf16 v[72:75], v[148:151], v[148:151], 0
    v_mfma_f32_16x16x32_bf16 v[72:75], v[152:155], v[152:155], v[72:75]
    buffer_load_dwordx4 v29, s[16:19], s77 offen offset:1024 lds
    v_fmac_f32 v32, v76, v188
    v_fmac_f32 v33, v77, v189
    v_fmac_f32 v34, v78, v190
    v_fmac_f32 v35, v79, v191
    s_add_u32 m0, s82, 2048
    v_add_u32_dpp v24, v38, v2 row_newbcast:6 row_mask:0xf bank_mask:0x3
    v_add_u32_dpp v24, v38, v2 row_newbcast:14 row_mask:0xf bank_mask:0xc
    buffer_load_dwordx4 v24, s[12:15], 0 offen offset:0 lds
    v_mfma_f32_16x16x32_bf16 v[76:79], v[84:87], v[116:119], 0
    v_mfma_f32_16x16x32_bf16 v[76:79], v[88:91], v[120:123], v[76:79]
    v_add_u32_dpp v25, v38, v3 row_newbcast:7 row_mask:0xf bank_mask:0x3
    v_add_u32_dpp v25, v38, v3 row_newbcast:15 row_mask:0xf bank_mask:0xc
    buffer_load_dwordx4 v25, s[24:27], 0 offen offset:1024 lds
    v_fmac_f32 v32, v80, v192
    v_fmac_f32 v33, v81, v193
    v_fmac_f32 v34, v82, v194
    v_fmac_f32 v35, v83, v195
    s_add_u32 m0, s81, 32768
    s_nop 0
    buffer_load_dwordx4 v30, s[16:19], s77 offen offset:2048 lds
    s_mov_b64 exec, s[36:37]
    v_mov_b64 v[132:133], v[108:109]
    v_mov_b64 v[134:135], v[110:111]
    v_mov_b64 v[136:137], v[112:113]
    v_mov_b64 v[138:139], v[114:115]
    s_mov_b64 exec, -1
    buffer_load_dwordx4 v31, s[16:19], s77 offen offset:3072 lds
    s_add_u32 s77, s77, 16384
    v_mfma_f32_16x16x32_bf16 v[80:83], v[100:103], v[108:111], 0
    v_mfma_f32_16x16x32_bf16 v[80:83], v[104:107], v[112:115], v[80:83]
    s_add_u32 m0, s80, 20480
    v_add_u32_dpp v26, v49, v1 row_newbcast:3 row_mask:0xf bank_mask:0x3
    v_add_u32_dpp v26, v49, v1 row_newbcast:11 row_mask:0xf bank_mask:0xc
    buffer_load_dwordx4 v26, s[12:15], 0 offen offset:0 lds
    v_fmac_f32 v32, v72, v196
    v_fmac_f32 v33, v73, v197
    v_fmac_f32 v34, v74, v198
    v_fmac_f32 v35, v75, v199
    v_add_u32_dpp v27, v53, v1 row_newbcast:3 row_mask:0xf bank_mask:0x3
    v_add_u32_dpp v27, v53, v1 row_newbcast:11 row_mask:0xf bank_mask:0xc
    buffer_load_dwordx4 v27, s[28:31], 0 offen offset:2048 lds
    v_mfma_f32_16x16x32_bf16 v[72:75], v[92:95], v[116:119], 0
    v_mfma_f32_16x16x32_bf16 v[72:75], v[96:99], v[120:123], v[72:75]
    s_add_u32 m0, s82, 10240
    v_add_u32_dpp v24, v39, v2 row_newbcast:4 row_mask:0xf bank_mask:0x3
    v_add_u32_dpp v24, v39, v2 row_newbcast:12 row_mask:0xf bank_mask:0xc
    s_mov_b32 exec_hi, 0
    buffer_load_dwordx4 v24, s[12:15], 0 offen offset:0 lds
    s_mov_b32 exec_hi, -1
    v_fmac_f32 v32, v76, v200
    v_fmac_f32 v33, v77, v201
    v_fmac_f32 v34, v78, v202
    v_fmac_f32 v35, v79, v203
    ds_read_b128 v[124:127], v4 offset:4096
    ds_read_b128 v[128:131], v5 offset:4096
    s_mov_b64 exec, s[62:63]
    ds_read_b128 v[156:159], v22 offset:4096
    ds_read_b128 v[160:163], v23 offset:4096
    s_mov_b64 exec, -1
    s_waitcnt vmcnt(17)
    s_barrier
    s_waitcnt lgkmcnt(0)
    s_add_u32 m0, s81, 49152
    s_nop 0
    buffer_load_dwordx4 v28, s[16:19], s77 offen offset:0 lds
    v_mfma_f32_16x16x32_bf16 v[76:79], v[84:87], v[124:127], 0
    v_mfma_f32_16x16x32_bf16 v[76:79], v[88:91], v[128:131], v[76:79]
    buffer_load_dwordx4 v29, s[16:19], s77 offen offset:1024 lds
    v_fmac_f32 v32, v80, v204
    v_fmac_f32 v33, v81, v205
    v_fmac_f32 v34, v82, v206
    v_fmac_f32 v35, v83, v207
    s_add_u32 m0, s82, 4096
    v_add_u32_dpp v25, v39, v2 row_newbcast:0 row_mask:0xf bank_mask:0x3
    v_add_u32_dpp v25, v39, v2 row_newbcast:8 row_mask:0xf bank_mask:0xc
    buffer_load_dwordx4 v25, s[12:15], 0 offen offset:0 lds
    v_mfma_f32_16x16x32_bf16 v[80:83], v[108:111], v[132:135], 0
    v_mfma_f32_16x16x32_bf16 v[80:83], v[112:115], v[136:139], v[80:83]
    v_add_u32_dpp v26, v39, v3 row_newbcast:1 row_mask:0xf bank_mask:0x3
    v_add_u32_dpp v26, v39, v3 row_newbcast:9 row_mask:0xf bank_mask:0xc
    buffer_load_dwordx4 v26, s[24:27], 0 offen offset:1024 lds
    v_fmac_f32 v32, v72, v208
    v_fmac_f32 v33, v73, v209
    v_fmac_f32 v34, v74, v210
    v_fmac_f32 v35, v75, v211
    s_add_u32 m0, s81, 49152
    s_nop 0
    buffer_load_dwordx4 v30, s[16:19], s77 offen offset:2048 lds
    v_mfma_f32_16x16x32_bf16 v[72:75], v[92:95], v[124:127], 0
    v_mfma_f32_16x16x32_bf16 v[72:75], v[96:99], v[128:131], v[72:75]
    buffer_load_dwordx4 v31, s[16:19], s77 offen offset:3072 lds
    s_add_u32 s77, s77, 16384
    v_fmac_f32 v32, v76, v212
    v_fmac_f32 v33, v77, v213
    v_fmac_f32 v34, v78, v214
    v_fmac_f32 v35, v79, v215
    s_add_u32 m0, s80, 32768
    v_add_u32_dpp v27, v42, v1 row_newbcast:3 row_mask:0xf bank_mask:0x3
    v_add_u32_dpp v27, v42, v1 row_newbcast:11 row_mask:0xf bank_mask:0xc
    buffer_load_dwordx4 v27, s[12:15], 0 offen offset:0 lds
    v_mfma_f32_16x16x32_bf16 v[76:79], v[156:159], v[156:159], 0
    v_mfma_f32_16x16x32_bf16 v[76:79], v[160:163], v[160:163], v[76:79]
    v_add_u32_dpp v24, v46, v1 row_newbcast:3 row_mask:0xf bank_mask:0x3
    v_add_u32_dpp v24, v46, v1 row_newbcast:11 row_mask:0xf bank_mask:0xc
    buffer_load_dwordx4 v24, s[28:31], 0 offen offset:2048 lds
    v_fmac_f32 v32, v80, v216
    v_fmac_f32 v33, v81, v217
    v_fmac_f32 v34, v82, v218
    v_fmac_f32 v35, v83, v219
    ds_read_b128 v[84:87], v4 offset:6144
    ds_read_b128 v[88:91], v5 offset:6144
    s_mov_b64 exec, s[60:61]
    ds_read_b128 v[148:151], v22 offset:6144
    ds_read_b128 v[152:155], v23 offset:6144
    s_mov_b64 exec, -1
    s_waitcnt vmcnt(8)
    s_mov_b64 exec, s[60:61]
    ds_read_b128 v[140:143], v4 offset:10240
    ds_read_b128 v[144:147], v5 offset:10240
    s_mov_b64 exec, s[64:65]
    ds_read_b128 v[156:159], v22 offset:10240
    ds_read_b128 v[160:163], v23 offset:10240
    s_mov_b64 exec, -1
    s_barrier
    s_waitcnt lgkmcnt(0)
    s_add_u32 m0, s81, 0
    s_nop 0
    buffer_load_dwordx4 v28, s[16:19], s77 offen offset:0 lds
    v_mfma_f32_16x16x32_bf16 v[80:83], v[100:103], v[116:119], 0
    v_mfma_f32_16x16x32_bf16 v[80:83], v[104:107], v[120:123], v[80:83]
    buffer_load_dwordx4 v29, s[16:19], s77 offen offset:1024 lds
    v_fmac_f32 v32, v72, v220
    v_fmac_f32 v33, v73, v221
    v_fmac_f32 v34, v74, v222
    v_fmac_f32 v35, v75, v223
    s_add_u32 m0, s82, 6144
    v_add_u32_dpp v25, v39, v2 row_newbcast:2 row_mask:0xf bank_mask:0x3
    v_add_u32_dpp v25, v39, v2 row_newbcast:10 row_mask:0xf bank_mask:0xc
    buffer_load_dwordx4 v25, s[12:15], 0 offen offset:0 lds
    s_mov_b64 exec, s[36:37]
    v_mov_b64 v[132:133], v[116:117]
    v_mov_b64 v[134:135], v[118:119]
    v_mov_b64 v[136:137], v[120:121]
    v_mov_b64 v[138:139], v[122:123]
    s_mov_b64 exec, -1
    v_add_u32_dpp v26, v39, v3 row_newbcast:3 row_mask:0xf bank_mask:0x3
    v_add_u32_dpp v26, v39, v3 row_newbcast:11 row_mask:0xf bank_mask:0xc
    buffer_load_dwordx4 v26, s[24:27], 0 offen offset:1024 lds
    v_mfma_f32_16x16x32_bf16 v[72:75], v[108:111], v[116:119], 0
    v_mfma_f32_16x16x32_bf16 v[72:75], v[112:115], v[120:123], v[72:75]
    s_add_u32 m0, s81, 0
    s_nop 0
    buffer_load_dwordx4 v30, s[16:19], s77 offen offset:2048 lds
    v_fmac_f32 v32, v76, v224
    v_fmac_f32 v33, v77, v225
    v_fmac_f32 v34, v78, v226
    v_fmac_f32 v35, v79, v227
    buffer_load_dwordx4 v31, s[16:19], s77 offen offset:3072 lds
    s_add_u32 s77, s77, 16384
    v_mfma_f32_16x16x32_bf16 v[76:79], v[100:103], v[124:127], 0
    v_mfma_f32_16x16x32_bf16 v[76:79], v[104:107], v[128:131], v[76:79]
    s_add_u32 m0, s80, 36864
    v_add_u32_dpp v27, v50, v1 row_newbcast:3 row_mask:0xf bank_mask:0x3
    v_add_u32_dpp v27, v50, v1 row_newbcast:11 row_mask:0xf bank_mask:0xc
    buffer_load_dwordx4 v27, s[12:15], 0 offen offset:0 lds
    v_fmac_f32 v32, v80, v228
    v_fmac_f32 v33, v81, v229
    v_fmac_f32 v34, v82, v230
    v_fmac_f32 v35, v83, v231
    v_add_u32_dpp v24, v54, v1 row_newbcast:3 row_mask:0xf bank_mask:0x3
    v_add_u32_dpp v24, v54, v1 row_newbcast:11 row_mask:0xf bank_mask:0xc
    buffer_load_dwordx4 v24, s[28:31], 0 offen offset:2048 lds
    v_mfma_f32_16x16x32_bf16 v[80:83], v[116:119], v[132:135], 0
    v_mfma_f32_16x16x32_bf16 v[80:83], v[120:123], v[136:139], v[80:83]
    s_movk_i32 s74, 8000
    buffer_load_dword v38, v8, s[8:11], s74 offen
    buffer_load_dword v39, v8, s[8:11], s74 offen offset:256
    v_fmac_f32 v32, v72, v232
    v_fmac_f32 v33, v73, v233
    v_fmac_f32 v34, v74, v234
    v_fmac_f32 v35, v75, v235
    ds_read_b128 v[92:95], v4 offset:8192
    ds_read_b128 v[96:99], v5 offset:8192
    s_mov_b64 exec, s[62:63]
    ds_read_b128 v[148:151], v22 offset:8192
    ds_read_b128 v[152:155], v23 offset:8192
    s_mov_b64 exec, -1
    s_barrier
    s_waitcnt lgkmcnt(0)
    s_add_u32 m0, s81, 16384
    s_nop 0
    buffer_load_dwordx4 v28, s[16:19], s77 offen offset:0 lds
    v_mfma_f32_16x16x32_bf16 v[72:75], v[108:111], v[124:127], 0
    v_mfma_f32_16x16x32_bf16 v[72:75], v[112:115], v[128:131], v[72:75]
    buffer_load_dwordx4 v29, s[16:19], s77 offen offset:1024 lds
    v_fmac_f32 v32, v76, v236
    v_fmac_f32 v33, v77, v237
    v_fmac_f32 v34, v78, v238
    v_fmac_f32 v35, v79, v239
    v_lshlrev_b32 v36, 7, v36
    v_lshlrev_b32 v37, 7, v37
    s_nop 0
    s_add_u32 m0, s82, 8192
    v_add_u32_dpp v25, v36, v2 row_newbcast:0 row_mask:0xf bank_mask:0x3
    v_add_u32_dpp v25, v36, v2 row_newbcast:8 row_mask:0xf bank_mask:0xc
    buffer_load_dwordx4 v25, s[12:15], 0 offen offset:0 lds
    s_mov_b64 exec, s[36:37]
    v_mov_b64 v[132:133], v[124:125]
    v_mov_b64 v[134:135], v[126:127]
    v_mov_b64 v[136:137], v[128:129]
    v_mov_b64 v[138:139], v[130:131]
    s_mov_b64 exec, -1
    v_add_u32_dpp v26, v36, v3 row_newbcast:1 row_mask:0xf bank_mask:0x3
    v_add_u32_dpp v26, v36, v3 row_newbcast:9 row_mask:0xf bank_mask:0xc
    buffer_load_dwordx4 v26, s[24:27], 0 offen offset:1024 lds
    v_mfma_f32_16x16x32_bf16 v[76:79], v[116:119], v[124:127], 0
    v_mfma_f32_16x16x32_bf16 v[76:79], v[120:123], v[128:131], v[76:79]
    s_add_u32 m0, s81, 16384
    s_nop 0
    buffer_load_dwordx4 v30, s[16:19], s77 offen offset:2048 lds
    v_fmac_f32 v32, v80, v240
    v_fmac_f32 v33, v81, v241
    v_fmac_f32 v34, v82, v242
    v_fmac_f32 v35, v83, v243
    buffer_load_dwordx4 v31, s[16:19], s77 offen offset:3072 lds
    s_add_u32 s77, s77, 16384
    v_mfma_f32_16x16x32_bf16 v[80:83], v[124:127], v[132:135], 0
    v_mfma_f32_16x16x32_bf16 v[80:83], v[128:131], v[136:139], v[80:83]
    s_add_u32 m0, s80, 0
    v_add_u32_dpp v27, v43, v1 row_newbcast:3 row_mask:0xf bank_mask:0x3
    v_add_u32_dpp v27, v43, v1 row_newbcast:11 row_mask:0xf bank_mask:0xc
    buffer_load_dwordx4 v27, s[12:15], 0 offen offset:0 lds
    v_fmac_f32 v32, v72, v244
    v_fmac_f32 v33, v73, v245
    v_fmac_f32 v34, v74, v246
    v_fmac_f32 v35, v75, v247
    v_add_u32_dpp v24, v47, v1 row_newbcast:3 row_mask:0xf bank_mask:0x3
    v_add_u32_dpp v24, v47, v1 row_newbcast:11 row_mask:0xf bank_mask:0xc
    buffer_load_dwordx4 v24, s[28:31], 0 offen offset:2048 lds
    s_mov_b64 exec, s[36:37]
    v_mov_b64 v[140:141], v[84:85]
    v_mov_b64 v[142:143], v[86:87]
    v_mov_b64 v[144:145], v[88:89]
    v_mov_b64 v[146:147], v[90:91]
    s_mov_b64 exec, -1
    ds_read_b128 v[100:103], v4 offset:0
    ds_read_b128 v[104:107], v5 offset:0
    s_mov_b64 exec, s[64:65]
    ds_read_b128 v[148:151], v22 offset:0
    ds_read_b128 v[152:155], v23 offset:0
    s_mov_b64 exec, -1
    s_waitcnt vmcnt(20)
    s_barrier
    s_waitcnt lgkmcnt(0)
    s_add_u32 m0, s81, 32768
    s_nop 0
    buffer_load_dwordx4 v28, s[16:19], s77 offen offset:0 lds
    v_mfma_f32_16x16x32_bf16 v[72:75], v[84:87], v[140:143], 0
    v_mfma_f32_16x16x32_bf16 v[72:75], v[88:91], v[144:147], v[72:75]
    buffer_load_dwordx4 v29, s[16:19], s77 offen offset:1024 lds
    v_fmac_f32 v32, v76, v248
    v_fmac_f32 v33, v77, v249
    v_fmac_f32 v34, v78, v250
    v_fmac_f32 v35, v79, v251
    s_add_u32 m0, s82, 0
    v_add_u32_dpp v25, v36, v2 row_newbcast:2 row_mask:0xf bank_mask:0x3
    v_add_u32_dpp v25, v36, v2 row_newbcast:10 row_mask:0xf bank_mask:0xc
    buffer_load_dwordx4 v25, s[12:15], 0 offen offset:0 lds
    s_mov_b64 exec, s[36:37]
    v_mov_b64 v[140:141], v[92:93]
    v_mov_b64 v[142:143], v[94:95]
    v_mov_b64 v[144:145], v[96:97]
    v_mov_b64 v[146:147], v[98:99]
    s_mov_b64 exec, -1
    v_add_u32_dpp v26, v36, v3 row_newbcast:3 row_mask:0xf bank_mask:0x3
    v_add_u32_dpp v26, v36, v3 row_newbcast:11 row_mask:0xf bank_mask:0xc
    buffer_load_dwordx4 v26, s[24:27], 0 offen offset:1024 lds
    v_mfma_f32_16x16x32_bf16 v[76:79], v[84:87], v[92:95], 0
    v_mfma_f32_16x16x32_bf16 v[76:79], v[88:91], v[96:99], v[76:79]
    s_add_u32 m0, s81, 32768
    s_nop 0
    buffer_load_dwordx4 v30, s[16:19], s77 offen offset:2048 lds
    v_fmac_f32 v32, v80, v252
    v_fmac_f32 v33, v81, v253
    v_fmac_f32 v34, v82, v254
    v_fmac_f32 v35, v83, v255
    v_add_f32 v12, v32, v33
    v_add_f32 v13, v34, v35
    v_add_f32 v12, v12, v13
    v_mfma_f32_16x16x32_bf16 v[80:83], v[92:95], v[140:143], 0
    v_mfma_f32_16x16x32_bf16 v[80:83], v[96:99], v[144:147], v[80:83]
    buffer_load_dwordx4 v31, s[16:19], s77 offen offset:3072 lds
    s_add_u32 s77, s77, 16384
    v_add_f32_dpp v12, v12, v12 row_shr:1 row_mask:0xf bank_mask:0xf bound_ctrl:0
    v_mul_f32 v32, v72, v164
    v_mul_f32 v33, v73, v165
    v_mul_f32 v34, v74, v166
    v_mul_f32 v35, v75, v167
    s_add_u32 m0, s80, 4096
    v_add_u32_dpp v27, v51, v1 row_newbcast:3 row_mask:0xf bank_mask:0x3
    v_add_u32_dpp v27, v51, v1 row_newbcast:11 row_mask:0xf bank_mask:0xc
    buffer_load_dwordx4 v27, s[12:15], 0 offen offset:0 lds
    v_add_f32_dpp v12, v12, v12 row_shr:2 row_mask:0xf bank_mask:0xf bound_ctrl:0
    v_mfma_f32_16x16x32_bf16 v[72:75], v[84:87], v[100:103], 0
    v_mfma_f32_16x16x32_bf16 v[72:75], v[88:91], v[104:107], v[72:75]
    v_add_u32_dpp v24, v55, v1 row_newbcast:3 row_mask:0xf bank_mask:0x3
    v_add_u32_dpp v24, v55, v1 row_newbcast:11 row_mask:0xf bank_mask:0xc
    buffer_load_dwordx4 v24, s[28:31], 0 offen offset:2048 lds
    v_add_f32_dpp v12, v12, v12 row_shr:4 row_mask:0xf bank_mask:0xf bound_ctrl:0
    v_fmac_f32 v32, v76, v168
    v_fmac_f32 v33, v77, v169
    v_fmac_f32 v34, v78, v170
    v_fmac_f32 v35, v79, v171
    v_add_f32_dpp v12, v12, v12 row_shr:8 row_mask:0xf bank_mask:0xf bound_ctrl:0
    ds_read_b128 v[108:111], v4 offset:2048
    ds_read_b128 v[112:115], v5 offset:2048
    s_mov_b64 exec, s[66:67]
    ds_read_b128 v[148:151], v22 offset:2048
    ds_read_b128 v[152:155], v23 offset:2048
    s_mov_b64 exec, -1
    s_waitcnt vmcnt(18)
    s_barrier
    s_waitcnt lgkmcnt(0)
    s_add_u32 m0, s81, 49152
    s_nop 0
    buffer_load_dwordx4 v28, s[16:19], s77 offen offset:0 lds
    s_mov_b64 exec, s[36:37]
    v_mov_b64 v[140:141], v[100:101]
    v_mov_b64 v[142:143], v[102:103]
    v_mov_b64 v[144:145], v[104:105]
    v_mov_b64 v[146:147], v[106:107]
    s_mov_b64 exec, -1
    buffer_load_dwordx4 v29, s[16:19], s77 offen offset:1024 lds
    v_add_f32_dpp v12, v12, v12 row_bcast:15 row_mask:0xa bank_mask:0xf
    v_mfma_f32_16x16x32_bf16 v[76:79], v[92:95], v[100:103], 0
    v_mfma_f32_16x16x32_bf16 v[76:79], v[96:99], v[104:107], v[76:79]
    s_add_u32 m0, s82, 2048
    v_add_u32_dpp v25, v36, v2 row_newbcast:4 row_mask:0xf bank_mask:0x3
    v_add_u32_dpp v25, v36, v2 row_newbcast:12 row_mask:0xf bank_mask:0xc
    buffer_load_dwordx4 v25, s[12:15], 0 offen offset:0 lds
    v_add_f32_dpp v12, v12, v12 row_bcast:31 row_mask:0xc bank_mask:0xf
    v_fmac_f32 v32, v80, v172
    v_fmac_f32 v33, v81, v173
    v_fmac_f32 v34, v82, v174
    v_fmac_f32 v35, v83, v175
    v_add_u32_dpp v26, v36, v3 row_newbcast:5 row_mask:0xf bank_mask:0x3
    v_add_u32_dpp v26, v36, v3 row_newbcast:13 row_mask:0xf bank_mask:0xc
    buffer_load_dwordx4 v26, s[24:27], 0 offen offset:1024 lds
    v_readlane_b32 s38, v12, 63
    v_mfma_f32_16x16x32_bf16 v[80:83], v[84:87], v[108:111], 0
    v_mfma_f32_16x16x32_bf16 v[80:83], v[88:91], v[112:115], v[80:83]
    s_add_u32 m0, s81, 49152
    s_nop 0
    buffer_load_dwordx4 v30, s[16:19], s77 offen offset:2048 lds
    v_writelane_b32 v9, s38, 2
    v_fmac_f32 v32, v72, v176
    v_fmac_f32 v33, v73, v177
    v_fmac_f32 v34, v74, v178
    v_fmac_f32 v35, v75, v179
    v_mfma_f32_16x16x32_bf16 v[72:75], v[100:103], v[140:143], 0
    v_mfma_f32_16x16x32_bf16 v[72:75], v[104:107], v[144:147], v[72:75]
    buffer_load_dwordx4 v31, s[16:19], s77 offen offset:3072 lds
    s_add_u32 s77, s77, 16384
    v_fmac_f32 v32, v76, v180
    v_fmac_f32 v33, v77, v181
    v_fmac_f32 v34, v78, v182
    v_fmac_f32 v35, v79, v183
    s_add_u32 m0, s80, 16384
    v_add_u32_dpp v27, v40, v1 row_newbcast:4 row_mask:0xf bank_mask:0x3
    v_add_u32_dpp v27, v40, v1 row_newbcast:12 row_mask:0xf bank_mask:0xc
    buffer_load_dwordx4 v27, s[12:15], 0 offen offset:0 lds
    v_mfma_f32_16x16x32_bf16 v[76:79], v[92:95], v[108:111], 0
    v_mfma_f32_16x16x32_bf16 v[76:79], v[96:99], v[112:115], v[76:79]
    v_add_u32_dpp v24, v44, v1 row_newbcast:4 row_mask:0xf bank_mask:0x3
    v_add_u32_dpp v24, v44, v1 row_newbcast:12 row_mask:0xf bank_mask:0xc
    buffer_load_dwordx4 v24, s[28:31], 0 offen offset:2048 lds
    v_fmac_f32 v32, v80, v184
    v_fmac_f32 v33, v81, v185
    v_fmac_f32 v34, v82, v186
    v_fmac_f32 v35, v83, v187
    ds_read_b128 v[116:119], v4 offset:4096
    ds_read_b128 v[120:123], v5 offset:4096
    s_mov_b64 exec, s[60:61]
    ds_read_b128 v[156:159], v22 offset:4096
    ds_read_b128 v[160:163], v23 offset:4096
    s_mov_b64 exec, -1
    s_waitcnt vmcnt(18)
    s_barrier
    s_waitcnt lgkmcnt(0)
    s_add_u32 m0, s81, 0
    s_nop 0
    buffer_load_dwordx4 v28, s[16:19], s77 offen offset:0 lds
    v_mfma_f32_16x16x32_bf16 v[80:83], v[148:151], v[148:151], 0
    v_mfma_f32_16x16x32_bf16 v[80:83], v[152:155], v[152:155], v[80:83]
    buffer_load_dwordx4 v29, s[16:19], s77 offen offset:1024 lds
    v_fmac_f32 v32, v72, v188
    v_fmac_f32 v33, v73, v189
    v_fmac_f32 v34, v74, v190
    v_fmac_f32 v35, v75, v191
    s_add_u32 m0, s82, 4096
    v_add_u32_dpp v25, v36, v2 row_newbcast:6 row_mask:0xf bank_mask:0x3
    v_add_u32_dpp v25, v36, v2 row_newbcast:14 row_mask:0xf bank_mask:0xc
    buffer_load_dwordx4 v25, s[12:15], 0 offen offset:0 lds
    v_mfma_f32_16x16x32_bf16 v[72:75], v[84:87], v[116:119], 0
    v_mfma_f32_16x16x32_bf16 v[72:75], v[88:91], v[120:123], v[72:75]
    v_add_u32_dpp v26, v36, v3 row_newbcast:7 row_mask:0xf bank_mask:0x3
    v_add_u32_dpp v26, v36, v3 row_newbcast:15 row_mask:0xf bank_mask:0xc
    buffer_load_dwordx4 v26, s[24:27], 0 offen offset:1024 lds
    v_fmac_f32 v32, v76, v192
    v_fmac_f32 v33, v77, v193
    v_fmac_f32 v34, v78, v194
    v_fmac_f32 v35, v79, v195
    s_add_u32 m0, s81, 0
    s_nop 0
    buffer_load_dwordx4 v30, s[16:19], s77 offen offset:2048 lds
    s_mov_b64 exec, s[36:37]
    v_mov_b64 v[140:141], v[108:109]
    v_mov_b64 v[142:143], v[110:111]
    v_mov_b64 v[144:145], v[112:113]
    v_mov_b64 v[146:147], v[114:115]
    s_mov_b64 exec, -1
    buffer_load_dwordx4 v31, s[16:19], s77 offen offset:3072 lds
    s_add_u32 s77, s77, 16384
    v_mfma_f32_16x16x32_bf16 v[76:79], v[100:103], v[108:111], 0
    v_mfma_f32_16x16x32_bf16 v[76:79], v[104:107], v[112:115], v[76:79]
    s_add_u32 m0, s80, 20480
    v_add_u32_dpp v27, v48, v1 row_newbcast:4 row_mask:0xf bank_mask:0x3
    v_add_u32_dpp v27, v48, v1 row_newbcast:12 row_mask:0xf bank_mask:0xc
    buffer_load_dwordx4 v27, s[12:15], 0 offen offset:0 lds
    v_fmac_f32 v32, v80, v196
    v_fmac_f32 v33, v81, v197
    v_fmac_f32 v34, v82, v198
    v_fmac_f32 v35, v83, v199
    v_add_u32_dpp v24, v52, v1 row_newbcast:4 row_mask:0xf bank_mask:0x3
    v_add_u32_dpp v24, v52, v1 row_newbcast:12 row_mask:0xf bank_mask:0xc
    buffer_load_dwordx4 v24, s[28:31], 0 offen offset:2048 lds
    v_mfma_f32_16x16x32_bf16 v[80:83], v[92:95], v[116:119], 0
    v_mfma_f32_16x16x32_bf16 v[80:83], v[96:99], v[120:123], v[80:83]
    s_add_u32 m0, s82, 10240
    v_add_u32_dpp v25, v37, v2 row_newbcast:4 row_mask:0xf bank_mask:0x3
    v_add_u32_dpp v25, v37, v2 row_newbcast:12 row_mask:0xf bank_mask:0xc
    s_mov_b32 exec_hi, 0
    buffer_load_dwordx4 v25, s[12:15], 0 offen offset:0 lds
    s_mov_b32 exec_hi, -1
    v_fmac_f32 v32, v72, v200
    v_fmac_f32 v33, v73, v201
    v_fmac_f32 v34, v74, v202
    v_fmac_f32 v35, v75, v203
    ds_read_b128 v[124:127], v4 offset:6144
    ds_read_b128 v[128:131], v5 offset:6144
    s_mov_b64 exec, s[62:63]
    ds_read_b128 v[156:159], v22 offset:6144
    ds_read_b128 v[160:163], v23 offset:6144
    s_mov_b64 exec, -1
    s_waitcnt vmcnt(17)
    s_barrier
    s_waitcnt lgkmcnt(0)
    s_add_u32 m0, s81, 16384
    s_nop 0
    buffer_load_dwordx4 v28, s[16:19], s77 offen offset:0 lds
    v_mfma_f32_16x16x32_bf16 v[72:75], v[84:87], v[124:127], 0
    v_mfma_f32_16x16x32_bf16 v[72:75], v[88:91], v[128:131], v[72:75]
    buffer_load_dwordx4 v29, s[16:19], s77 offen offset:1024 lds
    v_fmac_f32 v32, v76, v204
    v_fmac_f32 v33, v77, v205
    v_fmac_f32 v34, v78, v206
    v_fmac_f32 v35, v79, v207
    s_add_u32 m0, s82, 6144
    v_add_u32_dpp v26, v37, v2 row_newbcast:0 row_mask:0xf bank_mask:0x3
    v_add_u32_dpp v26, v37, v2 row_newbcast:8 row_mask:0xf bank_mask:0xc
    buffer_load_dwordx4 v26, s[12:15], 0 offen offset:0 lds
    v_mfma_f32_16x16x32_bf16 v[76:79], v[108:111], v[140:143], 0
    v_mfma_f32_16x16x32_bf16 v[76:79], v[112:115], v[144:147], v[76:79]
    v_add_u32_dpp v27, v37, v3 row_newbcast:1 row_mask:0xf bank_mask:0x3
    v_add_u32_dpp v27, v37, v3 row_newbcast:9 row_mask:0xf bank_mask:0xc
    buffer_load_dwordx4 v27, s[24:27], 0 offen offset:1024 lds
    v_fmac_f32 v32, v80, v208
    v_fmac_f32 v33, v81, v209
    v_fmac_f32 v34, v82, v210
    v_fmac_f32 v35, v83, v211
    s_add_u32 m0, s81, 16384
    s_nop 0
    buffer_load_dwordx4 v30, s[16:19], s77 offen offset:2048 lds
    v_mfma_f32_16x16x32_bf16 v[80:83], v[92:95], v[124:127], 0
    v_mfma_f32_16x16x32_bf16 v[80:83], v[96:99], v[128:131], v[80:83]
    buffer_load_dwordx4 v31, s[16:19], s77 offen offset:3072 lds
    s_add_u32 s77, s77, 16384
    v_fmac_f32 v32, v72, v212
    v_fmac_f32 v33, v73, v213
    v_fmac_f32 v34, v74, v214
    v_fmac_f32 v35, v75, v215
    s_add_u32 m0, s80, 32768
    v_add_u32_dpp v24, v41, v1 row_newbcast:4 row_mask:0xf bank_mask:0x3
    v_add_u32_dpp v24, v41, v1 row_newbcast:12 row_mask:0xf bank_mask:0xc
    buffer_load_dwordx4 v24, s[12:15], 0 offen offset:0 lds
    v_mfma_f32_16x16x32_bf16 v[72:75], v[156:159], v[156:159], 0
    v_mfma_f32_16x16x32_bf16 v[72:75], v[160:163], v[160:163], v[72:75]
    v_add_u32_dpp v25, v45, v1 row_newbcast:4 row_mask:0xf bank_mask:0x3
    v_add_u32_dpp v25, v45, v1 row_newbcast:12 row_mask:0xf bank_mask:0xc
    buffer_load_dwordx4 v25, s[28:31], 0 offen offset:2048 lds
    v_fmac_f32 v32, v76, v216
    v_fmac_f32 v33, v77, v217
    v_fmac_f32 v34, v78, v218
    v_fmac_f32 v35, v79, v219
    ds_read_b128 v[84:87], v4 offset:8192
    ds_read_b128 v[88:91], v5 offset:8192
    s_mov_b64 exec, s[60:61]
    ds_read_b128 v[148:151], v22 offset:8192
    ds_read_b128 v[152:155], v23 offset:8192
    s_mov_b64 exec, -1
    s_waitcnt vmcnt(8)
    s_mov_b64 exec, s[60:61]
    ds_read_b128 v[132:135], v4 offset:10240
    ds_read_b128 v[136:139], v5 offset:10240
    s_mov_b64 exec, s[64:65]
    ds_read_b128 v[156:159], v22 offset:10240
    ds_read_b128 v[160:163], v23 offset:10240
    s_mov_b64 exec, -1
    s_barrier
    s_waitcnt lgkmcnt(0)
    s_add_u32 m0, s81, 32768
    s_nop 0
    buffer_load_dwordx4 v28, s[16:19], s77 offen offset:0 lds
    v_mfma_f32_16x16x32_bf16 v[76:79], v[100:103], v[116:119], 0
    v_mfma_f32_16x16x32_bf16 v[76:79], v[104:107], v[120:123], v[76:79]
    buffer_load_dwordx4 v29, s[16:19], s77 offen offset:1024 lds
    v_fmac_f32 v32, v80, v220
    v_fmac_f32 v33, v81, v221
    v_fmac_f32 v34, v82, v222
    v_fmac_f32 v35, v83, v223
    s_add_u32 m0, s82, 8192
    v_add_u32_dpp v26, v37, v2 row_newbcast:2 row_mask:0xf bank_mask:0x3
    v_add_u32_dpp v26, v37, v2 row_newbcast:10 row_mask:0xf bank_mask:0xc
    buffer_load_dwordx4 v26, s[12:15], 0 offen offset:0 lds
    s_mov_b64 exec, s[36:37]
    v_mov_b64 v[140:141], v[116:117]
    v_mov_b64 v[142:143], v[118:119]
    v_mov_b64 v[144:145], v[120:121]
    v_mov_b64 v[146:147], v[122:123]
    s_mov_b64 exec, -1
    v_add_u32_dpp v27, v37, v3 row_newbcast:3 row_mask:0xf bank_mask:0x3
    v_add_u32_dpp v27, v37, v3 row_newbcast:11 row_mask:0xf bank_mask:0xc
    buffer_load_dwordx4 v27, s[24:27], 0 offen offset:1024 lds
    v_mfma_f32_16x16x32_bf16 v[80:83], v[108:111], v[116:119], 0
    v_mfma_f32_16x16x32_bf16 v[80:83], v[112:115], v[120:123], v[80:83]
    s_add_u32 m0, s81, 32768
    s_nop 0
    buffer_load_dwordx4 v30, s[16:19], s77 offen offset:2048 lds
    v_fmac_f32 v32, v72, v224
    v_fmac_f32 v33, v73, v225
    v_fmac_f32 v34, v74, v226
    v_fmac_f32 v35, v75, v227
    buffer_load_dwordx4 v31, s[16:19], s77 offen offset:3072 lds
    s_add_u32 s77, s77, 16384
    v_mfma_f32_16x16x32_bf16 v[72:75], v[100:103], v[124:127], 0
    v_mfma_f32_16x16x32_bf16 v[72:75], v[104:107], v[128:131], v[72:75]
    s_add_u32 m0, s80, 36864
    v_add_u32_dpp v24, v49, v1 row_newbcast:4 row_mask:0xf bank_mask:0x3
    v_add_u32_dpp v24, v49, v1 row_newbcast:12 row_mask:0xf bank_mask:0xc
    buffer_load_dwordx4 v24, s[12:15], 0 offen offset:0 lds
    v_fmac_f32 v32, v76, v228
    v_fmac_f32 v33, v77, v229
    v_fmac_f32 v34, v78, v230
    v_fmac_f32 v35, v79, v231
    v_add_u32_dpp v25, v53, v1 row_newbcast:4 row_mask:0xf bank_mask:0x3
    v_add_u32_dpp v25, v53, v1 row_newbcast:12 row_mask:0xf bank_mask:0xc
    buffer_load_dwordx4 v25, s[28:31], 0 offen offset:2048 lds
    v_mfma_f32_16x16x32_bf16 v[76:79], v[116:119], v[140:143], 0
    v_mfma_f32_16x16x32_bf16 v[76:79], v[120:123], v[144:147], v[76:79]
    s_movk_i32 s74, 9600
    buffer_load_dword v36, v8, s[8:11], s74 offen
    buffer_load_dword v37, v8, s[8:11], s74 offen offset:256
    v_fmac_f32 v32, v80, v232
    v_fmac_f32 v33, v81, v233
    v_fmac_f32 v34, v82, v234
    v_fmac_f32 v35, v83, v235
    ds_read_b128 v[92:95], v4 offset:0
    ds_read_b128 v[96:99], v5 offset:0
    s_mov_b64 exec, s[62:63]
    ds_read_b128 v[148:151], v22 offset:0
    ds_read_b128 v[152:155], v23 offset:0
    s_mov_b64 exec, -1
    s_barrier
    s_waitcnt lgkmcnt(0)
    s_add_u32 m0, s81, 49152
    s_nop 0
    buffer_load_dwordx4 v28, s[16:19], s77 offen offset:0 lds
    v_mfma_f32_16x16x32_bf16 v[80:83], v[108:111], v[124:127], 0
    v_mfma_f32_16x16x32_bf16 v[80:83], v[112:115], v[128:131], v[80:83]
    buffer_load_dwordx4 v29, s[16:19], s77 offen offset:1024 lds
    v_fmac_f32 v32, v72, v236
    v_fmac_f32 v33, v73, v237
    v_fmac_f32 v34, v74, v238
    v_fmac_f32 v35, v75, v239
    v_lshlrev_b32 v38, 7, v38
    v_lshlrev_b32 v39, 7, v39
    s_nop 0
    s_add_u32 m0, s82, 0
    v_add_u32_dpp v26, v38, v2 row_newbcast:0 row_mask:0xf bank_mask:0x3
    v_add_u32_dpp v26, v38, v2 row_newbcast:8 row_mask:0xf bank_mask:0xc
    buffer_load_dwordx4 v26, s[12:15], 0 offen offset:0 lds
    s_mov_b64 exec, s[36:37]
    v_mov_b64 v[140:141], v[124:125]
    v_mov_b64 v[142:143], v[126:127]
    v_mov_b64 v[144:145], v[128:129]
    v_mov_b64 v[146:147], v[130:131]
    s_mov_b64 exec, -1
    v_add_u32_dpp v27, v38, v3 row_newbcast:1 row_mask:0xf bank_mask:0x3
    v_add_u32_dpp v27, v38, v3 row_newbcast:9 row_mask:0xf bank_mask:0xc
    buffer_load_dwordx4 v27, s[24:27], 0 offen offset:1024 lds
    v_mfma_f32_16x16x32_bf16 v[72:75], v[116:119], v[124:127], 0
    v_mfma_f32_16x16x32_bf16 v[72:75], v[120:123], v[128:131], v[72:75]
    s_add_u32 m0, s81, 49152
    s_nop 0
    buffer_load_dwordx4 v30, s[16:19], s77 offen offset:2048 lds
    v_fmac_f32 v32, v76, v240
    v_fmac_f32 v33, v77, v241
    v_fmac_f32 v34, v78, v242
    v_fmac_f32 v35, v79, v243
    buffer_load_dwordx4 v31, s[16:19], s77 offen offset:3072 lds
    s_add_u32 s77, s77, 16384
    v_mfma_f32_16x16x32_bf16 v[76:79], v[124:127], v[140:143], 0
    v_mfma_f32_16x16x32_bf16 v[76:79], v[128:131], v[144:147], v[76:79]
    s_add_u32 m0, s80, 0
    v_add_u32_dpp v24, v42, v1 row_newbcast:4 row_mask:0xf bank_mask:0x3
    v_add_u32_dpp v24, v42, v1 row_newbcast:12 row_mask:0xf bank_mask:0xc
    buffer_load_dwordx4 v24, s[12:15], 0 offen offset:0 lds
    v_fmac_f32 v32, v80, v244
    v_fmac_f32 v33, v81, v245
    v_fmac_f32 v34, v82, v246
    v_fmac_f32 v35, v83, v247
    v_add_u32_dpp v25, v46, v1 row_newbcast:4 row_mask:0xf bank_mask:0x3
    v_add_u32_dpp v25, v46, v1 row_newbcast:12 row_mask:0xf bank_mask:0xc
    buffer_load_dwordx4 v25, s[28:31], 0 offen offset:2048 lds
    s_mov_b64 exec, s[36:37]
    v_mov_b64 v[132:133], v[84:85]
    v_mov_b64 v[134:135], v[86:87]
    v_mov_b64 v[136:137], v[88:89]
    v_mov_b64 v[138:139], v[90:91]
    s_mov_b64 exec, -1
    ds_read_b128 v[100:103], v4 offset:2048
    ds_read_b128 v[104:107], v5 offset:2048
    s_mov_b64 exec, s[64:65]
    ds_read_b128 v[148:151], v22 offset:2048
    ds_read_b128 v[152:155], v23 offset:2048
    s_mov_b64 exec, -1
    s_waitcnt vmcnt(20)
    s_barrier
    s_waitcnt lgkmcnt(0)
    s_add_u32 m0, s81, 0
    s_nop 0
    buffer_load_dwordx4 v28, s[16:19], s77 offen offset:0 lds
    v_mfma_f32_16x16x32_bf16 v[80:83], v[84:87], v[132:135], 0
    v_mfma_f32_16x16x32_bf16 v[80:83], v[88:91], v[136:139], v[80:83]
    buffer_load_dwordx4 v29, s[16:19], s77 offen offset:1024 lds
    v_fmac_f32 v32, v72, v248
    v_fmac_f32 v33, v73, v249
    v_fmac_f32 v34, v74, v250
    v_fmac_f32 v35, v75, v251
    s_add_u32 m0, s82, 2048
    v_add_u32_dpp v26, v38, v2 row_newbcast:2 row_mask:0xf bank_mask:0x3
    v_add_u32_dpp v26, v38, v2 row_newbcast:10 row_mask:0xf bank_mask:0xc
    buffer_load_dwordx4 v26, s[12:15], 0 offen offset:0 lds
    s_mov_b64 exec, s[36:37]
    v_mov_b64 v[132:133], v[92:93]
    v_mov_b64 v[134:135], v[94:95]
    v_mov_b64 v[136:137], v[96:97]
    v_mov_b64 v[138:139], v[98:99]
    s_mov_b64 exec, -1
    v_add_u32_dpp v27, v38, v3 row_newbcast:3 row_mask:0xf bank_mask:0x3
    v_add_u32_dpp v27, v38, v3 row_newbcast:11 row_mask:0xf bank_mask:0xc
    buffer_load_dwordx4 v27, s[24:27], 0 offen offset:1024 lds
    v_mfma_f32_16x16x32_bf16 v[72:75], v[84:87], v[92:95], 0
    v_mfma_f32_16x16x32_bf16 v[72:75], v[88:91], v[96:99], v[72:75]
    s_add_u32 m0, s81, 0
    s_nop 0
    buffer_load_dwordx4 v30, s[16:19], s77 offen offset:2048 lds
    v_fmac_f32 v32, v76, v252
    v_fmac_f32 v33, v77, v253
    v_fmac_f32 v34, v78, v254
    v_fmac_f32 v35, v79, v255
    v_add_f32 v12, v32, v33
    v_add_f32 v13, v34, v35
    v_add_f32 v12, v12, v13
    v_mfma_f32_16x16x32_bf16 v[76:79], v[92:95], v[132:135], 0
    v_mfma_f32_16x16x32_bf16 v[76:79], v[96:99], v[136:139], v[76:79]
    buffer_load_dwordx4 v31, s[16:19], s77 offen offset:3072 lds
    s_add_u32 s77, s77, 16384
    v_add_f32_dpp v12, v12, v12 row_shr:1 row_mask:0xf bank_mask:0xf bound_ctrl:0
    v_mul_f32 v32, v80, v164
    v_mul_f32 v33, v81, v165
    v_mul_f32 v34, v82, v166
    v_mul_f32 v35, v83, v167
    s_add_u32 m0, s80, 4096
    v_add_u32_dpp v24, v50, v1 row_newbcast:4 row_mask:0xf bank_mask:0x3
    v_add_u32_dpp v24, v50, v1 row_newbcast:12 row_mask:0xf bank_mask:0xc
    buffer_load_dwordx4 v24, s[12:15], 0 offen offset:0 lds
    v_add_f32_dpp v12, v12, v12 row_shr:2 row_mask:0xf bank_mask:0xf bound_ctrl:0
    v_mfma_f32_16x16x32_bf16 v[80:83], v[84:87], v[100:103], 0
    v_mfma_f32_16x16x32_bf16 v[80:83], v[88:91], v[104:107], v[80:83]
    v_add_u32_dpp v25, v54, v1 row_newbcast:4 row_mask:0xf bank_mask:0x3
    v_add_u32_dpp v25, v54, v1 row_newbcast:12 row_mask:0xf bank_mask:0xc
    buffer_load_dwordx4 v25, s[28:31], 0 offen offset:2048 lds
    v_add_f32_dpp v12, v12, v12 row_shr:4 row_mask:0xf bank_mask:0xf bound_ctrl:0
    v_fmac_f32 v32, v72, v168
    v_fmac_f32 v33, v73, v169
    v_fmac_f32 v34, v74, v170
    v_fmac_f32 v35, v75, v171
    v_add_f32_dpp v12, v12, v12 row_shr:8 row_mask:0xf bank_mask:0xf bound_ctrl:0
    ds_read_b128 v[108:111], v4 offset:4096
    ds_read_b128 v[112:115], v5 offset:4096
    s_mov_b64 exec, s[66:67]
    ds_read_b128 v[148:151], v22 offset:4096
    ds_read_b128 v[152:155], v23 offset:4096
    s_mov_b64 exec, -1
    s_waitcnt vmcnt(18)
    s_barrier
    s_waitcnt lgkmcnt(0)
    s_add_u32 m0, s81, 16384
    s_nop 0
    buffer_load_dwordx4 v28, s[16:19], s77 offen offset:0 lds
    s_mov_b64 exec, s[36:37]
    v_mov_b64 v[132:133], v[100:101]
    v_mov_b64 v[134:135], v[102:103]
    v_mov_b64 v[136:137], v[104:105]
    v_mov_b64 v[138:139], v[106:107]
    s_mov_b64 exec, -1
    buffer_load_dwordx4 v29, s[16:19], s77 offen offset:1024 lds
    v_add_f32_dpp v12, v12, v12 row_bcast:15 row_mask:0xa bank_mask:0xf
    v_mfma_f32_16x16x32_bf16 v[72:75], v[92:95], v[100:103], 0
    v_mfma_f32_16x16x32_bf16 v[72:75], v[96:99], v[104:107], v[72:75]
    s_add_u32 m0, s82, 4096
    v_add_u32_dpp v26, v38, v2 row_newbcast:4 row_mask:0xf bank_mask:0x3
    v_add_u32_dpp v26, v38, v2 row_newbcast:12 row_mask:0xf bank_mask:0xc
    buffer_load_dwordx4 v26, s[12:15], 0 offen offset:0 lds
    v_add_f32_dpp v12, v12, v12 row_bcast:31 row_mask:0xc bank_mask:0xf
    v_fmac_f32 v32, v76, v172
    v_fmac_f32 v33, v77, v173
    v_fmac_f32 v34, v78, v174
    v_fmac_f32 v35, v79, v175
    v_add_u32_dpp v27, v38, v3 row_newbcast:5 row_mask:0xf bank_mask:0x3
    v_add_u32_dpp v27, v38, v3 row_newbcast:13 row_mask:0xf bank_mask:0xc
    buffer_load_dwordx4 v27, s[24:27], 0 offen offset:1024 lds
    v_readlane_b32 s38, v12, 63
    v_mfma_f32_16x16x32_bf16 v[76:79], v[84:87], v[108:111], 0
    v_mfma_f32_16x16x32_bf16 v[76:79], v[88:91], v[112:115], v[76:79]
    s_add_u32 m0, s81, 16384
    s_nop 0
    buffer_load_dwordx4 v30, s[16:19], s77 offen offset:2048 lds
    v_writelane_b32 v9, s38, 3
    v_fmac_f32 v32, v80, v176
    v_fmac_f32 v33, v81, v177
    v_fmac_f32 v34, v82, v178
    v_fmac_f32 v35, v83, v179
    v_mfma_f32_16x16x32_bf16 v[80:83], v[100:103], v[132:135], 0
    v_mfma_f32_16x16x32_bf16 v[80:83], v[104:107], v[136:139], v[80:83]
    buffer_load_dwordx4 v31, s[16:19], s77 offen offset:3072 lds
    s_add_u32 s77, s77, 16384
    v_fmac_f32 v32, v72, v180
    v_fmac_f32 v33, v73, v181
    v_fmac_f32 v34, v74, v182
    v_fmac_f32 v35, v75, v183
    s_add_u32 m0, s80, 16384
    v_add_u32_dpp v24, v43, v1 row_newbcast:4 row_mask:0xf bank_mask:0x3
    v_add_u32_dpp v24, v43, v1 row_newbcast:12 row_mask:0xf bank_mask:0xc
    buffer_load_dwordx4 v24, s[12:15], 0 offen offset:0 lds
    v_mfma_f32_16x16x32_bf16 v[72:75], v[92:95], v[108:111], 0
    v_mfma_f32_16x16x32_bf16 v[72:75], v[96:99], v[112:115], v[72:75]
    v_add_u32_dpp v25, v47, v1 row_newbcast:4 row_mask:0xf bank_mask:0x3
    v_add_u32_dpp v25, v47, v1 row_newbcast:12 row_mask:0xf bank_mask:0xc
    buffer_load_dwordx4 v25, s[28:31], 0 offen offset:2048 lds
    v_fmac_f32 v32, v76, v184
    v_fmac_f32 v33, v77, v185
    v_fmac_f32 v34, v78, v186
    v_fmac_f32 v35, v79, v187
    ds_read_b128 v[116:119], v4 offset:6144
    ds_read_b128 v[120:123], v5 offset:6144
    s_mov_b64 exec, s[60:61]
    ds_read_b128 v[156:159], v22 offset:6144
    ds_read_b128 v[160:163], v23 offset:6144
    s_mov_b64 exec, -1
    s_waitcnt vmcnt(18)
    s_barrier
    s_waitcnt lgkmcnt(0)
    s_add_u32 m0, s81, 32768
    s_nop 0
    buffer_load_dwordx4 v28, s[16:19], s77 offen offset:0 lds
    v_mfma_f32_16x16x32_bf16 v[76:79], v[148:151], v[148:151], 0
    v_mfma_f32_16x16x32_bf16 v[76:79], v[152:155], v[152:155], v[76:79]
    buffer_load_dwordx4 v29, s[16:19], s77 offen offset:1024 lds
    v_fmac_f32 v32, v80, v188
    v_fmac_f32 v33, v81, v189
    v_fmac_f32 v34, v82, v190
    v_fmac_f32 v35, v83, v191
    s_add_u32 m0, s82, 6144
    v_add_u32_dpp v26, v38, v2 row_newbcast:6 row_mask:0xf bank_mask:0x3
    v_add_u32_dpp v26, v38, v2 row_newbcast:14 row_mask:0xf bank_mask:0xc
    buffer_load_dwordx4 v26, s[12:15], 0 offen offset:0 lds
    v_mfma_f32_16x16x32_bf16 v[80:83], v[84:87], v[116:119], 0
    v_mfma_f32_16x16x32_bf16 v[80:83], v[88:91], v[120:123], v[80:83]
    v_add_u32_dpp v27, v38, v3 row_newbcast:7 row_mask:0xf bank_mask:0x3
    v_add_u32_dpp v27, v38, v3 row_newbcast:15 row_mask:0xf bank_mask:0xc
    buffer_load_dwordx4 v27, s[24:27], 0 offen offset:1024 lds
    v_fmac_f32 v32, v72, v192
    v_fmac_f32 v33, v73, v193
    v_fmac_f32 v34, v74, v194
    v_fmac_f32 v35, v75, v195
    s_add_u32 m0, s81, 32768
    s_nop 0
    buffer_load_dwordx4 v30, s[16:19], s77 offen offset:2048 lds
    s_mov_b64 exec, s[36:37]
    v_mov_b64 v[132:133], v[108:109]
    v_mov_b64 v[134:135], v[110:111]
    v_mov_b64 v[136:137], v[112:113]
    v_mov_b64 v[138:139], v[114:115]
    s_mov_b64 exec, -1
    buffer_load_dwordx4 v31, s[16:19], s77 offen offset:3072 lds
    s_add_u32 s77, s77, 16384
    v_mfma_f32_16x16x32_bf16 v[72:75], v[100:103], v[108:111], 0
    v_mfma_f32_16x16x32_bf16 v[72:75], v[104:107], v[112:115], v[72:75]
    s_add_u32 m0, s80, 20480
    v_add_u32_dpp v24, v51, v1 row_newbcast:4 row_mask:0xf bank_mask:0x3
    v_add_u32_dpp v24, v51, v1 row_newbcast:12 row_mask:0xf bank_mask:0xc
    buffer_load_dwordx4 v24, s[12:15], 0 offen offset:0 lds
    v_fmac_f32 v32, v76, v196
    v_fmac_f32 v33, v77, v197
    v_fmac_f32 v34, v78, v198
    v_fmac_f32 v35, v79, v199
    v_add_u32_dpp v25, v55, v1 row_newbcast:4 row_mask:0xf bank_mask:0x3
    v_add_u32_dpp v25, v55, v1 row_newbcast:12 row_mask:0xf bank_mask:0xc
    buffer_load_dwordx4 v25, s[28:31], 0 offen offset:2048 lds
    v_mfma_f32_16x16x32_bf16 v[76:79], v[92:95], v[116:119], 0
    v_mfma_f32_16x16x32_bf16 v[76:79], v[96:99], v[120:123], v[76:79]
    s_add_u32 m0, s82, 10240
    v_add_u32_dpp v26, v39, v2 row_newbcast:4 row_mask:0xf bank_mask:0x3
    v_add_u32_dpp v26, v39, v2 row_newbcast:12 row_mask:0xf bank_mask:0xc
    s_mov_b32 exec_hi, 0
    buffer_load_dwordx4 v26, s[12:15], 0 offen offset:0 lds
    s_mov_b32 exec_hi, -1
    v_fmac_f32 v32, v80, v200
    v_fmac_f32 v33, v81, v201
    v_fmac_f32 v34, v82, v202
    v_fmac_f32 v35, v83, v203
    ds_read_b128 v[124:127], v4 offset:8192
    ds_read_b128 v[128:131], v5 offset:8192
    s_mov_b64 exec, s[62:63]
    ds_read_b128 v[156:159], v22 offset:8192
    ds_read_b128 v[160:163], v23 offset:8192
    s_mov_b64 exec, -1
    s_waitcnt vmcnt(17)
    s_barrier
    s_waitcnt lgkmcnt(0)
    s_add_u32 m0, s81, 49152
    s_nop 0
    buffer_load_dwordx4 v28, s[16:19], s77 offen offset:0 lds
    v_mfma_f32_16x16x32_bf16 v[80:83], v[84:87], v[124:127], 0
    v_mfma_f32_16x16x32_bf16 v[80:83], v[88:91], v[128:131], v[80:83]
    buffer_load_dwordx4 v29, s[16:19], s77 offen offset:1024 lds
    v_fmac_f32 v32, v72, v204
    v_fmac_f32 v33, v73, v205
    v_fmac_f32 v34, v74, v206
    v_fmac_f32 v35, v75, v207
    s_add_u32 m0, s82, 8192
    v_add_u32_dpp v27, v39, v2 row_newbcast:0 row_mask:0xf bank_mask:0x3
    v_add_u32_dpp v27, v39, v2 row_newbcast:8 row_mask:0xf bank_mask:0xc
    buffer_load_dwordx4 v27, s[12:15], 0 offen offset:0 lds
    v_mfma_f32_16x16x32_bf16 v[72:75], v[108:111], v[132:135], 0
    v_mfma_f32_16x16x32_bf16 v[72:75], v[112:115], v[136:139], v[72:75]
    v_add_u32_dpp v24, v39, v3 row_newbcast:1 row_mask:0xf bank_mask:0x3
    v_add_u32_dpp v24, v39, v3 row_newbcast:9 row_mask:0xf bank_mask:0xc
    buffer_load_dwordx4 v24, s[24:27], 0 offen offset:1024 lds
    v_fmac_f32 v32, v76, v208
    v_fmac_f32 v33, v77, v209
    v_fmac_f32 v34, v78, v210
    v_fmac_f32 v35, v79, v211
    s_add_u32 m0, s81, 49152
    s_nop 0
    buffer_load_dwordx4 v30, s[16:19], s77 offen offset:2048 lds
    v_mfma_f32_16x16x32_bf16 v[76:79], v[92:95], v[124:127], 0
    v_mfma_f32_16x16x32_bf16 v[76:79], v[96:99], v[128:131], v[76:79]
    buffer_load_dwordx4 v31, s[16:19], s77 offen offset:3072 lds
    s_add_u32 s77, s77, 16384
    v_fmac_f32 v32, v80, v212
    v_fmac_f32 v33, v81, v213
    v_fmac_f32 v34, v82, v214
    v_fmac_f32 v35, v83, v215
    s_add_u32 m0, s80, 32768
    v_add_u32_dpp v25, v40, v1 row_newbcast:5 row_mask:0xf bank_mask:0x3
    v_add_u32_dpp v25, v40, v1 row_newbcast:13 row_mask:0xf bank_mask:0xc
    buffer_load_dwordx4 v25, s[12:15], 0 offen offset:0 lds
    v_mfma_f32_16x16x32_bf16 v[80:83], v[156:159], v[156:159], 0
    v_mfma_f32_16x16x32_bf16 v[80:83], v[160:163], v[160:163], v[80:83]
    v_add_u32_dpp v26, v44, v1 row_newbcast:5 row_mask:0xf bank_mask:0x3
    v_add_u32_dpp v26, v44, v1 row_newbcast:13 row_mask:0xf bank_mask:0xc
    buffer_load_dwordx4 v26, s[28:31], 0 offen offset:2048 lds
    v_fmac_f32 v32, v72, v216
    v_fmac_f32 v33, v73, v217
    v_fmac_f32 v34, v74, v218
    v_fmac_f32 v35, v75, v219
    ds_read_b128 v[84:87], v4 offset:0
    ds_read_b128 v[88:91], v5 offset:0
    s_mov_b64 exec, s[60:61]
    ds_read_b128 v[148:151], v22 offset:0
    ds_read_b128 v[152:155], v23 offset:0
    s_mov_b64 exec, -1
    s_waitcnt vmcnt(8)
    s_mov_b64 exec, s[60:61]
    ds_read_b128 v[140:143], v4 offset:10240
    ds_read_b128 v[144:147], v5 offset:10240
    s_mov_b64 exec, s[64:65]
    ds_read_b128 v[156:159], v22 offset:10240
    ds_read_b128 v[160:163], v23 offset:10240
    s_mov_b64 exec, -1
    s_barrier
    s_waitcnt lgkmcnt(0)
    s_add_u32 m0, s81, 0
    s_nop 0
    buffer_load_dwordx4 v28, s[16:19], s77 offen offset:0 lds
    v_mfma_f32_16x16x32_bf16 v[72:75], v[100:103], v[116:119], 0
    v_mfma_f32_16x16x32_bf16 v[72:75], v[104:107], v[120:123], v[72:75]
    buffer_load_dwordx4 v29, s[16:19], s77 offen offset:1024 lds
    v_fmac_f32 v32, v76, v220
    v_fmac_f32 v33, v77, v221
    v_fmac_f32 v34, v78, v222
    v_fmac_f32 v35, v79, v223
    s_add_u32 m0, s82, 0
    v_add_u32_dpp v27, v39, v2 row_newbcast:2 row_mask:0xf bank_mask:0x3
    v_add_u32_dpp v27, v39, v2 row_newbcast:10 row_mask:0xf bank_mask:0xc
    buffer_load_dwordx4 v27, s[12:15], 0 offen offset:0 lds
    s_mov_b64 exec, s[36:37]
    v_mov_b64 v[132:133], v[116:117]
    v_mov_b64 v[134:135], v[118:119]
    v_mov_b64 v[136:137], v[120:121]
    v_mov_b64 v[138:139], v[122:123]
    s_mov_b64 exec, -1
    v_add_u32_dpp v24, v39, v3 row_newbcast:3 row_mask:0xf bank_mask:0x3
    v_add_u32_dpp v24, v39, v3 row_newbcast:11 row_mask:0xf bank_mask:0xc
    buffer_load_dwordx4 v24, s[24:27], 0 offen offset:1024 lds
    v_mfma_f32_16x16x32_bf16 v[76:79], v[108:111], v[116:119], 0
    v_mfma_f32_16x16x32_bf16 v[76:79], v[112:115], v[120:123], v[76:79]
    s_add_u32 m0, s81, 0
    s_nop 0
    buffer_load_dwordx4 v30, s[16:19], s77 offen offset:2048 lds
    v_fmac_f32 v32, v80, v224
    v_fmac_f32 v33, v81, v225
    v_fmac_f32 v34, v82, v226
    v_fmac_f32 v35, v83, v227
    buffer_load_dwordx4 v31, s[16:19], s77 offen offset:3072 lds
    s_add_u32 s77, s77, 16384
    v_mfma_f32_16x16x32_bf16 v[80:83], v[100:103], v[124:127], 0
    v_mfma_f32_16x16x32_bf16 v[80:83], v[104:107], v[128:131], v[80:83]
    s_add_u32 m0, s80, 36864
    v_add_u32_dpp v25, v48, v1 row_newbcast:5 row_mask:0xf bank_mask:0x3
    v_add_u32_dpp v25, v48, v1 row_newbcast:13 row_mask:0xf bank_mask:0xc
    buffer_load_dwordx4 v25, s[12:15], 0 offen offset:0 lds
    v_fmac_f32 v32, v72, v228
    v_fmac_f32 v33, v73, v229
    v_fmac_f32 v34, v74, v230
    v_fmac_f32 v35, v75, v231
    v_add_u32_dpp v26, v52, v1 row_newbcast:5 row_mask:0xf bank_mask:0x3
    v_add_u32_dpp v26, v52, v1 row_newbcast:13 row_mask:0xf bank_mask:0xc
    buffer_load_dwordx4 v26, s[28:31], 0 offen offset:2048 lds
    v_mfma_f32_16x16x32_bf16 v[72:75], v[116:119], v[132:135], 0
    v_mfma_f32_16x16x32_bf16 v[72:75], v[120:123], v[136:139], v[72:75]
    s_movk_i32 s74, 11200
    buffer_load_dword v38, v8, s[8:11], s74 offen
    buffer_load_dword v39, v8, s[8:11], s74 offen offset:256
    v_fmac_f32 v32, v76, v232
    v_fmac_f32 v33, v77, v233
    v_fmac_f32 v34, v78, v234
    v_fmac_f32 v35, v79, v235
    ds_read_b128 v[92:95], v4 offset:2048
    ds_read_b128 v[96:99], v5 offset:2048
    s_mov_b64 exec, s[62:63]
    ds_read_b128 v[148:151], v22 offset:2048
    ds_read_b128 v[152:155], v23 offset:2048
    s_mov_b64 exec, -1
    s_barrier
    s_waitcnt lgkmcnt(0)
    s_add_u32 m0, s81, 16384
    s_nop 0
    buffer_load_dwordx4 v28, s[16:19], s77 offen offset:0 lds
    v_mfma_f32_16x16x32_bf16 v[76:79], v[108:111], v[124:127], 0
    v_mfma_f32_16x16x32_bf16 v[76:79], v[112:115], v[128:131], v[76:79]
    buffer_load_dwordx4 v29, s[16:19], s77 offen offset:1024 lds
    v_fmac_f32 v32, v80, v236
    v_fmac_f32 v33, v81, v237
    v_fmac_f32 v34, v82, v238
    v_fmac_f32 v35, v83, v239
    v_lshlrev_b32 v36, 7, v36
    v_lshlrev_b32 v37, 7, v37
    s_nop 0
    s_add_u32 m0, s82, 2048
    v_add_u32_dpp v27, v36, v2 row_newbcast:0 row_mask:0xf bank_mask:0x3
    v_add_u32_dpp v27, v36, v2 row_newbcast:8 row_mask:0xf bank_mask:0xc
    buffer_load_dwordx4 v27, s[12:15], 0 offen offset:0 lds
    s_mov_b64 exec, s[36:37]
    v_mov_b64 v[132:133], v[124:125]
    v_mov_b64 v[134:135], v[126:127]
    v_mov_b64 v[136:137], v[128:129]
    v_mov_b64 v[138:139], v[130:131]
    s_mov_b64 exec, -1
    v_add_u32_dpp v24, v36, v3 row_newbcast:1 row_mask:0xf bank_mask:0x3
    v_add_u32_dpp v24, v36, v3 row_newbcast:9 row_mask:0xf bank_mask:0xc
    buffer_load_dwordx4 v24, s[24:27], 0 offen offset:1024 lds
    v_mfma_f32_16x16x32_bf16 v[80:83], v[116:119], v[124:127], 0
    v_mfma_f32_16x16x32_bf16 v[80:83], v[120:123], v[128:131], v[80:83]
    s_add_u32 m0, s81, 16384
    s_nop 0
    buffer_load_dwordx4 v30, s[16:19], s77 offen offset:2048 lds
    v_fmac_f32 v32, v72, v240
    v_fmac_f32 v33, v73, v241
    v_fmac_f32 v34, v74, v242
    v_fmac_f32 v35, v75, v243
    buffer_load_dwordx4 v31, s[16:19], s77 offen offset:3072 lds
    s_add_u32 s77, s77, 16384
    v_mfma_f32_16x16x32_bf16 v[72:75], v[124:127], v[132:135], 0
    v_mfma_f32_16x16x32_bf16 v[72:75], v[128:131], v[136:139], v[72:75]
    s_add_u32 m0, s80, 0
    v_add_u32_dpp v25, v41, v1 row_newbcast:5 row_mask:0xf bank_mask:0x3
    v_add_u32_dpp v25, v41, v1 row_newbcast:13 row_mask:0xf bank_mask:0xc
    buffer_load_dwordx4 v25, s[12:15], 0 offen offset:0 lds
    v_fmac_f32 v32, v76, v244
    v_fmac_f32 v33, v77, v245
    v_fmac_f32 v34, v78, v246
    v_fmac_f32 v35, v79, v247
    v_add_u32_dpp v26, v45, v1 row_newbcast:5 row_mask:0xf bank_mask:0x3
    v_add_u32_dpp v26, v45, v1 row_newbcast:13 row_mask:0xf bank_mask:0xc
    buffer_load_dwordx4 v26, s[28:31], 0 offen offset:2048 lds
    s_mov_b64 exec, s[36:37]
    v_mov_b64 v[140:141], v[84:85]
    v_mov_b64 v[142:143], v[86:87]
    v_mov_b64 v[144:145], v[88:89]
    v_mov_b64 v[146:147], v[90:91]
    s_mov_b64 exec, -1
    ds_read_b128 v[100:103], v4 offset:4096
    ds_read_b128 v[104:107], v5 offset:4096
    s_mov_b64 exec, s[64:65]
    ds_read_b128 v[148:151], v22 offset:4096
    ds_read_b128 v[152:155], v23 offset:4096
    s_mov_b64 exec, -1
    s_waitcnt vmcnt(20)
    s_barrier
    s_waitcnt lgkmcnt(0)
    s_add_u32 m0, s81, 32768
    s_nop 0
    buffer_load_dwordx4 v28, s[16:19], s77 offen offset:0 lds
    v_mfma_f32_16x16x32_bf16 v[76:79], v[84:87], v[140:143], 0
    v_mfma_f32_16x16x32_bf16 v[76:79], v[88:91], v[144:147], v[76:79]
    buffer_load_dwordx4 v29, s[16:19], s77 offen offset:1024 lds
    v_fmac_f32 v32, v80, v248
    v_fmac_f32 v33, v81, v249
    v_fmac_f32 v34, v82, v250
    v_fmac_f32 v35, v83, v251
    s_add_u32 m0, s82, 4096
    v_add_u32_dpp v27, v36, v2 row_newbcast:2 row_mask:0xf bank_mask:0x3
    v_add_u32_dpp v27, v36, v2 row_newbcast:10 row_mask:0xf bank_mask:0xc
    buffer_load_dwordx4 v27, s[12:15], 0 offen offset:0 lds
    s_mov_b64 exec, s[36:37]
    v_mov_b64 v[140:141], v[92:93]
    v_mov_b64 v[142:143], v[94:95]
    v_mov_b64 v[144:145], v[96:97]
    v_mov_b64 v[146:147], v[98:99]
    s_mov_b64 exec, -1
    v_add_u32_dpp v24, v36, v3 row_newbcast:3 row_mask:0xf bank_mask:0x3
    v_add_u32_dpp v24, v36, v3 row_newbcast:11 row_mask:0xf bank_mask:0xc
    buffer_load_dwordx4 v24, s[24:27], 0 offen offset:1024 lds
    v_mfma_f32_16x16x32_bf16 v[80:83], v[84:87], v[92:95], 0
    v_mfma_f32_16x16x32_bf16 v[80:83], v[88:91], v[96:99], v[80:83]
    s_add_u32 m0, s81, 32768
    s_nop 0
    buffer_load_dwordx4 v30, s[16:19], s77 offen offset:2048 lds
    v_fmac_f32 v32, v72, v252
    v_fmac_f32 v33, v73, v253
    v_fmac_f32 v34, v74, v254
    v_fmac_f32 v35, v75, v255
    v_add_f32 v12, v32, v33
    v_add_f32 v13, v34, v35
    v_add_f32 v12, v12, v13
    v_mfma_f32_16x16x32_bf16 v[72:75], v[92:95], v[140:143], 0
    v_mfma_f32_16x16x32_bf16 v[72:75], v[96:99], v[144:147], v[72:75]
    buffer_load_dwordx4 v31, s[16:19], s77 offen offset:3072 lds
    s_add_u32 s77, s77, 16384
    v_add_f32_dpp v12, v12, v12 row_shr:1 row_mask:0xf bank_mask:0xf bound_ctrl:0
    v_mul_f32 v32, v76, v164
    v_mul_f32 v33, v77, v165
    v_mul_f32 v34, v78, v166
    v_mul_f32 v35, v79, v167
    s_add_u32 m0, s80, 4096
    v_add_u32_dpp v25, v49, v1 row_newbcast:5 row_mask:0xf bank_mask:0x3
    v_add_u32_dpp v25, v49, v1 row_newbcast:13 row_mask:0xf bank_mask:0xc
    buffer_load_dwordx4 v25, s[12:15], 0 offen offset:0 lds
    v_add_f32_dpp v12, v12, v12 row_shr:2 row_mask:0xf bank_mask:0xf bound_ctrl:0
    v_mfma_f32_16x16x32_bf16 v[76:79], v[84:87], v[100:103], 0
    v_mfma_f32_16x16x32_bf16 v[76:79], v[88:91], v[104:107], v[76:79]
    v_add_u32_dpp v26, v53, v1 row_newbcast:5 row_mask:0xf bank_mask:0x3
    v_add_u32_dpp v26, v53, v1 row_newbcast:13 row_mask:0xf bank_mask:0xc
    buffer_load_dwordx4 v26, s[28:31], 0 offen offset:2048 lds
    v_add_f32_dpp v12, v12, v12 row_shr:4 row_mask:0xf bank_mask:0xf bound_ctrl:0
    v_fmac_f32 v32, v80, v168
    v_fmac_f32 v33, v81, v169
    v_fmac_f32 v34, v82, v170
    v_fmac_f32 v35, v83, v171
    v_add_f32_dpp v12, v12, v12 row_shr:8 row_mask:0xf bank_mask:0xf bound_ctrl:0
    ds_read_b128 v[108:111], v4 offset:6144
    ds_read_b128 v[112:115], v5 offset:6144
    s_mov_b64 exec, s[66:67]
    ds_read_b128 v[148:151], v22 offset:6144
    ds_read_b128 v[152:155], v23 offset:6144
    s_mov_b64 exec, -1
    s_waitcnt vmcnt(18)
    s_barrier
    s_waitcnt lgkmcnt(0)
    s_add_u32 m0, s81, 49152
    s_nop 0
    buffer_load_dwordx4 v28, s[16:19], s77 offen offset:0 lds
    s_mov_b64 exec, s[36:37]
    v_mov_b64 v[140:141], v[100:101]
    v_mov_b64 v[142:143], v[102:103]
    v_mov_b64 v[144:145], v[104:105]
    v_mov_b64 v[146:147], v[106:107]
    s_mov_b64 exec, -1
    buffer_load_dwordx4 v29, s[16:19], s77 offen offset:1024 lds
    v_add_f32_dpp v12, v12, v12 row_bcast:15 row_mask:0xa bank_mask:0xf
    v_mfma_f32_16x16x32_bf16 v[80:83], v[92:95], v[100:103], 0
    v_mfma_f32_16x16x32_bf16 v[80:83], v[96:99], v[104:107], v[80:83]
    s_add_u32 m0, s82, 6144
    v_add_u32_dpp v27, v36, v2 row_newbcast:4 row_mask:0xf bank_mask:0x3
    v_add_u32_dpp v27, v36, v2 row_newbcast:12 row_mask:0xf bank_mask:0xc
    buffer_load_dwordx4 v27, s[12:15], 0 offen offset:0 lds
    v_add_f32_dpp v12, v12, v12 row_bcast:31 row_mask:0xc bank_mask:0xf
    v_fmac_f32 v32, v72, v172
    v_fmac_f32 v33, v73, v173
    v_fmac_f32 v34, v74, v174
    v_fmac_f32 v35, v75, v175
    v_add_u32_dpp v24, v36, v3 row_newbcast:5 row_mask:0xf bank_mask:0x3
    v_add_u32_dpp v24, v36, v3 row_newbcast:13 row_mask:0xf bank_mask:0xc
    buffer_load_dwordx4 v24, s[24:27], 0 offen offset:1024 lds
    v_readlane_b32 s38, v12, 63
    v_mfma_f32_16x16x32_bf16 v[72:75], v[84:87], v[108:111], 0
    v_mfma_f32_16x16x32_bf16 v[72:75], v[88:91], v[112:115], v[72:75]
    s_add_u32 m0, s81, 49152
    s_nop 0
    buffer_load_dwordx4 v30, s[16:19], s77 offen offset:2048 lds
    v_writelane_b32 v9, s38, 4
    v_fmac_f32 v32, v76, v176
    v_fmac_f32 v33, v77, v177
    v_fmac_f32 v34, v78, v178
    v_fmac_f32 v35, v79, v179
    buffer_load_dwordx4 v31, s[16:19], s77 offen offset:3072 lds
    s_add_u32 s77, s77, 16384
    v_mfma_f32_16x16x32_bf16 v[76:79], v[100:103], v[140:143], 0
    v_mfma_f32_16x16x32_bf16 v[76:79], v[104:107], v[144:147], v[76:79]
    s_add_u32 m0, s80, 16384
    v_add_u32_dpp v25, v42, v1 row_newbcast:5 row_mask:0xf bank_mask:0x3
    v_add_u32_dpp v25, v42, v1 row_newbcast:13 row_mask:0xf bank_mask:0xc
    buffer_load_dwordx4 v25, s[12:15], 0 offen offset:0 lds
    v_fmac_f32 v32, v80, v180
    v_fmac_f32 v33, v81, v181
    v_fmac_f32 v34, v82, v182
    v_fmac_f32 v35, v83, v183
    v_add_u32_dpp v26, v46, v1 row_newbcast:5 row_mask:0xf bank_mask:0x3
    v_add_u32_dpp v26, v46, v1 row_newbcast:13 row_mask:0xf bank_mask:0xc
    buffer_load_dwordx4 v26, s[28:31], 0 offen offset:2048 lds
    v_mfma_f32_16x16x32_bf16 v[80:83], v[92:95], v[108:111], 0
    v_mfma_f32_16x16x32_bf16 v[80:83], v[96:99], v[112:115], v[80:83]
    v_lshlrev_b32 v56, 7, v56
    v_fmac_f32 v32, v72, v184
    v_fmac_f32 v33, v73, v185
    v_fmac_f32 v34, v74, v186
    v_fmac_f32 v35, v75, v187
    ds_read_b128 v[116:119], v4 offset:8192
    ds_read_b128 v[120:123], v5 offset:8192
    s_mov_b64 exec, s[60:61]
    ds_read_b128 v[156:159], v22 offset:8192
    ds_read_b128 v[160:163], v23 offset:8192
    s_mov_b64 exec, -1
    s_waitcnt vmcnt(18)
    s_barrier
    s_waitcnt lgkmcnt(0)
    s_add_u32 m0, s81, 0
    s_nop 0
    buffer_load_dwordx4 v28, s[16:19], s77 offen offset:0 lds
    v_mfma_f32_16x16x32_bf16 v[72:75], v[148:151], v[148:151], 0
    v_mfma_f32_16x16x32_bf16 v[72:75], v[152:155], v[152:155], v[72:75]
    buffer_load_dwordx4 v29, s[16:19], s77 offen offset:1024 lds
    v_fmac_f32 v32, v76, v188
    v_fmac_f32 v33, v77, v189
    v_fmac_f32 v34, v78, v190
    v_fmac_f32 v35, v79, v191
    s_add_u32 m0, s82, 8192
    v_add_u32_dpp v27, v36, v2 row_newbcast:6 row_mask:0xf bank_mask:0x3
    v_add_u32_dpp v27, v36, v2 row_newbcast:14 row_mask:0xf bank_mask:0xc
    buffer_load_dwordx4 v27, s[12:15], 0 offen offset:0 lds
    v_mfma_f32_16x16x32_bf16 v[76:79], v[84:87], v[116:119], 0
    v_mfma_f32_16x16x32_bf16 v[76:79], v[88:91], v[120:123], v[76:79]
    v_add_u32_dpp v24, v36, v3 row_newbcast:7 row_mask:0xf bank_mask:0x3
    v_add_u32_dpp v24, v36, v3 row_newbcast:15 row_mask:0xf bank_mask:0xc
    buffer_load_dwordx4 v24, s[24:27], 0 offen offset:1024 lds
    v_fmac_f32 v32, v80, v192
    v_fmac_f32 v33, v81, v193
    v_fmac_f32 v34, v82, v194
    v_fmac_f32 v35, v83, v195
    s_add_u32 m0, s81, 0
    s_nop 0
    buffer_load_dwordx4 v30, s[16:19], s77 offen offset:2048 lds
    s_mov_b64 exec, s[36:37]
    v_mov_b64 v[140:141], v[108:109]
    v_mov_b64 v[142:143], v[110:111]
    v_mov_b64 v[144:145], v[112:113]
    v_mov_b64 v[146:147], v[114:115]
    s_mov_b64 exec, -1
    buffer_load_dwordx4 v31, s[16:19], s77 offen offset:3072 lds
    s_add_u32 s77, s77, 16384
    v_mfma_f32_16x16x32_bf16 v[80:83], v[100:103], v[108:111], 0
    v_mfma_f32_16x16x32_bf16 v[80:83], v[104:107], v[112:115], v[80:83]
    s_add_u32 m0, s80, 20480
    v_add_u32_dpp v25, v50, v1 row_newbcast:5 row_mask:0xf bank_mask:0x3
    v_add_u32_dpp v25, v50, v1 row_newbcast:13 row_mask:0xf bank_mask:0xc
    buffer_load_dwordx4 v25, s[12:15], 0 offen offset:0 lds
    v_fmac_f32 v32, v72, v196
    v_fmac_f32 v33, v73, v197
    v_fmac_f32 v34, v74, v198
    v_fmac_f32 v35, v75, v199
    v_add_u32_dpp v26, v54, v1 row_newbcast:5 row_mask:0xf bank_mask:0x3
    v_add_u32_dpp v26, v54, v1 row_newbcast:13 row_mask:0xf bank_mask:0xc
    buffer_load_dwordx4 v26, s[28:31], 0 offen offset:2048 lds
    v_mfma_f32_16x16x32_bf16 v[72:75], v[92:95], v[116:119], 0
    v_mfma_f32_16x16x32_bf16 v[72:75], v[96:99], v[120:123], v[72:75]
    s_add_u32 m0, s82, 10240
    v_add_u32_dpp v27, v37, v2 row_newbcast:4 row_mask:0xf bank_mask:0x3
    v_add_u32_dpp v27, v37, v2 row_newbcast:12 row_mask:0xf bank_mask:0xc
    s_mov_b32 exec_hi, 0
    buffer_load_dwordx4 v27, s[12:15], 0 offen offset:0 lds
    s_mov_b32 exec_hi, -1
    v_fmac_f32 v32, v76, v200
    v_fmac_f32 v33, v77, v201
    v_fmac_f32 v34, v78, v202
    v_fmac_f32 v35, v79, v203
    v_lshlrev_b32 v57, 7, v57
    ds_read_b128 v[124:127], v4 offset:0
    ds_read_b128 v[128:131], v5 offset:0
    s_mov_b64 exec, s[62:63]
    ds_read_b128 v[156:159], v22 offset:0
    ds_read_b128 v[160:163], v23 offset:0
    s_mov_b64 exec, -1
    s_waitcnt vmcnt(17)
    s_barrier
    s_waitcnt lgkmcnt(0)
    s_add_u32 m0, s81, 16384
    s_nop 0
    buffer_load_dwordx4 v28, s[16:19], s77 offen offset:0 lds
    v_mfma_f32_16x16x32_bf16 v[76:79], v[84:87], v[124:127], 0
    v_mfma_f32_16x16x32_bf16 v[76:79], v[88:91], v[128:131], v[76:79]
    buffer_load_dwordx4 v29, s[16:19], s77 offen offset:1024 lds
    v_fmac_f32 v32, v80, v204
    v_fmac_f32 v33, v81, v205
    v_fmac_f32 v34, v82, v206
    v_fmac_f32 v35, v83, v207
    s_add_u32 m0, s82, 0
    v_add_u32_dpp v24, v37, v2 row_newbcast:0 row_mask:0xf bank_mask:0x3
    v_add_u32_dpp v24, v37, v2 row_newbcast:8 row_mask:0xf bank_mask:0xc
    buffer_load_dwordx4 v24, s[12:15], 0 offen offset:0 lds
    v_mfma_f32_16x16x32_bf16 v[80:83], v[108:111], v[140:143], 0
    v_mfma_f32_16x16x32_bf16 v[80:83], v[112:115], v[144:147], v[80:83]
    v_add_u32_dpp v25, v37, v3 row_newbcast:1 row_mask:0xf bank_mask:0x3
    v_add_u32_dpp v25, v37, v3 row_newbcast:9 row_mask:0xf bank_mask:0xc
    buffer_load_dwordx4 v25, s[24:27], 0 offen offset:1024 lds
    v_fmac_f32 v32, v72, v208
    v_fmac_f32 v33, v73, v209
    v_fmac_f32 v34, v74, v210
    v_fmac_f32 v35, v75, v211
    s_add_u32 m0, s81, 16384
    s_nop 0
    buffer_load_dwordx4 v30, s[16:19], s77 offen offset:2048 lds
    v_mfma_f32_16x16x32_bf16 v[72:75], v[92:95], v[124:127], 0
    v_mfma_f32_16x16x32_bf16 v[72:75], v[96:99], v[128:131], v[72:75]
    buffer_load_dwordx4 v31, s[16:19], s77 offen offset:3072 lds
    s_add_u32 s77, s77, 16384
    v_fmac_f32 v32, v76, v212
    v_fmac_f32 v33, v77, v213
    v_fmac_f32 v34, v78, v214
    v_fmac_f32 v35, v79, v215
    s_add_u32 m0, s80, 32768
    v_add_u32_dpp v26, v43, v1 row_newbcast:5 row_mask:0xf bank_mask:0x3
    v_add_u32_dpp v26, v43, v1 row_newbcast:13 row_mask:0xf bank_mask:0xc
    buffer_load_dwordx4 v26, s[12:15], 0 offen offset:0 lds
    v_mfma_f32_16x16x32_bf16 v[76:79], v[156:159], v[156:159], 0
    v_mfma_f32_16x16x32_bf16 v[76:79], v[160:163], v[160:163], v[76:79]
    v_add_u32_dpp v27, v47, v1 row_newbcast:5 row_mask:0xf bank_mask:0x3
    v_add_u32_dpp v27, v47, v1 row_newbcast:13 row_mask:0xf bank_mask:0xc
    buffer_load_dwordx4 v27, s[28:31], 0 offen offset:2048 lds
    v_fmac_f32 v32, v80, v216
    v_fmac_f32 v33, v81, v217
    v_fmac_f32 v34, v82, v218
    v_fmac_f32 v35, v83, v219
    v_lshlrev_b32 v58, 7, v58
    ds_read_b128 v[84:87], v4 offset:2048
    ds_read_b128 v[88:91], v5 offset:2048
    s_mov_b64 exec, s[60:61]
    ds_read_b128 v[148:151], v22 offset:2048
    ds_read_b128 v[152:155], v23 offset:2048
    s_mov_b64 exec, -1
    s_waitcnt vmcnt(8)
    s_mov_b64 exec, s[60:61]
    ds_read_b128 v[132:135], v4 offset:10240
    ds_read_b128 v[136:139], v5 offset:10240
    s_mov_b64 exec, s[64:65]
    ds_read_b128 v[156:159], v22 offset:10240
    ds_read_b128 v[160:163], v23 offset:10240
    s_mov_b64 exec, -1
    s_barrier
    s_waitcnt lgkmcnt(0)
    s_add_u32 m0, s81, 32768
    s_nop 0
    buffer_load_dwordx4 v28, s[16:19], s77 offen offset:0 lds
    v_mfma_f32_16x16x32_bf16 v[80:83], v[100:103], v[116:119], 0
    v_mfma_f32_16x16x32_bf16 v[80:83], v[104:107], v[120:123], v[80:83]
    buffer_load_dwordx4 v29, s[16:19], s77 offen offset:1024 lds
    v_fmac_f32 v32, v72, v220
    v_fmac_f32 v33, v73, v221
    v_fmac_f32 v34, v74, v222
    v_fmac_f32 v35, v75, v223
    s_add_u32 m0, s82, 2048
    v_add_u32_dpp v24, v37, v2 row_newbcast:2 row_mask:0xf bank_mask:0x3
    v_add_u32_dpp v24, v37, v2 row_newbcast:10 row_mask:0xf bank_mask:0xc
    buffer_load_dwordx4 v24, s[12:15], 0 offen offset:0 lds
    s_mov_b64 exec, s[36:37]
    v_mov_b64 v[140:141], v[116:117]
    v_mov_b64 v[142:143], v[118:119]
    v_mov_b64 v[144:145], v[120:121]
    v_mov_b64 v[146:147], v[122:123]
    s_mov_b64 exec, -1
    v_add_u32_dpp v25, v37, v3 row_newbcast:3 row_mask:0xf bank_mask:0x3
    v_add_u32_dpp v25, v37, v3 row_newbcast:11 row_mask:0xf bank_mask:0xc
    buffer_load_dwordx4 v25, s[24:27], 0 offen offset:1024 lds
    v_mfma_f32_16x16x32_bf16 v[72:75], v[108:111], v[116:119], 0
    v_mfma_f32_16x16x32_bf16 v[72:75], v[112:115], v[120:123], v[72:75]
    s_add_u32 m0, s81, 32768
    s_nop 0
    buffer_load_dwordx4 v30, s[16:19], s77 offen offset:2048 lds
    v_fmac_f32 v32, v76, v224
    v_fmac_f32 v33, v77, v225
    v_fmac_f32 v34, v78, v226
    v_fmac_f32 v35, v79, v227
    buffer_load_dwordx4 v31, s[16:19], s77 offen offset:3072 lds
    s_add_u32 s77, s77, 16384
    v_mfma_f32_16x16x32_bf16 v[76:79], v[100:103], v[124:127], 0
    v_mfma_f32_16x16x32_bf16 v[76:79], v[104:107], v[128:131], v[76:79]
    s_add_u32 m0, s80, 36864
    v_add_u32_dpp v26, v51, v1 row_newbcast:5 row_mask:0xf bank_mask:0x3
    v_add_u32_dpp v26, v51, v1 row_newbcast:13 row_mask:0xf bank_mask:0xc
    buffer_load_dwordx4 v26, s[12:15], 0 offen offset:0 lds
    v_fmac_f32 v32, v80, v228
    v_fmac_f32 v33, v81, v229
    v_fmac_f32 v34, v82, v230
    v_fmac_f32 v35, v83, v231
    v_add_u32_dpp v27, v55, v1 row_newbcast:5 row_mask:0xf bank_mask:0x3
    v_add_u32_dpp v27, v55, v1 row_newbcast:13 row_mask:0xf bank_mask:0xc
    buffer_load_dwordx4 v27, s[28:31], 0 offen offset:2048 lds
    v_mfma_f32_16x16x32_bf16 v[80:83], v[116:119], v[140:143], 0
    v_mfma_f32_16x16x32_bf16 v[80:83], v[120:123], v[144:147], v[80:83]
    s_movk_i32 s74, 12800
    buffer_load_dword v36, v8, s[8:11], s74 offen
    buffer_load_dword v37, v8, s[8:11], s74 offen offset:256
    v_fmac_f32 v32, v72, v232
    v_fmac_f32 v33, v73, v233
    v_fmac_f32 v34, v74, v234
    v_fmac_f32 v35, v75, v235
    v_lshlrev_b32 v59, 7, v59
    ds_read_b128 v[92:95], v4 offset:4096
    ds_read_b128 v[96:99], v5 offset:4096
    s_mov_b64 exec, s[62:63]
    ds_read_b128 v[148:151], v22 offset:4096
    ds_read_b128 v[152:155], v23 offset:4096
    s_mov_b64 exec, -1
    s_barrier
    s_waitcnt lgkmcnt(0)
    s_add_u32 m0, s81, 49152
    s_nop 0
    buffer_load_dwordx4 v28, s[16:19], s77 offen offset:0 lds
    v_mfma_f32_16x16x32_bf16 v[72:75], v[108:111], v[124:127], 0
    v_mfma_f32_16x16x32_bf16 v[72:75], v[112:115], v[128:131], v[72:75]
    buffer_load_dwordx4 v29, s[16:19], s77 offen offset:1024 lds
    v_fmac_f32 v32, v76, v236
    v_fmac_f32 v33, v77, v237
    v_fmac_f32 v34, v78, v238
    v_fmac_f32 v35, v79, v239
    v_lshlrev_b32 v38, 7, v38
    v_lshlrev_b32 v39, 7, v39
    s_nop 0
    s_add_u32 m0, s82, 4096
    v_add_u32_dpp v24, v38, v2 row_newbcast:0 row_mask:0xf bank_mask:0x3
    v_add_u32_dpp v24, v38, v2 row_newbcast:8 row_mask:0xf bank_mask:0xc
    buffer_load_dwordx4 v24, s[12:15], 0 offen offset:0 lds
    s_mov_b64 exec, s[36:37]
    v_mov_b64 v[140:141], v[124:125]
    v_mov_b64 v[142:143], v[126:127]
    v_mov_b64 v[144:145], v[128:129]
    v_mov_b64 v[146:147], v[130:131]
    s_mov_b64 exec, -1
    v_add_u32_dpp v25, v38, v3 row_newbcast:1 row_mask:0xf bank_mask:0x3
    v_add_u32_dpp v25, v38, v3 row_newbcast:9 row_mask:0xf bank_mask:0xc
    buffer_load_dwordx4 v25, s[24:27], 0 offen offset:1024 lds
    v_mfma_f32_16x16x32_bf16 v[76:79], v[116:119], v[124:127], 0
    v_mfma_f32_16x16x32_bf16 v[76:79], v[120:123], v[128:131], v[76:79]
    s_add_u32 m0, s81, 49152
    s_nop 0
    buffer_load_dwordx4 v30, s[16:19], s77 offen offset:2048 lds
    v_fmac_f32 v32, v80, v240
    v_fmac_f32 v33, v81, v241
    v_fmac_f32 v34, v82, v242
    v_fmac_f32 v35, v83, v243
    buffer_load_dwordx4 v31, s[16:19], s77 offen offset:3072 lds
    s_add_u32 s77, s77, 16384
    v_mfma_f32_16x16x32_bf16 v[80:83], v[124:127], v[140:143], 0
    v_mfma_f32_16x16x32_bf16 v[80:83], v[128:131], v[144:147], v[80:83]
    s_add_u32 m0, s80, 0
    v_add_u32_dpp v26, v40, v1 row_newbcast:6 row_mask:0xf bank_mask:0x3
    v_add_u32_dpp v26, v40, v1 row_newbcast:14 row_mask:0xf bank_mask:0xc
    buffer_load_dwordx4 v26, s[12:15], 0 offen offset:0 lds
    v_fmac_f32 v32, v72, v244
    v_fmac_f32 v33, v73, v245
    v_fmac_f32 v34, v74, v246
    v_fmac_f32 v35, v75, v247
    v_add_u32_dpp v27, v44, v1 row_newbcast:6 row_mask:0xf bank_mask:0x3
    v_add_u32_dpp v27, v44, v1 row_newbcast:14 row_mask:0xf bank_mask:0xc
    buffer_load_dwordx4 v27, s[28:31], 0 offen offset:2048 lds
    s_mov_b64 exec, s[36:37]
    v_mov_b64 v[132:133], v[84:85]
    v_mov_b64 v[134:135], v[86:87]
    v_mov_b64 v[136:137], v[88:89]
    v_mov_b64 v[138:139], v[90:91]
    s_mov_b64 exec, -1
    v_lshlrev_b32 v60, 7, v60
    ds_read_b128 v[100:103], v4 offset:6144
    ds_read_b128 v[104:107], v5 offset:6144
    s_mov_b64 exec, s[64:65]
    ds_read_b128 v[148:151], v22 offset:6144
    ds_read_b128 v[152:155], v23 offset:6144
    s_mov_b64 exec, -1
    s_waitcnt vmcnt(20)
    s_barrier
    s_waitcnt lgkmcnt(0)
    s_add_u32 m0, s81, 0
    s_nop 0
    buffer_load_dwordx4 v28, s[16:19], s77 offen offset:0 lds
    v_mfma_f32_16x16x32_bf16 v[72:75], v[84:87], v[132:135], 0
    v_mfma_f32_16x16x32_bf16 v[72:75], v[88:91], v[136:139], v[72:75]
    buffer_load_dwordx4 v29, s[16:19], s77 offen offset:1024 lds
    v_fmac_f32 v32, v76, v248
    v_fmac_f32 v33, v77, v249
    v_fmac_f32 v34, v78, v250
    v_fmac_f32 v35, v79, v251
    s_add_u32 m0, s82, 6144
    v_add_u32_dpp v24, v38, v2 row_newbcast:2 row_mask:0xf bank_mask:0x3
    v_add_u32_dpp v24, v38, v2 row_newbcast:10 row_mask:0xf bank_mask:0xc
    buffer_load_dwordx4 v24, s[12:15], 0 offen offset:0 lds
    s_mov_b64 exec, s[36:37]
    v_mov_b64 v[132:133], v[92:93]
    v_mov_b64 v[134:135], v[94:95]
    v_mov_b64 v[136:137], v[96:97]
    v_mov_b64 v[138:139], v[98:99]
    s_mov_b64 exec, -1
    v_add_u32_dpp v25, v38, v3 row_newbcast:3 row_mask:0xf bank_mask:0x3
    v_add_u32_dpp v25, v38, v3 row_newbcast:11 row_mask:0xf bank_mask:0xc
    buffer_load_dwordx4 v25, s[24:27], 0 offen offset:1024 lds
    v_mfma_f32_16x16x32_bf16 v[76:79], v[84:87], v[92:95], 0
    v_mfma_f32_16x16x32_bf16 v[76:79], v[88:91], v[96:99], v[76:79]
    s_add_u32 m0, s81, 0
    s_nop 0
    buffer_load_dwordx4 v30, s[16:19], s77 offen offset:2048 lds
    v_fmac_f32 v32, v80, v252
    v_fmac_f32 v33, v81, v253
    v_fmac_f32 v34, v82, v254
    v_fmac_f32 v35, v83, v255
    v_add_f32 v12, v32, v33
    v_add_f32 v13, v34, v35
    v_add_f32 v12, v12, v13
    buffer_load_dwordx4 v31, s[16:19], s77 offen offset:3072 lds
    s_add_u32 s77, s77, 16384
    v_add_f32_dpp v12, v12, v12 row_shr:1 row_mask:0xf bank_mask:0xf bound_ctrl:0
    v_mfma_f32_16x16x32_bf16 v[80:83], v[92:95], v[132:135], 0
    v_mfma_f32_16x16x32_bf16 v[80:83], v[96:99], v[136:139], v[80:83]
    s_add_u32 m0, s80, 4096
    v_add_u32_dpp v26, v48, v1 row_newbcast:6 row_mask:0xf bank_mask:0x3
    v_add_u32_dpp v26, v48, v1 row_newbcast:14 row_mask:0xf bank_mask:0xc
    buffer_load_dwordx4 v26, s[12:15], 0 offen offset:0 lds
    v_add_f32_dpp v12, v12, v12 row_shr:2 row_mask:0xf bank_mask:0xf bound_ctrl:0
    v_mul_f32 v32, v72, v164
    v_mul_f32 v33, v73, v165
    v_mul_f32 v34, v74, v166
    v_mul_f32 v35, v75, v167
    v_add_u32_dpp v27, v52, v1 row_newbcast:6 row_mask:0xf bank_mask:0x3
    v_add_u32_dpp v27, v52, v1 row_newbcast:14 row_mask:0xf bank_mask:0xc
    buffer_load_dwordx4 v27, s[28:31], 0 offen offset:2048 lds
    v_add_f32_dpp v12, v12, v12 row_shr:4 row_mask:0xf bank_mask:0xf bound_ctrl:0
    v_mfma_f32_16x16x32_bf16 v[72:75], v[84:87], v[100:103], 0
    v_mfma_f32_16x16x32_bf16 v[72:75], v[88:91], v[104:107], v[72:75]
    v_lshlrev_b32 v61, 7, v61
    v_add_f32_dpp v12, v12, v12 row_shr:8 row_mask:0xf bank_mask:0xf bound_ctrl:0
    v_fmac_f32 v32, v76, v168
    v_fmac_f32 v33, v77, v169
    v_fmac_f32 v34, v78, v170
    v_fmac_f32 v35, v79, v171
    v_add_f32_dpp v12, v12, v12 row_bcast:15 row_mask:0xa bank_mask:0xf
    ds_read_b128 v[108:111], v4 offset:8192
    ds_read_b128 v[112:115], v5 offset:8192
    s_mov_b64 exec, s[66:67]
    ds_read_b128 v[148:151], v22 offset:8192
    ds_read_b128 v[152:155], v23 offset:8192
    s_mov_b64 exec, -1
    s_waitcnt vmcnt(18)
    s_barrier
    s_waitcnt lgkmcnt(0)
    s_add_u32 m0, s81, 16384
    s_nop 0
    buffer_load_dwordx4 v28, s[16:19], s77 offen offset:0 lds
    s_mov_b64 exec, s[36:37]
    v_mov_b64 v[132:133], v[100:101]
    v_mov_b64 v[134:135], v[102:103]
    v_mov_b64 v[136:137], v[104:105]
    v_mov_b64 v[138:139], v[106:107]
    s_mov_b64 exec, -1
    buffer_load_dwordx4 v29, s[16:19], s77 offen offset:1024 lds
    v_add_f32_dpp v12, v12, v12 row_bcast:31 row_mask:0xc bank_mask:0xf
    v_mfma_f32_16x16x32_bf16 v[76:79], v[92:95], v[100:103], 0
    v_mfma_f32_16x16x32_bf16 v[76:79], v[96:99], v[104:107], v[76:79]
    s_add_u32 m0, s82, 8192
    v_add_u32_dpp v24, v38, v2 row_newbcast:4 row_mask:0xf bank_mask:0x3
    v_add_u32_dpp v24, v38, v2 row_newbcast:12 row_mask:0xf bank_mask:0xc
    buffer_load_dwordx4 v24, s[12:15], 0 offen offset:0 lds
    v_readlane_b32 s38, v12, 63
    v_fmac_f32 v32, v80, v172
    v_fmac_f32 v33, v81, v173
    v_fmac_f32 v34, v82, v174
    v_fmac_f32 v35, v83, v175
    v_add_u32_dpp v25, v38, v3 row_newbcast:5 row_mask:0xf bank_mask:0x3
    v_add_u32_dpp v25, v38, v3 row_newbcast:13 row_mask:0xf bank_mask:0xc
    buffer_load_dwordx4 v25, s[24:27], 0 offen offset:1024 lds
    v_writelane_b32 v9, s38, 5
    v_mfma_f32_16x16x32_bf16 v[80:83], v[84:87], v[108:111], 0
    v_mfma_f32_16x16x32_bf16 v[80:83], v[88:91], v[112:115], v[80:83]
    s_add_u32 m0, s81, 16384
    s_nop 0
    buffer_load_dwordx4 v30, s[16:19], s77 offen offset:2048 lds
    v_fmac_f32 v32, v72, v176
    v_fmac_f32 v33, v73, v177
    v_fmac_f32 v34, v74, v178
    v_fmac_f32 v35, v75, v179
    buffer_load_dwordx4 v31, s[16:19], s77 offen offset:3072 lds
    s_add_u32 s77, s77, 16384
    v_mfma_f32_16x16x32_bf16 v[72:75], v[100:103], v[132:135], 0
    v_mfma_f32_16x16x32_bf16 v[72:75], v[104:107], v[136:139], v[72:75]
    s_add_u32 m0, s80, 16384
    v_add_u32_dpp v26, v41, v1 row_newbcast:6 row_mask:0xf bank_mask:0x3
    v_add_u32_dpp v26, v41, v1 row_newbcast:14 row_mask:0xf bank_mask:0xc
    buffer_load_dwordx4 v26, s[12:15], 0 offen offset:0 lds
    v_fmac_f32 v32, v76, v180
    v_fmac_f32 v33, v77, v181
    v_fmac_f32 v34, v78, v182
    v_fmac_f32 v35, v79, v183
    v_add_u32_dpp v27, v45, v1 row_newbcast:6 row_mask:0xf bank_mask:0x3
    v_add_u32_dpp v27, v45, v1 row_newbcast:14 row_mask:0xf bank_mask:0xc
    buffer_load_dwordx4 v27, s[28:31], 0 offen offset:2048 lds
    v_mfma_f32_16x16x32_bf16 v[76:79], v[92:95], v[108:111], 0
    v_mfma_f32_16x16x32_bf16 v[76:79], v[96:99], v[112:115], v[76:79]
    v_lshlrev_b32 v62, 7, v62
    v_fmac_f32 v32, v80, v184
    v_fmac_f32 v33, v81, v185
    v_fmac_f32 v34, v82, v186
    v_fmac_f32 v35, v83, v187
    ds_read_b128 v[116:119], v4 offset:0
    ds_read_b128 v[120:123], v5 offset:0
    s_mov_b64 exec, s[60:61]
    ds_read_b128 v[156:159], v22 offset:0
    ds_read_b128 v[160:163], v23 offset:0
    s_mov_b64 exec, -1
    s_waitcnt vmcnt(18)
    s_barrier
    s_waitcnt lgkmcnt(0)
    s_add_u32 m0, s81, 32768
    s_nop 0
    buffer_load_dwordx4 v28, s[16:19], s77 offen offset:0 lds
    v_mfma_f32_16x16x32_bf16 v[80:83], v[148:151], v[148:151], 0
    v_mfma_f32_16x16x32_bf16 v[80:83], v[152:155], v[152:155], v[80:83]
    buffer_load_dwordx4 v29, s[16:19], s77 offen offset:1024 lds
    v_fmac_f32 v32, v72, v188
    v_fmac_f32 v33, v73, v189
    v_fmac_f32 v34, v74, v190
    v_fmac_f32 v35, v75, v191
    s_add_u32 m0, s82, 0
    v_add_u32_dpp v24, v38, v2 row_newbcast:6 row_mask:0xf bank_mask:0x3
    v_add_u32_dpp v24, v38, v2 row_newbcast:14 row_mask:0xf bank_mask:0xc
    buffer_load_dwordx4 v24, s[12:15], 0 offen offset:0 lds
    v_mfma_f32_16x16x32_bf16 v[72:75], v[84:87], v[116:119], 0
    v_mfma_f32_16x16x32_bf16 v[72:75], v[88:91], v[120:123], v[72:75]
    v_add_u32_dpp v25, v38, v3 row_newbcast:7 row_mask:0xf bank_mask:0x3
    v_add_u32_dpp v25, v38, v3 row_newbcast:15 row_mask:0xf bank_mask:0xc
    buffer_load_dwordx4 v25, s[24:27], 0 offen offset:1024 lds
    v_fmac_f32 v32, v76, v192
    v_fmac_f32 v33, v77, v193
    v_fmac_f32 v34, v78, v194
    v_fmac_f32 v35, v79, v195
    s_add_u32 m0, s81, 32768
    s_nop 0
    buffer_load_dwordx4 v30, s[16:19], s77 offen offset:2048 lds
    s_mov_b64 exec, s[36:37]
    v_mov_b64 v[132:133], v[108:109]
    v_mov_b64 v[134:135], v[110:111]
    v_mov_b64 v[136:137], v[112:113]
    v_mov_b64 v[138:139], v[114:115]
    s_mov_b64 exec, -1
    buffer_load_dwordx4 v31, s[16:19], s77 offen offset:3072 lds
    s_add_u32 s77, s77, 16384
    v_mfma_f32_16x16x32_bf16 v[76:79], v[100:103], v[108:111], 0
    v_mfma_f32_16x16x32_bf16 v[76:79], v[104:107], v[112:115], v[76:79]
    s_add_u32 m0, s80, 20480
    v_add_u32_dpp v26, v49, v1 row_newbcast:6 row_mask:0xf bank_mask:0x3
    v_add_u32_dpp v26, v49, v1 row_newbcast:14 row_mask:0xf bank_mask:0xc
    buffer_load_dwordx4 v26, s[12:15], 0 offen offset:0 lds
    v_fmac_f32 v32, v80, v196
    v_fmac_f32 v33, v81, v197
    v_fmac_f32 v34, v82, v198
    v_fmac_f32 v35, v83, v199
    v_add_u32_dpp v27, v53, v1 row_newbcast:6 row_mask:0xf bank_mask:0x3
    v_add_u32_dpp v27, v53, v1 row_newbcast:14 row_mask:0xf bank_mask:0xc
    buffer_load_dwordx4 v27, s[28:31], 0 offen offset:2048 lds
    v_mfma_f32_16x16x32_bf16 v[80:83], v[92:95], v[116:119], 0
    v_mfma_f32_16x16x32_bf16 v[80:83], v[96:99], v[120:123], v[80:83]
    s_add_u32 m0, s82, 10240
    v_add_u32_dpp v24, v39, v2 row_newbcast:4 row_mask:0xf bank_mask:0x3
    v_add_u32_dpp v24, v39, v2 row_newbcast:12 row_mask:0xf bank_mask:0xc
    s_mov_b32 exec_hi, 0
    buffer_load_dwordx4 v24, s[12:15], 0 offen offset:0 lds
    s_mov_b32 exec_hi, -1
    v_fmac_f32 v32, v72, v200
    v_fmac_f32 v33, v73, v201
    v_fmac_f32 v34, v74, v202
    v_fmac_f32 v35, v75, v203
    v_lshlrev_b32 v63, 7, v63
    ds_read_b128 v[124:127], v4 offset:2048
    ds_read_b128 v[128:131], v5 offset:2048
    s_mov_b64 exec, s[62:63]
    ds_read_b128 v[156:159], v22 offset:2048
    ds_read_b128 v[160:163], v23 offset:2048
    s_mov_b64 exec, -1
    s_waitcnt vmcnt(17)
    s_barrier
    s_waitcnt lgkmcnt(0)
    s_add_u32 m0, s81, 49152
    s_nop 0
    buffer_load_dwordx4 v28, s[16:19], s77 offen offset:0 lds
    v_mfma_f32_16x16x32_bf16 v[72:75], v[84:87], v[124:127], 0
    v_mfma_f32_16x16x32_bf16 v[72:75], v[88:91], v[128:131], v[72:75]
    buffer_load_dwordx4 v29, s[16:19], s77 offen offset:1024 lds
    v_fmac_f32 v32, v76, v204
    v_fmac_f32 v33, v77, v205
    v_fmac_f32 v34, v78, v206
    v_fmac_f32 v35, v79, v207
    s_add_u32 m0, s82, 2048
    v_add_u32_dpp v25, v39, v2 row_newbcast:0 row_mask:0xf bank_mask:0x3
    v_add_u32_dpp v25, v39, v2 row_newbcast:8 row_mask:0xf bank_mask:0xc
    buffer_load_dwordx4 v25, s[12:15], 0 offen offset:0 lds
    v_mfma_f32_16x16x32_bf16 v[76:79], v[108:111], v[132:135], 0
    v_mfma_f32_16x16x32_bf16 v[76:79], v[112:115], v[136:139], v[76:79]
    v_add_u32_dpp v26, v39, v3 row_newbcast:1 row_mask:0xf bank_mask:0x3
    v_add_u32_dpp v26, v39, v3 row_newbcast:9 row_mask:0xf bank_mask:0xc
    buffer_load_dwordx4 v26, s[24:27], 0 offen offset:1024 lds
    v_fmac_f32 v32, v80, v208
    v_fmac_f32 v33, v81, v209
    v_fmac_f32 v34, v82, v210
    v_fmac_f32 v35, v83, v211
    s_add_u32 m0, s81, 49152
    s_nop 0
    buffer_load_dwordx4 v30, s[16:19], s77 offen offset:2048 lds
    v_mfma_f32_16x16x32_bf16 v[80:83], v[92:95], v[124:127], 0
    v_mfma_f32_16x16x32_bf16 v[80:83], v[96:99], v[128:131], v[80:83]
    buffer_load_dwordx4 v31, s[16:19], s77 offen offset:3072 lds
    s_add_u32 s77, s77, 16384
    v_fmac_f32 v32, v72, v212
    v_fmac_f32 v33, v73, v213
    v_fmac_f32 v34, v74, v214
    v_fmac_f32 v35, v75, v215
    s_add_u32 m0, s80, 32768
    v_add_u32_dpp v27, v42, v1 row_newbcast:6 row_mask:0xf bank_mask:0x3
    v_add_u32_dpp v27, v42, v1 row_newbcast:14 row_mask:0xf bank_mask:0xc
    buffer_load_dwordx4 v27, s[12:15], 0 offen offset:0 lds
    v_mfma_f32_16x16x32_bf16 v[72:75], v[156:159], v[156:159], 0
    v_mfma_f32_16x16x32_bf16 v[72:75], v[160:163], v[160:163], v[72:75]
    v_add_u32_dpp v24, v46, v1 row_newbcast:6 row_mask:0xf bank_mask:0x3
    v_add_u32_dpp v24, v46, v1 row_newbcast:14 row_mask:0xf bank_mask:0xc
    buffer_load_dwordx4 v24, s[28:31], 0 offen offset:2048 lds
    v_fmac_f32 v32, v76, v216
    v_fmac_f32 v33, v77, v217
    v_fmac_f32 v34, v78, v218
    v_fmac_f32 v35, v79, v219
    v_lshlrev_b32 v64, 7, v64
    ds_read_b128 v[84:87], v4 offset:4096
    ds_read_b128 v[88:91], v5 offset:4096
    s_mov_b64 exec, s[60:61]
    ds_read_b128 v[148:151], v22 offset:4096
    ds_read_b128 v[152:155], v23 offset:4096
    s_mov_b64 exec, -1
    s_waitcnt vmcnt(8)
    s_mov_b64 exec, s[60:61]
    ds_read_b128 v[140:143], v4 offset:10240
    ds_read_b128 v[144:147], v5 offset:10240
    s_mov_b64 exec, s[64:65]
    ds_read_b128 v[156:159], v22 offset:10240
    ds_read_b128 v[160:163], v23 offset:10240
    s_mov_b64 exec, -1
    s_barrier
    s_waitcnt lgkmcnt(0)
    s_add_u32 m0, s81, 0
    s_nop 0
    buffer_load_dwordx4 v28, s[16:19], s77 offen offset:0 lds
    v_mfma_f32_16x16x32_bf16 v[76:79], v[100:103], v[116:119], 0
    v_mfma_f32_16x16x32_bf16 v[76:79], v[104:107], v[120:123], v[76:79]
    buffer_load_dwordx4 v29, s[16:19], s77 offen offset:1024 lds
    v_fmac_f32 v32, v80, v220
    v_fmac_f32 v33, v81, v221
    v_fmac_f32 v34, v82, v222
    v_fmac_f32 v35, v83, v223
    s_add_u32 m0, s82, 4096
    v_add_u32_dpp v25, v39, v2 row_newbcast:2 row_mask:0xf bank_mask:0x3
    v_add_u32_dpp v25, v39, v2 row_newbcast:10 row_mask:0xf bank_mask:0xc
    buffer_load_dwordx4 v25, s[12:15], 0 offen offset:0 lds
    s_mov_b64 exec, s[36:37]
    v_mov_b64 v[132:133], v[116:117]
    v_mov_b64 v[134:135], v[118:119]
    v_mov_b64 v[136:137], v[120:121]
    v_mov_b64 v[138:139], v[122:123]
    s_mov_b64 exec, -1
    v_add_u32_dpp v26, v39, v3 row_newbcast:3 row_mask:0xf bank_mask:0x3
    v_add_u32_dpp v26, v39, v3 row_newbcast:11 row_mask:0xf bank_mask:0xc
    buffer_load_dwordx4 v26, s[24:27], 0 offen offset:1024 lds
    v_mfma_f32_16x16x32_bf16 v[80:83], v[108:111], v[116:119], 0
    v_mfma_f32_16x16x32_bf16 v[80:83], v[112:115], v[120:123], v[80:83]
    s_add_u32 m0, s81, 0
    s_nop 0
    buffer_load_dwordx4 v30, s[16:19], s77 offen offset:2048 lds
    v_fmac_f32 v32, v72, v224
    v_fmac_f32 v33, v73, v225
    v_fmac_f32 v34, v74, v226
    v_fmac_f32 v35, v75, v227
    buffer_load_dwordx4 v31, s[16:19], s77 offen offset:3072 lds
    s_add_u32 s77, s77, 16384
    v_mfma_f32_16x16x32_bf16 v[72:75], v[100:103], v[124:127], 0
    v_mfma_f32_16x16x32_bf16 v[72:75], v[104:107], v[128:131], v[72:75]
    s_add_u32 m0, s80, 36864
    v_add_u32_dpp v27, v50, v1 row_newbcast:6 row_mask:0xf bank_mask:0x3
    v_add_u32_dpp v27, v50, v1 row_newbcast:14 row_mask:0xf bank_mask:0xc
    buffer_load_dwordx4 v27, s[12:15], 0 offen offset:0 lds
    v_fmac_f32 v32, v76, v228
    v_fmac_f32 v33, v77, v229
    v_fmac_f32 v34, v78, v230
    v_fmac_f32 v35, v79, v231
    v_add_u32_dpp v24, v54, v1 row_newbcast:6 row_mask:0xf bank_mask:0x3
    v_add_u32_dpp v24, v54, v1 row_newbcast:14 row_mask:0xf bank_mask:0xc
    buffer_load_dwordx4 v24, s[28:31], 0 offen offset:2048 lds
    v_mfma_f32_16x16x32_bf16 v[76:79], v[116:119], v[132:135], 0
    v_mfma_f32_16x16x32_bf16 v[76:79], v[120:123], v[136:139], v[76:79]
    s_movk_i32 s74, 14400
    buffer_load_dword v38, v8, s[8:11], s74 offen
    buffer_load_dword v39, v8, s[8:11], s74 offen offset:256
    v_fmac_f32 v32, v80, v232
    v_fmac_f32 v33, v81, v233
    v_fmac_f32 v34, v82, v234
    v_fmac_f32 v35, v83, v235
    v_lshlrev_b32 v65, 7, v65
    ds_read_b128 v[92:95], v4 offset:6144
    ds_read_b128 v[96:99], v5 offset:6144
    s_mov_b64 exec, s[62:63]
    ds_read_b128 v[148:151], v22 offset:6144
    ds_read_b128 v[152:155], v23 offset:6144
    s_mov_b64 exec, -1
    s_barrier
    s_waitcnt lgkmcnt(0)
    s_add_u32 m0, s81, 16384
    s_nop 0
    buffer_load_dwordx4 v28, s[16:19], s77 offen offset:0 lds
    v_mfma_f32_16x16x32_bf16 v[80:83], v[108:111], v[124:127], 0
    v_mfma_f32_16x16x32_bf16 v[80:83], v[112:115], v[128:131], v[80:83]
    buffer_load_dwordx4 v29, s[16:19], s77 offen offset:1024 lds
    v_fmac_f32 v32, v72, v236
    v_fmac_f32 v33, v73, v237
    v_fmac_f32 v34, v74, v238
    v_fmac_f32 v35, v75, v239
    v_lshlrev_b32 v36, 7, v36
    v_lshlrev_b32 v37, 7, v37
    s_nop 0
    s_add_u32 m0, s82, 6144
    v_add_u32_dpp v25, v36, v2 row_newbcast:0 row_mask:0xf bank_mask:0x3
    v_add_u32_dpp v25, v36, v2 row_newbcast:8 row_mask:0xf bank_mask:0xc
    buffer_load_dwordx4 v25, s[12:15], 0 offen offset:0 lds
    s_mov_b64 exec, s[36:37]
    v_mov_b64 v[132:133], v[124:125]
    v_mov_b64 v[134:135], v[126:127]
    v_mov_b64 v[136:137], v[128:129]
    v_mov_b64 v[138:139], v[130:131]
    s_mov_b64 exec, -1
    v_add_u32_dpp v26, v36, v3 row_newbcast:1 row_mask:0xf bank_mask:0x3
    v_add_u32_dpp v26, v36, v3 row_newbcast:9 row_mask:0xf bank_mask:0xc
    buffer_load_dwordx4 v26, s[24:27], 0 offen offset:1024 lds
    v_mfma_f32_16x16x32_bf16 v[72:75], v[116:119], v[124:127], 0
    v_mfma_f32_16x16x32_bf16 v[72:75], v[120:123], v[128:131], v[72:75]
    s_add_u32 m0, s81, 16384
    s_nop 0
    buffer_load_dwordx4 v30, s[16:19], s77 offen offset:2048 lds
    v_fmac_f32 v32, v76, v240
    v_fmac_f32 v33, v77, v241
    v_fmac_f32 v34, v78, v242
    v_fmac_f32 v35, v79, v243
    buffer_load_dwordx4 v31, s[16:19], s77 offen offset:3072 lds
    s_add_u32 s77, s77, 16384
    v_mfma_f32_16x16x32_bf16 v[76:79], v[124:127], v[132:135], 0
    v_mfma_f32_16x16x32_bf16 v[76:79], v[128:131], v[136:139], v[76:79]
    s_add_u32 m0, s80, 0
    v_add_u32_dpp v27, v43, v1 row_newbcast:6 row_mask:0xf bank_mask:0x3
    v_add_u32_dpp v27, v43, v1 row_newbcast:14 row_mask:0xf bank_mask:0xc
    buffer_load_dwordx4 v27, s[12:15], 0 offen offset:0 lds
    v_fmac_f32 v32, v80, v244
    v_fmac_f32 v33, v81, v245
    v_fmac_f32 v34, v82, v246
    v_fmac_f32 v35, v83, v247
    v_add_u32_dpp v24, v47, v1 row_newbcast:6 row_mask:0xf bank_mask:0x3
    v_add_u32_dpp v24, v47, v1 row_newbcast:14 row_mask:0xf bank_mask:0xc
    buffer_load_dwordx4 v24, s[28:31], 0 offen offset:2048 lds
    s_mov_b64 exec, s[36:37]
    v_mov_b64 v[140:141], v[84:85]
    v_mov_b64 v[142:143], v[86:87]
    v_mov_b64 v[144:145], v[88:89]
    v_mov_b64 v[146:147], v[90:91]
    s_mov_b64 exec, -1
    v_lshlrev_b32 v66, 7, v66
    ds_read_b128 v[100:103], v4 offset:8192
    ds_read_b128 v[104:107], v5 offset:8192
    s_mov_b64 exec, s[64:65]
    ds_read_b128 v[148:151], v22 offset:8192
    ds_read_b128 v[152:155], v23 offset:8192
    s_mov_b64 exec, -1
    s_waitcnt vmcnt(20)
    s_barrier
    s_waitcnt lgkmcnt(0)
    s_add_u32 m0, s81, 32768
    s_nop 0
    buffer_load_dwordx4 v28, s[16:19], s77 offen offset:0 lds
    v_mfma_f32_16x16x32_bf16 v[80:83], v[84:87], v[140:143], 0
    v_mfma_f32_16x16x32_bf16 v[80:83], v[88:91], v[144:147], v[80:83]
    buffer_load_dwordx4 v29, s[16:19], s77 offen offset:1024 lds
    v_fmac_f32 v32, v72, v248
    v_fmac_f32 v33, v73, v249
    v_fmac_f32 v34, v74, v250
    v_fmac_f32 v35, v75, v251
    s_add_u32 m0, s82, 8192
    v_add_u32_dpp v25, v36, v2 row_newbcast:2 row_mask:0xf bank_mask:0x3
    v_add_u32_dpp v25, v36, v2 row_newbcast:10 row_mask:0xf bank_mask:0xc
    buffer_load_dwordx4 v25, s[12:15], 0 offen offset:0 lds
    s_mov_b64 exec, s[36:37]
    v_mov_b64 v[140:141], v[92:93]
    v_mov_b64 v[142:143], v[94:95]
    v_mov_b64 v[144:145], v[96:97]
    v_mov_b64 v[146:147], v[98:99]
    s_mov_b64 exec, -1
    v_add_u32_dpp v26, v36, v3 row_newbcast:3 row_mask:0xf bank_mask:0x3
    v_add_u32_dpp v26, v36, v3 row_newbcast:11 row_mask:0xf bank_mask:0xc
    buffer_load_dwordx4 v26, s[24:27], 0 offen offset:1024 lds
    v_mfma_f32_16x16x32_bf16 v[72:75], v[84:87], v[92:95], 0
    v_mfma_f32_16x16x32_bf16 v[72:75], v[88:91], v[96:99], v[72:75]
    s_add_u32 m0, s81, 32768
    s_nop 0
    buffer_load_dwordx4 v30, s[16:19], s77 offen offset:2048 lds
    v_fmac_f32 v32, v76, v252
    v_fmac_f32 v33, v77, v253
    v_fmac_f32 v34, v78, v254
    v_fmac_f32 v35, v79, v255
    v_add_f32 v12, v32, v33
    v_add_f32 v13, v34, v35
    v_add_f32 v12, v12, v13
    buffer_load_dwordx4 v31, s[16:19], s77 offen offset:3072 lds
    s_add_u32 s77, s77, 16384
    v_add_f32_dpp v12, v12, v12 row_shr:1 row_mask:0xf bank_mask:0xf bound_ctrl:0
    v_mfma_f32_16x16x32_bf16 v[76:79], v[92:95], v[140:143], 0
    v_mfma_f32_16x16x32_bf16 v[76:79], v[96:99], v[144:147], v[76:79]
    s_add_u32 m0, s80, 4096
    v_add_u32_dpp v27, v51, v1 row_newbcast:6 row_mask:0xf bank_mask:0x3
    v_add_u32_dpp v27, v51, v1 row_newbcast:14 row_mask:0xf bank_mask:0xc
    buffer_load_dwordx4 v27, s[12:15], 0 offen offset:0 lds
    v_add_f32_dpp v12, v12, v12 row_shr:2 row_mask:0xf bank_mask:0xf bound_ctrl:0
    v_mul_f32 v32, v80, v164
    v_mul_f32 v33, v81, v165
    v_mul_f32 v34, v82, v166
    v_mul_f32 v35, v83, v167
    v_add_u32_dpp v24, v55, v1 row_newbcast:6 row_mask:0xf bank_mask:0x3
    v_add_u32_dpp v24, v55, v1 row_newbcast:14 row_mask:0xf bank_mask:0xc
    buffer_load_dwordx4 v24, s[28:31], 0 offen offset:2048 lds
    v_add_f32_dpp v12, v12, v12 row_shr:4 row_mask:0xf bank_mask:0xf bound_ctrl:0
    v_mfma_f32_16x16x32_bf16 v[80:83], v[84:87], v[100:103], 0
    v_mfma_f32_16x16x32_bf16 v[80:83], v[88:91], v[104:107], v[80:83]
    v_lshlrev_b32 v67, 7, v67
    v_add_f32_dpp v12, v12, v12 row_shr:8 row_mask:0xf bank_mask:0xf bound_ctrl:0
    v_fmac_f32 v32, v72, v168
    v_fmac_f32 v33, v73, v169
    v_fmac_f32 v34, v74, v170
    v_fmac_f32 v35, v75, v171
    v_add_f32_dpp v12, v12, v12 row_bcast:15 row_mask:0xa bank_mask:0xf
    ds_read_b128 v[108:111], v4 offset:0
    ds_read_b128 v[112:115], v5 offset:0
    s_mov_b64 exec, s[66:67]
    ds_read_b128 v[148:151], v22 offset:0
    ds_read_b128 v[152:155], v23 offset:0
    s_mov_b64 exec, -1
    s_waitcnt vmcnt(18)
    s_barrier
    s_waitcnt lgkmcnt(0)
    s_add_u32 m0, s81, 49152
    s_nop 0
    buffer_load_dwordx4 v28, s[16:19], s77 offen offset:0 lds
    s_mov_b64 exec, s[36:37]
    v_mov_b64 v[140:141], v[100:101]
    v_mov_b64 v[142:143], v[102:103]
    v_mov_b64 v[144:145], v[104:105]
    v_mov_b64 v[146:147], v[106:107]
    s_mov_b64 exec, -1
    buffer_load_dwordx4 v29, s[16:19], s77 offen offset:1024 lds
    v_add_f32_dpp v12, v12, v12 row_bcast:31 row_mask:0xc bank_mask:0xf
    v_mfma_f32_16x16x32_bf16 v[72:75], v[92:95], v[100:103], 0
    v_mfma_f32_16x16x32_bf16 v[72:75], v[96:99], v[104:107], v[72:75]
    s_add_u32 m0, s82, 0
    v_add_u32_dpp v25, v36, v2 row_newbcast:4 row_mask:0xf bank_mask:0x3
    v_add_u32_dpp v25, v36, v2 row_newbcast:12 row_mask:0xf bank_mask:0xc
    buffer_load_dwordx4 v25, s[12:15], 0 offen offset:0 lds
    v_readlane_b32 s38, v12, 63
    v_fmac_f32 v32, v76, v172
    v_fmac_f32 v33, v77, v173
    v_fmac_f32 v34, v78, v174
    v_fmac_f32 v35, v79, v175
    v_add_u32_dpp v26, v36, v3 row_newbcast:5 row_mask:0xf bank_mask:0x3
    v_add_u32_dpp v26, v36, v3 row_newbcast:13 row_mask:0xf bank_mask:0xc
    buffer_load_dwordx4 v26, s[24:27], 0 offen offset:1024 lds
    v_writelane_b32 v9, s38, 6
    v_mfma_f32_16x16x32_bf16 v[76:79], v[84:87], v[108:111], 0
    v_mfma_f32_16x16x32_bf16 v[76:79], v[88:91], v[112:115], v[76:79]
    s_add_u32 m0, s81, 49152
    s_nop 0
    buffer_load_dwordx4 v30, s[16:19], s77 offen offset:2048 lds
    v_fmac_f32 v32, v80, v176
    v_fmac_f32 v33, v81, v177
    v_fmac_f32 v34, v82, v178
    v_fmac_f32 v35, v83, v179
    buffer_load_dwordx4 v31, s[16:19], s77 offen offset:3072 lds
    s_add_u32 s77, s77, 16384
    v_mfma_f32_16x16x32_bf16 v[80:83], v[100:103], v[140:143], 0
    v_mfma_f32_16x16x32_bf16 v[80:83], v[104:107], v[144:147], v[80:83]
    s_add_u32 m0, s80, 16384
    v_add_u32_dpp v27, v40, v1 row_newbcast:7 row_mask:0xf bank_mask:0x3
    v_add_u32_dpp v27, v40, v1 row_newbcast:15 row_mask:0xf bank_mask:0xc
    buffer_load_dwordx4 v27, s[12:15], 0 offen offset:0 lds
    v_fmac_f32 v32, v72, v180
    v_fmac_f32 v33, v73, v181
    v_fmac_f32 v34, v74, v182
    v_fmac_f32 v35, v75, v183
    v_add_u32_dpp v24, v44, v1 row_newbcast:7 row_mask:0xf bank_mask:0x3
    v_add_u32_dpp v24, v44, v1 row_newbcast:15 row_mask:0xf bank_mask:0xc
    buffer_load_dwordx4 v24, s[28:31], 0 offen offset:2048 lds
    v_mfma_f32_16x16x32_bf16 v[72:75], v[92:95], v[108:111], 0
    v_mfma_f32_16x16x32_bf16 v[72:75], v[96:99], v[112:115], v[72:75]
    v_lshlrev_b32 v68, 7, v68
    v_fmac_f32 v32, v76, v184
    v_fmac_f32 v33, v77, v185
    v_fmac_f32 v34, v78, v186
    v_fmac_f32 v35, v79, v187
    ds_read_b128 v[116:119], v4 offset:2048
    ds_read_b128 v[120:123], v5 offset:2048
    s_mov_b64 exec, s[60:61]
    ds_read_b128 v[156:159], v22 offset:2048
    ds_read_b128 v[160:163], v23 offset:2048
    s_mov_b64 exec, -1
    s_waitcnt vmcnt(18)
    s_barrier
    s_waitcnt lgkmcnt(0)
    s_add_u32 m0, s81, 0
    s_nop 0
    buffer_load_dwordx4 v28, s[16:19], s77 offen offset:0 lds
    v_mfma_f32_16x16x32_bf16 v[76:79], v[148:151], v[148:151], 0
    v_mfma_f32_16x16x32_bf16 v[76:79], v[152:155], v[152:155], v[76:79]
    buffer_load_dwordx4 v29, s[16:19], s77 offen offset:1024 lds
    v_fmac_f32 v32, v80, v188
    v_fmac_f32 v33, v81, v189
    v_fmac_f32 v34, v82, v190
    v_fmac_f32 v35, v83, v191
    s_add_u32 m0, s82, 2048
    v_add_u32_dpp v25, v36, v2 row_newbcast:6 row_mask:0xf bank_mask:0x3
    v_add_u32_dpp v25, v36, v2 row_newbcast:14 row_mask:0xf bank_mask:0xc
    buffer_load_dwordx4 v25, s[12:15], 0 offen offset:0 lds
    v_mfma_f32_16x16x32_bf16 v[80:83], v[84:87], v[116:119], 0
    v_mfma_f32_16x16x32_bf16 v[80:83], v[88:91], v[120:123], v[80:83]
    v_add_u32_dpp v26, v36, v3 row_newbcast:7 row_mask:0xf bank_mask:0x3
    v_add_u32_dpp v26, v36, v3 row_newbcast:15 row_mask:0xf bank_mask:0xc
    buffer_load_dwordx4 v26, s[24:27], 0 offen offset:1024 lds
    v_fmac_f32 v32, v72, v192
    v_fmac_f32 v33, v73, v193
    v_fmac_f32 v34, v74, v194
    v_fmac_f32 v35, v75, v195
    s_add_u32 m0, s81, 0
    s_nop 0
    buffer_load_dwordx4 v30, s[16:19], s77 offen offset:2048 lds
    s_mov_b64 exec, s[36:37]
    v_mov_b64 v[140:141], v[108:109]
    v_mov_b64 v[142:143], v[110:111]
    v_mov_b64 v[144:145], v[112:113]
    v_mov_b64 v[146:147], v[114:115]
    s_mov_b64 exec, -1
    buffer_load_dwordx4 v31, s[16:19], s77 offen offset:3072 lds
    s_add_u32 s77, s77, 16384
    v_mfma_f32_16x16x32_bf16 v[72:75], v[100:103], v[108:111], 0
    v_mfma_f32_16x16x32_bf16 v[72:75], v[104:107], v[112:115], v[72:75]
    s_add_u32 m0, s80, 20480
    v_add_u32_dpp v27, v48, v1 row_newbcast:7 row_mask:0xf bank_mask:0x3
    v_add_u32_dpp v27, v48, v1 row_newbcast:15 row_mask:0xf bank_mask:0xc
    buffer_load_dwordx4 v27, s[12:15], 0 offen offset:0 lds
    v_fmac_f32 v32, v76, v196
    v_fmac_f32 v33, v77, v197
    v_fmac_f32 v34, v78, v198
    v_fmac_f32 v35, v79, v199
    v_add_u32_dpp v24, v52, v1 row_newbcast:7 row_mask:0xf bank_mask:0x3
    v_add_u32_dpp v24, v52, v1 row_newbcast:15 row_mask:0xf bank_mask:0xc
    buffer_load_dwordx4 v24, s[28:31], 0 offen offset:2048 lds
    v_mfma_f32_16x16x32_bf16 v[76:79], v[92:95], v[116:119], 0
    v_mfma_f32_16x16x32_bf16 v[76:79], v[96:99], v[120:123], v[76:79]
    s_add_u32 m0, s82, 10240
    v_add_u32_dpp v25, v37, v2 row_newbcast:4 row_mask:0xf bank_mask:0x3
    v_add_u32_dpp v25, v37, v2 row_newbcast:12 row_mask:0xf bank_mask:0xc
    s_mov_b32 exec_hi, 0
    buffer_load_dwordx4 v25, s[12:15], 0 offen offset:0 lds
    s_mov_b32 exec_hi, -1
    v_fmac_f32 v32, v80, v200
    v_fmac_f32 v33, v81, v201
    v_fmac_f32 v34, v82, v202
    v_fmac_f32 v35, v83, v203
    v_lshlrev_b32 v69, 7, v69
    ds_read_b128 v[124:127], v4 offset:4096
    ds_read_b128 v[128:131], v5 offset:4096
    s_mov_b64 exec, s[62:63]
    ds_read_b128 v[156:159], v22 offset:4096
    ds_read_b128 v[160:163], v23 offset:4096
    s_mov_b64 exec, -1
    s_waitcnt vmcnt(17)
    s_barrier
    s_waitcnt lgkmcnt(0)
    s_add_u32 m0, s81, 16384
    s_nop 0
    buffer_load_dwordx4 v28, s[16:19], s77 offen offset:0 lds
    v_mfma_f32_16x16x32_bf16 v[80:83], v[84:87], v[124:127], 0
    v_mfma_f32_16x16x32_bf16 v[80:83], v[88:91], v[128:131], v[80:83]
    buffer_load_dwordx4 v29, s[16:19], s77 offen offset:1024 lds
    v_fmac_f32 v32, v72, v204
    v_fmac_f32 v33, v73, v205
    v_fmac_f32 v34, v74, v206
    v_fmac_f32 v35, v75, v207
    s_add_u32 m0, s82, 4096
    v_add_u32_dpp v26, v37, v2 row_newbcast:0 row_mask:0xf bank_mask:0x3
    v_add_u32_dpp v26, v37, v2 row_newbcast:8 row_mask:0xf bank_mask:0xc
    buffer_load_dwordx4 v26, s[12:15], 0 offen offset:0 lds
    v_mfma_f32_16x16x32_bf16 v[72:75], v[108:111], v[140:143], 0
    v_mfma_f32_16x16x32_bf16 v[72:75], v[112:115], v[144:147], v[72:75]
    v_add_u32_dpp v27, v37, v3 row_newbcast:1 row_mask:0xf bank_mask:0x3
    v_add_u32_dpp v27, v37, v3 row_newbcast:9 row_mask:0xf bank_mask:0xc
    buffer_load_dwordx4 v27, s[24:27], 0 offen offset:1024 lds
    v_fmac_f32 v32, v76, v208
    v_fmac_f32 v33, v77, v209
    v_fmac_f32 v34, v78, v210
    v_fmac_f32 v35, v79, v211
    s_add_u32 m0, s81, 16384
    s_nop 0
    buffer_load_dwordx4 v30, s[16:19], s77 offen offset:2048 lds
    v_mfma_f32_16x16x32_bf16 v[76:79], v[92:95], v[124:127], 0
    v_mfma_f32_16x16x32_bf16 v[76:79], v[96:99], v[128:131], v[76:79]
    buffer_load_dwordx4 v31, s[16:19], s77 offen offset:3072 lds
    s_add_u32 s77, s77, 16384
    v_fmac_f32 v32, v80, v212
    v_fmac_f32 v33, v81, v213
    v_fmac_f32 v34, v82, v214
    v_fmac_f32 v35, v83, v215
    s_add_u32 m0, s80, 32768
    v_add_u32_dpp v24, v41, v1 row_newbcast:7 row_mask:0xf bank_mask:0x3
    v_add_u32_dpp v24, v41, v1 row_newbcast:15 row_mask:0xf bank_mask:0xc
    buffer_load_dwordx4 v24, s[12:15], 0 offen offset:0 lds
    v_mfma_f32_16x16x32_bf16 v[80:83], v[156:159], v[156:159], 0
    v_mfma_f32_16x16x32_bf16 v[80:83], v[160:163], v[160:163], v[80:83]
    v_add_u32_dpp v25, v45, v1 row_newbcast:7 row_mask:0xf bank_mask:0x3
    v_add_u32_dpp v25, v45, v1 row_newbcast:15 row_mask:0xf bank_mask:0xc
    buffer_load_dwordx4 v25, s[28:31], 0 offen offset:2048 lds
    v_fmac_f32 v32, v72, v216
    v_fmac_f32 v33, v73, v217
    v_fmac_f32 v34, v74, v218
    v_fmac_f32 v35, v75, v219
    v_lshlrev_b32 v70, 7, v70
    ds_read_b128 v[84:87], v4 offset:6144
    ds_read_b128 v[88:91], v5 offset:6144
    s_mov_b64 exec, s[60:61]
    ds_read_b128 v[148:151], v22 offset:6144
    ds_read_b128 v[152:155], v23 offset:6144
    s_mov_b64 exec, -1
    s_waitcnt vmcnt(8)
    s_mov_b64 exec, s[60:61]
    ds_read_b128 v[132:135], v4 offset:10240
    ds_read_b128 v[136:139], v5 offset:10240
    s_mov_b64 exec, s[64:65]
    ds_read_b128 v[156:159], v22 offset:10240
    ds_read_b128 v[160:163], v23 offset:10240
    s_mov_b64 exec, -1
    s_barrier
    s_waitcnt lgkmcnt(0)
    s_add_u32 m0, s81, 32768
    s_nop 0
    buffer_load_dwordx4 v28, s[16:19], s77 offen offset:0 lds
    v_mfma_f32_16x16x32_bf16 v[72:75], v[100:103], v[116:119], 0
    v_mfma_f32_16x16x32_bf16 v[72:75], v[104:107], v[120:123], v[72:75]
    buffer_load_dwordx4 v29, s[16:19], s77 offen offset:1024 lds
    v_fmac_f32 v32, v76, v220
    v_fmac_f32 v33, v77, v221
    v_fmac_f32 v34, v78, v222
    v_fmac_f32 v35, v79, v223
    s_add_u32 m0, s82, 6144
    v_add_u32_dpp v26, v37, v2 row_newbcast:2 row_mask:0xf bank_mask:0x3
    v_add_u32_dpp v26, v37, v2 row_newbcast:10 row_mask:0xf bank_mask:0xc
    buffer_load_dwordx4 v26, s[12:15], 0 offen offset:0 lds
    s_mov_b64 exec, s[36:37]
    v_mov_b64 v[140:141], v[116:117]
    v_mov_b64 v[142:143], v[118:119]
    v_mov_b64 v[144:145], v[120:121]
    v_mov_b64 v[146:147], v[122:123]
    s_mov_b64 exec, -1
    v_add_u32_dpp v27, v37, v3 row_newbcast:3 row_mask:0xf bank_mask:0x3
    v_add_u32_dpp v27, v37, v3 row_newbcast:11 row_mask:0xf bank_mask:0xc
    buffer_load_dwordx4 v27, s[24:27], 0 offen offset:1024 lds
    v_mfma_f32_16x16x32_bf16 v[76:79], v[108:111], v[116:119], 0
    v_mfma_f32_16x16x32_bf16 v[76:79], v[112:115], v[120:123], v[76:79]
    s_add_u32 m0, s81, 32768
    s_nop 0
    buffer_load_dwordx4 v30, s[16:19], s77 offen offset:2048 lds
    v_fmac_f32 v32, v80, v224
    v_fmac_f32 v33, v81, v225
    v_fmac_f32 v34, v82, v226
    v_fmac_f32 v35, v83, v227
    buffer_load_dwordx4 v31, s[16:19], s77 offen offset:3072 lds
    s_add_u32 s77, s77, 16384
    v_mfma_f32_16x16x32_bf16 v[80:83], v[100:103], v[124:127], 0
    v_mfma_f32_16x16x32_bf16 v[80:83], v[104:107], v[128:131], v[80:83]
    s_add_u32 m0, s80, 36864
    v_add_u32_dpp v24, v49, v1 row_newbcast:7 row_mask:0xf bank_mask:0x3
    v_add_u32_dpp v24, v49, v1 row_newbcast:15 row_mask:0xf bank_mask:0xc
    buffer_load_dwordx4 v24, s[12:15], 0 offen offset:0 lds
    v_fmac_f32 v32, v72, v228
    v_fmac_f32 v33, v73, v229
    v_fmac_f32 v34, v74, v230
    v_fmac_f32 v35, v75, v231
    v_add_u32_dpp v25, v53, v1 row_newbcast:7 row_mask:0xf bank_mask:0x3
    v_add_u32_dpp v25, v53, v1 row_newbcast:15 row_mask:0xf bank_mask:0xc
    buffer_load_dwordx4 v25, s[28:31], 0 offen offset:2048 lds
    v_mfma_f32_16x16x32_bf16 v[72:75], v[116:119], v[140:143], 0
    v_mfma_f32_16x16x32_bf16 v[72:75], v[120:123], v[144:147], v[72:75]
    s_movk_i32 s74, 16000
    buffer_load_dword v36, v8, s[8:11], s74 offen
    buffer_load_dword v37, v8, s[8:11], s74 offen offset:256
    v_fmac_f32 v32, v76, v232
    v_fmac_f32 v33, v77, v233
    v_fmac_f32 v34, v78, v234
    v_fmac_f32 v35, v79, v235
    v_lshlrev_b32 v71, 7, v71
    ds_read_b128 v[92:95], v4 offset:8192
    ds_read_b128 v[96:99], v5 offset:8192
    s_mov_b64 exec, s[62:63]
    ds_read_b128 v[148:151], v22 offset:8192
    ds_read_b128 v[152:155], v23 offset:8192
    s_mov_b64 exec, -1
    s_barrier
    s_waitcnt lgkmcnt(0)
    s_add_u32 m0, s81, 49152
    s_nop 0
    buffer_load_dwordx4 v28, s[16:19], s77 offen offset:0 lds
    v_mfma_f32_16x16x32_bf16 v[76:79], v[108:111], v[124:127], 0
    v_mfma_f32_16x16x32_bf16 v[76:79], v[112:115], v[128:131], v[76:79]
    buffer_load_dwordx4 v29, s[16:19], s77 offen offset:1024 lds
    v_fmac_f32 v32, v80, v236
    v_fmac_f32 v33, v81, v237
    v_fmac_f32 v34, v82, v238
    v_fmac_f32 v35, v83, v239
    v_lshlrev_b32 v38, 7, v38
    v_lshlrev_b32 v39, 7, v39
    s_nop 0
    s_add_u32 m0, s82, 8192
    v_add_u32_dpp v26, v38, v2 row_newbcast:0 row_mask:0xf bank_mask:0x3
    v_add_u32_dpp v26, v38, v2 row_newbcast:8 row_mask:0xf bank_mask:0xc
    buffer_load_dwordx4 v26, s[12:15], 0 offen offset:0 lds
    s_mov_b64 exec, s[36:37]
    v_mov_b64 v[140:141], v[124:125]
    v_mov_b64 v[142:143], v[126:127]
    v_mov_b64 v[144:145], v[128:129]
    v_mov_b64 v[146:147], v[130:131]
    s_mov_b64 exec, -1
    v_add_u32_dpp v27, v38, v3 row_newbcast:1 row_mask:0xf bank_mask:0x3
    v_add_u32_dpp v27, v38, v3 row_newbcast:9 row_mask:0xf bank_mask:0xc
    buffer_load_dwordx4 v27, s[24:27], 0 offen offset:1024 lds
    v_mfma_f32_16x16x32_bf16 v[80:83], v[116:119], v[124:127], 0
    v_mfma_f32_16x16x32_bf16 v[80:83], v[120:123], v[128:131], v[80:83]
    s_add_u32 m0, s81, 49152
    s_nop 0
    buffer_load_dwordx4 v30, s[16:19], s77 offen offset:2048 lds
    v_fmac_f32 v32, v72, v240
    v_fmac_f32 v33, v73, v241
    v_fmac_f32 v34, v74, v242
    v_fmac_f32 v35, v75, v243
    buffer_load_dwordx4 v31, s[16:19], s77 offen offset:3072 lds
    s_add_u32 s77, s77, 16384
    v_mfma_f32_16x16x32_bf16 v[72:75], v[124:127], v[140:143], 0
    v_mfma_f32_16x16x32_bf16 v[72:75], v[128:131], v[144:147], v[72:75]
    s_add_u32 m0, s80, 0
    v_add_u32_dpp v24, v42, v1 row_newbcast:7 row_mask:0xf bank_mask:0x3
    v_add_u32_dpp v24, v42, v1 row_newbcast:15 row_mask:0xf bank_mask:0xc
    buffer_load_dwordx4 v24, s[12:15], 0 offen offset:0 lds
    v_fmac_f32 v32, v76, v244
    v_fmac_f32 v33, v77, v245
    v_fmac_f32 v34, v78, v246
    v_fmac_f32 v35, v79, v247
    v_add_u32_dpp v25, v46, v1 row_newbcast:7 row_mask:0xf bank_mask:0x3
    v_add_u32_dpp v25, v46, v1 row_newbcast:15 row_mask:0xf bank_mask:0xc
    buffer_load_dwordx4 v25, s[28:31], 0 offen offset:2048 lds
    s_mov_b64 exec, s[36:37]
    v_mov_b64 v[132:133], v[84:85]
    v_mov_b64 v[134:135], v[86:87]
    v_mov_b64 v[136:137], v[88:89]
    v_mov_b64 v[138:139], v[90:91]
    s_mov_b64 exec, -1
    ds_read_b128 v[100:103], v4 offset:0
    ds_read_b128 v[104:107], v5 offset:0
    s_mov_b64 exec, s[64:65]
    ds_read_b128 v[148:151], v22 offset:0
    ds_read_b128 v[152:155], v23 offset:0
    s_mov_b64 exec, -1
    s_waitcnt vmcnt(20)
    s_barrier
    s_waitcnt lgkmcnt(0)
    s_add_u32 m0, s81, 0
    s_nop 0
    buffer_load_dwordx4 v28, s[16:19], s77 offen offset:0 lds
    v_mfma_f32_16x16x32_bf16 v[76:79], v[84:87], v[132:135], 0
    v_mfma_f32_16x16x32_bf16 v[76:79], v[88:91], v[136:139], v[76:79]
    buffer_load_dwordx4 v29, s[16:19], s77 offen offset:1024 lds
    v_fmac_f32 v32, v80, v248
    v_fmac_f32 v33, v81, v249
    v_fmac_f32 v34, v82, v250
    v_fmac_f32 v35, v83, v251
    s_add_u32 m0, s82, 0
    v_add_u32_dpp v26, v38, v2 row_newbcast:2 row_mask:0xf bank_mask:0x3
    v_add_u32_dpp v26, v38, v2 row_newbcast:10 row_mask:0xf bank_mask:0xc
    buffer_load_dwordx4 v26, s[12:15], 0 offen offset:0 lds
    s_mov_b64 exec, s[36:37]
    v_mov_b64 v[132:133], v[92:93]
    v_mov_b64 v[134:135], v[94:95]
    v_mov_b64 v[136:137], v[96:97]
    v_mov_b64 v[138:139], v[98:99]
    s_mov_b64 exec, -1
    v_add_u32_dpp v27, v38, v3 row_newbcast:3 row_mask:0xf bank_mask:0x3
    v_add_u32_dpp v27, v38, v3 row_newbcast:11 row_mask:0xf bank_mask:0xc
    buffer_load_dwordx4 v27, s[24:27], 0 offen offset:1024 lds
    v_mfma_f32_16x16x32_bf16 v[80:83], v[84:87], v[92:95], 0
    v_mfma_f32_16x16x32_bf16 v[80:83], v[88:91], v[96:99], v[80:83]
    s_add_u32 m0, s81, 0
    s_nop 0
    buffer_load_dwordx4 v30, s[16:19], s77 offen offset:2048 lds
    v_fmac_f32 v32, v72, v252
    v_fmac_f32 v33, v73, v253
    v_fmac_f32 v34, v74, v254
    v_fmac_f32 v35, v75, v255
    v_add_f32 v12, v32, v33
    v_add_f32 v13, v34, v35
    v_add_f32 v12, v12, v13
    v_mfma_f32_16x16x32_bf16 v[72:75], v[92:95], v[132:135], 0
    v_mfma_f32_16x16x32_bf16 v[72:75], v[96:99], v[136:139], v[72:75]
    buffer_load_dwordx4 v31, s[16:19], s77 offen offset:3072 lds
    s_add_u32 s77, s77, 16384
    v_add_f32_dpp v12, v12, v12 row_shr:1 row_mask:0xf bank_mask:0xf bound_ctrl:0
    v_mul_f32 v32, v76, v164
    v_mul_f32 v33, v77, v165
    v_mul_f32 v34, v78, v166
    v_mul_f32 v35, v79, v167
    s_add_u32 m0, s80, 4096
    v_add_u32_dpp v24, v50, v1 row_newbcast:7 row_mask:0xf bank_mask:0x3
    v_add_u32_dpp v24, v50, v1 row_newbcast:15 row_mask:0xf bank_mask:0xc
    buffer_load_dwordx4 v24, s[12:15], 0 offen offset:0 lds
    v_add_f32_dpp v12, v12, v12 row_shr:2 row_mask:0xf bank_mask:0xf bound_ctrl:0
    v_mfma_f32_16x16x32_bf16 v[76:79], v[84:87], v[100:103], 0
    v_mfma_f32_16x16x32_bf16 v[76:79], v[88:91], v[104:107], v[76:79]
    v_add_u32_dpp v25, v54, v1 row_newbcast:7 row_mask:0xf bank_mask:0x3
    v_add_u32_dpp v25, v54, v1 row_newbcast:15 row_mask:0xf bank_mask:0xc
    buffer_load_dwordx4 v25, s[28:31], 0 offen offset:2048 lds
    v_add_f32_dpp v12, v12, v12 row_shr:4 row_mask:0xf bank_mask:0xf bound_ctrl:0
    v_fmac_f32 v32, v80, v168
    v_fmac_f32 v33, v81, v169
    v_fmac_f32 v34, v82, v170
    v_fmac_f32 v35, v83, v171
    v_add_f32_dpp v12, v12, v12 row_shr:8 row_mask:0xf bank_mask:0xf bound_ctrl:0
    ds_read_b128 v[108:111], v4 offset:2048
    ds_read_b128 v[112:115], v5 offset:2048
    s_mov_b64 exec, s[66:67]
    ds_read_b128 v[148:151], v22 offset:2048
    ds_read_b128 v[152:155], v23 offset:2048
    s_mov_b64 exec, -1
    s_waitcnt vmcnt(18)
    s_barrier
    s_waitcnt lgkmcnt(0)
    s_add_u32 m0, s81, 16384
    s_nop 0
    buffer_load_dwordx4 v28, s[16:19], s77 offen offset:0 lds
    s_mov_b64 exec, s[36:37]
    v_mov_b64 v[132:133], v[100:101]
    v_mov_b64 v[134:135], v[102:103]
    v_mov_b64 v[136:137], v[104:105]
    v_mov_b64 v[138:139], v[106:107]
    s_mov_b64 exec, -1
    buffer_load_dwordx4 v29, s[16:19], s77 offen offset:1024 lds
    v_add_f32_dpp v12, v12, v12 row_bcast:15 row_mask:0xa bank_mask:0xf
    v_mfma_f32_16x16x32_bf16 v[80:83], v[92:95], v[100:103], 0
    v_mfma_f32_16x16x32_bf16 v[80:83], v[96:99], v[104:107], v[80:83]
    s_add_u32 m0, s82, 2048
    v_add_u32_dpp v26, v38, v2 row_newbcast:4 row_mask:0xf bank_mask:0x3
    v_add_u32_dpp v26, v38, v2 row_newbcast:12 row_mask:0xf bank_mask:0xc
    buffer_load_dwordx4 v26, s[12:15], 0 offen offset:0 lds
    v_add_f32_dpp v12, v12, v12 row_bcast:31 row_mask:0xc bank_mask:0xf
    v_fmac_f32 v32, v72, v172
    v_fmac_f32 v33, v73, v173
    v_fmac_f32 v34, v74, v174
    v_fmac_f32 v35, v75, v175
    v_add_u32_dpp v27, v38, v3 row_newbcast:5 row_mask:0xf bank_mask:0x3
    v_add_u32_dpp v27, v38, v3 row_newbcast:13 row_mask:0xf bank_mask:0xc
    buffer_load_dwordx4 v27, s[24:27], 0 offen offset:1024 lds
    v_readlane_b32 s38, v12, 63
    v_mfma_f32_16x16x32_bf16 v[72:75], v[84:87], v[108:111], 0
    v_mfma_f32_16x16x32_bf16 v[72:75], v[88:91], v[112:115], v[72:75]
    s_add_u32 m0, s81, 16384
    s_nop 0
    buffer_load_dwordx4 v30, s[16:19], s77 offen offset:2048 lds
    v_writelane_b32 v9, s38, 7
    v_fmac_f32 v32, v76, v176
    v_fmac_f32 v33, v77, v177
    v_fmac_f32 v34, v78, v178
    v_fmac_f32 v35, v79, v179
    v_mfma_f32_16x16x32_bf16 v[76:79], v[100:103], v[132:135], 0
    v_mfma_f32_16x16x32_bf16 v[76:79], v[104:107], v[136:139], v[76:79]
    buffer_load_dwordx4 v31, s[16:19], s77 offen offset:3072 lds
    s_add_u32 s77, s77, 16384
    v_fmac_f32 v32, v80, v180
    v_fmac_f32 v33, v81, v181
    v_fmac_f32 v34, v82, v182
    v_fmac_f32 v35, v83, v183
    s_add_u32 m0, s80, 16384
    v_add_u32_dpp v24, v43, v1 row_newbcast:7 row_mask:0xf bank_mask:0x3
    v_add_u32_dpp v24, v43, v1 row_newbcast:15 row_mask:0xf bank_mask:0xc
    buffer_load_dwordx4 v24, s[12:15], 0 offen offset:0 lds
    v_mfma_f32_16x16x32_bf16 v[80:83], v[92:95], v[108:111], 0
    v_mfma_f32_16x16x32_bf16 v[80:83], v[96:99], v[112:115], v[80:83]
    v_add_u32_dpp v25, v47, v1 row_newbcast:7 row_mask:0xf bank_mask:0x3
    v_add_u32_dpp v25, v47, v1 row_newbcast:15 row_mask:0xf bank_mask:0xc
    buffer_load_dwordx4 v25, s[28:31], 0 offen offset:2048 lds
    v_fmac_f32 v32, v72, v184
    v_fmac_f32 v33, v73, v185
    v_fmac_f32 v34, v74, v186
    v_fmac_f32 v35, v75, v187
    ds_read_b128 v[116:119], v4 offset:4096
    ds_read_b128 v[120:123], v5 offset:4096
    s_mov_b64 exec, s[60:61]
    ds_read_b128 v[156:159], v22 offset:4096
    ds_read_b128 v[160:163], v23 offset:4096
    s_mov_b64 exec, -1
    s_waitcnt vmcnt(18)
    s_barrier
    s_waitcnt lgkmcnt(0)
    s_add_u32 m0, s81, 32768
    s_nop 0
    buffer_load_dwordx4 v28, s[16:19], s77 offen offset:0 lds
    v_mfma_f32_16x16x32_bf16 v[72:75], v[148:151], v[148:151], 0
    v_mfma_f32_16x16x32_bf16 v[72:75], v[152:155], v[152:155], v[72:75]
    buffer_load_dwordx4 v29, s[16:19], s77 offen offset:1024 lds
    v_fmac_f32 v32, v76, v188
    v_fmac_f32 v33, v77, v189
    v_fmac_f32 v34, v78, v190
    v_fmac_f32 v35, v79, v191
    s_add_u32 m0, s82, 4096
    v_add_u32_dpp v26, v38, v2 row_newbcast:6 row_mask:0xf bank_mask:0x3
    v_add_u32_dpp v26, v38, v2 row_newbcast:14 row_mask:0xf bank_mask:0xc
    buffer_load_dwordx4 v26, s[12:15], 0 offen offset:0 lds
    v_mfma_f32_16x16x32_bf16 v[76:79], v[84:87], v[116:119], 0
    v_mfma_f32_16x16x32_bf16 v[76:79], v[88:91], v[120:123], v[76:79]
    v_add_u32_dpp v27, v38, v3 row_newbcast:7 row_mask:0xf bank_mask:0x3
    v_add_u32_dpp v27, v38, v3 row_newbcast:15 row_mask:0xf bank_mask:0xc
    buffer_load_dwordx4 v27, s[24:27], 0 offen offset:1024 lds
    v_fmac_f32 v32, v80, v192
    v_fmac_f32 v33, v81, v193
    v_fmac_f32 v34, v82, v194
    v_fmac_f32 v35, v83, v195
    s_add_u32 m0, s81, 32768
    s_nop 0
    buffer_load_dwordx4 v30, s[16:19], s77 offen offset:2048 lds
    s_mov_b64 exec, s[36:37]
    v_mov_b64 v[132:133], v[108:109]
    v_mov_b64 v[134:135], v[110:111]
    v_mov_b64 v[136:137], v[112:113]
    v_mov_b64 v[138:139], v[114:115]
    s_mov_b64 exec, -1
    buffer_load_dwordx4 v31, s[16:19], s77 offen offset:3072 lds
    s_add_u32 s77, s77, 16384
    v_mfma_f32_16x16x32_bf16 v[80:83], v[100:103], v[108:111], 0
    v_mfma_f32_16x16x32_bf16 v[80:83], v[104:107], v[112:115], v[80:83]
    s_add_u32 m0, s80, 20480
    v_add_u32_dpp v24, v51, v1 row_newbcast:7 row_mask:0xf bank_mask:0x3
    v_add_u32_dpp v24, v51, v1 row_newbcast:15 row_mask:0xf bank_mask:0xc
    buffer_load_dwordx4 v24, s[12:15], 0 offen offset:0 lds
    v_fmac_f32 v32, v72, v196
    v_fmac_f32 v33, v73, v197
    v_fmac_f32 v34, v74, v198
    v_fmac_f32 v35, v75, v199
    v_add_u32_dpp v25, v55, v1 row_newbcast:7 row_mask:0xf bank_mask:0x3
    v_add_u32_dpp v25, v55, v1 row_newbcast:15 row_mask:0xf bank_mask:0xc
    buffer_load_dwordx4 v25, s[28:31], 0 offen offset:2048 lds
    v_mfma_f32_16x16x32_bf16 v[72:75], v[92:95], v[116:119], 0
    v_mfma_f32_16x16x32_bf16 v[72:75], v[96:99], v[120:123], v[72:75]
    s_add_u32 m0, s82, 10240
    v_add_u32_dpp v26, v39, v2 row_newbcast:4 row_mask:0xf bank_mask:0x3
    v_add_u32_dpp v26, v39, v2 row_newbcast:12 row_mask:0xf bank_mask:0xc
    s_mov_b32 exec_hi, 0
    buffer_load_dwordx4 v26, s[12:15], 0 offen offset:0 lds
    s_mov_b32 exec_hi, -1
    v_fmac_f32 v32, v76, v200
    v_fmac_f32 v33, v77, v201
    v_fmac_f32 v34, v78, v202
    v_fmac_f32 v35, v79, v203
    ds_read_b128 v[124:127], v4 offset:6144
    ds_read_b128 v[128:131], v5 offset:6144
    s_mov_b64 exec, s[62:63]
    ds_read_b128 v[156:159], v22 offset:6144
    ds_read_b128 v[160:163], v23 offset:6144
    s_mov_b64 exec, -1
    s_waitcnt vmcnt(17)
    s_barrier
    s_waitcnt lgkmcnt(0)
    s_add_u32 m0, s81, 49152
    s_nop 0
    buffer_load_dwordx4 v28, s[16:19], s77 offen offset:0 lds
    v_mfma_f32_16x16x32_bf16 v[76:79], v[84:87], v[124:127], 0
    v_mfma_f32_16x16x32_bf16 v[76:79], v[88:91], v[128:131], v[76:79]
    buffer_load_dwordx4 v29, s[16:19], s77 offen offset:1024 lds
    v_fmac_f32 v32, v80, v204
    v_fmac_f32 v33, v81, v205
    v_fmac_f32 v34, v82, v206
    v_fmac_f32 v35, v83, v207
    s_add_u32 m0, s82, 6144
    v_add_u32_dpp v27, v39, v2 row_newbcast:0 row_mask:0xf bank_mask:0x3
    v_add_u32_dpp v27, v39, v2 row_newbcast:8 row_mask:0xf bank_mask:0xc
    buffer_load_dwordx4 v27, s[12:15], 0 offen offset:0 lds
    v_mfma_f32_16x16x32_bf16 v[80:83], v[108:111], v[132:135], 0
    v_mfma_f32_16x16x32_bf16 v[80:83], v[112:115], v[136:139], v[80:83]
    v_add_u32_dpp v24, v39, v3 row_newbcast:1 row_mask:0xf bank_mask:0x3
    v_add_u32_dpp v24, v39, v3 row_newbcast:9 row_mask:0xf bank_mask:0xc
    buffer_load_dwordx4 v24, s[24:27], 0 offen offset:1024 lds
    v_fmac_f32 v32, v72, v208
    v_fmac_f32 v33, v73, v209
    v_fmac_f32 v34, v74, v210
    v_fmac_f32 v35, v75, v211
    s_add_u32 m0, s81, 49152
    s_nop 0
    buffer_load_dwordx4 v30, s[16:19], s77 offen offset:2048 lds
    v_mfma_f32_16x16x32_bf16 v[72:75], v[92:95], v[124:127], 0
    v_mfma_f32_16x16x32_bf16 v[72:75], v[96:99], v[128:131], v[72:75]
    buffer_load_dwordx4 v31, s[16:19], s77 offen offset:3072 lds
    s_add_u32 s77, s77, 16384
    v_fmac_f32 v32, v76, v212
    v_fmac_f32 v33, v77, v213
    v_fmac_f32 v34, v78, v214
    v_fmac_f32 v35, v79, v215
    s_nop 1
    s_add_u32 m0, s80, 32768
    v_add_u32_dpp v25, v56, v1 row_newbcast:0 row_mask:0xf bank_mask:0x3
    v_add_u32_dpp v25, v56, v1 row_newbcast:8 row_mask:0xf bank_mask:0xc
    buffer_load_dwordx4 v25, s[12:15], 0 offen offset:0 lds
    v_mfma_f32_16x16x32_bf16 v[76:79], v[156:159], v[156:159], 0
    v_mfma_f32_16x16x32_bf16 v[76:79], v[160:163], v[160:163], v[76:79]
    v_add_u32_dpp v26, v60, v1 row_newbcast:0 row_mask:0xf bank_mask:0x3
    v_add_u32_dpp v26, v60, v1 row_newbcast:8 row_mask:0xf bank_mask:0xc
    buffer_load_dwordx4 v26, s[28:31], 0 offen offset:2048 lds
    v_fmac_f32 v32, v80, v216
    v_fmac_f32 v33, v81, v217
    v_fmac_f32 v34, v82, v218
    v_fmac_f32 v35, v83, v219
    ds_read_b128 v[84:87], v4 offset:8192
    ds_read_b128 v[88:91], v5 offset:8192
    s_mov_b64 exec, s[60:61]
    ds_read_b128 v[148:151], v22 offset:8192
    ds_read_b128 v[152:155], v23 offset:8192
    s_mov_b64 exec, -1
    s_waitcnt vmcnt(8)
    s_mov_b64 exec, s[60:61]
    ds_read_b128 v[140:143], v4 offset:10240
    ds_read_b128 v[144:147], v5 offset:10240
    s_mov_b64 exec, s[64:65]
    ds_read_b128 v[156:159], v22 offset:10240
    ds_read_b128 v[160:163], v23 offset:10240
    s_mov_b64 exec, -1
    s_barrier
    s_waitcnt lgkmcnt(0)
    s_add_u32 m0, s81, 0
    s_nop 0
    buffer_load_dwordx4 v28, s[16:19], s77 offen offset:0 lds
    v_mfma_f32_16x16x32_bf16 v[80:83], v[100:103], v[116:119], 0
    v_mfma_f32_16x16x32_bf16 v[80:83], v[104:107], v[120:123], v[80:83]
    buffer_load_dwordx4 v29, s[16:19], s77 offen offset:1024 lds
    v_fmac_f32 v32, v72, v220
    v_fmac_f32 v33, v73, v221
    v_fmac_f32 v34, v74, v222
    v_fmac_f32 v35, v75, v223
    s_add_u32 m0, s82, 8192
    v_add_u32_dpp v27, v39, v2 row_newbcast:2 row_mask:0xf bank_mask:0x3
    v_add_u32_dpp v27, v39, v2 row_newbcast:10 row_mask:0xf bank_mask:0xc
    buffer_load_dwordx4 v27, s[12:15], 0 offen offset:0 lds
    s_mov_b64 exec, s[36:37]
    v_mov_b64 v[132:133], v[116:117]
    v_mov_b64 v[134:135], v[118:119]
    v_mov_b64 v[136:137], v[120:121]
    v_mov_b64 v[138:139], v[122:123]
    s_mov_b64 exec, -1
    v_add_u32_dpp v24, v39, v3 row_newbcast:3 row_mask:0xf bank_mask:0x3
    v_add_u32_dpp v24, v39, v3 row_newbcast:11 row_mask:0xf bank_mask:0xc
    buffer_load_dwordx4 v24, s[24:27], 0 offen offset:1024 lds
    v_mfma_f32_16x16x32_bf16 v[72:75], v[108:111], v[116:119], 0
    v_mfma_f32_16x16x32_bf16 v[72:75], v[112:115], v[120:123], v[72:75]
    s_add_u32 m0, s81, 0
    s_nop 0
    buffer_load_dwordx4 v30, s[16:19], s77 offen offset:2048 lds
    v_fmac_f32 v32, v76, v224
    v_fmac_f32 v33, v77, v225
    v_fmac_f32 v34, v78, v226
    v_fmac_f32 v35, v79, v227
    buffer_load_dwordx4 v31, s[16:19], s77 offen offset:3072 lds
    s_add_u32 s77, s77, 16384
    v_mfma_f32_16x16x32_bf16 v[76:79], v[100:103], v[124:127], 0
    v_mfma_f32_16x16x32_bf16 v[76:79], v[104:107], v[128:131], v[76:79]
    s_add_u32 m0, s80, 36864
    v_add_u32_dpp v25, v64, v1 row_newbcast:0 row_mask:0xf bank_mask:0x3
    v_add_u32_dpp v25, v64, v1 row_newbcast:8 row_mask:0xf bank_mask:0xc
    buffer_load_dwordx4 v25, s[12:15], 0 offen offset:0 lds
    v_fmac_f32 v32, v80, v228
    v_fmac_f32 v33, v81, v229
    v_fmac_f32 v34, v82, v230
    v_fmac_f32 v35, v83, v231
    v_add_u32_dpp v26, v68, v1 row_newbcast:0 row_mask:0xf bank_mask:0x3
    v_add_u32_dpp v26, v68, v1 row_newbcast:8 row_mask:0xf bank_mask:0xc
    buffer_load_dwordx4 v26, s[28:31], 0 offen offset:2048 lds
    v_mfma_f32_16x16x32_bf16 v[80:83], v[116:119], v[132:135], 0
    v_mfma_f32_16x16x32_bf16 v[80:83], v[120:123], v[136:139], v[80:83]
    s_movk_i32 s74, 17600
    buffer_load_dword v38, v8, s[8:11], s74 offen
    buffer_load_dword v39, v8, s[8:11], s74 offen offset:256
    v_fmac_f32 v32, v72, v232
    v_fmac_f32 v33, v73, v233
    v_fmac_f32 v34, v74, v234
    v_fmac_f32 v35, v75, v235
    ds_read_b128 v[92:95], v4 offset:0
    ds_read_b128 v[96:99], v5 offset:0
    s_mov_b64 exec, s[62:63]
    ds_read_b128 v[148:151], v22 offset:0
    ds_read_b128 v[152:155], v23 offset:0
    s_mov_b64 exec, -1
    s_barrier
    s_waitcnt lgkmcnt(0)
    s_add_u32 m0, s81, 16384
    s_nop 0
    buffer_load_dwordx4 v28, s[16:19], s77 offen offset:0 lds
    v_mfma_f32_16x16x32_bf16 v[72:75], v[108:111], v[124:127], 0
    v_mfma_f32_16x16x32_bf16 v[72:75], v[112:115], v[128:131], v[72:75]
    buffer_load_dwordx4 v29, s[16:19], s77 offen offset:1024 lds
    v_fmac_f32 v32, v76, v236
    v_fmac_f32 v33, v77, v237
    v_fmac_f32 v34, v78, v238
    v_fmac_f32 v35, v79, v239
    v_lshlrev_b32 v36, 7, v36
    v_lshlrev_b32 v37, 7, v37
    s_nop 0
    s_add_u32 m0, s82, 0
    v_add_u32_dpp v27, v36, v2 row_newbcast:0 row_mask:0xf bank_mask:0x3
    v_add_u32_dpp v27, v36, v2 row_newbcast:8 row_mask:0xf bank_mask:0xc
    buffer_load_dwordx4 v27, s[12:15], 0 offen offset:0 lds
    s_mov_b64 exec, s[36:37]
    v_mov_b64 v[132:133], v[124:125]
    v_mov_b64 v[134:135], v[126:127]
    v_mov_b64 v[136:137], v[128:129]
    v_mov_b64 v[138:139], v[130:131]
    s_mov_b64 exec, -1
    v_add_u32_dpp v24, v36, v3 row_newbcast:1 row_mask:0xf bank_mask:0x3
    v_add_u32_dpp v24, v36, v3 row_newbcast:9 row_mask:0xf bank_mask:0xc
    buffer_load_dwordx4 v24, s[24:27], 0 offen offset:1024 lds
    v_mfma_f32_16x16x32_bf16 v[76:79], v[116:119], v[124:127], 0
    v_mfma_f32_16x16x32_bf16 v[76:79], v[120:123], v[128:131], v[76:79]
    s_add_u32 m0, s81, 16384
    s_nop 0
    buffer_load_dwordx4 v30, s[16:19], s77 offen offset:2048 lds
    v_fmac_f32 v32, v80, v240
    v_fmac_f32 v33, v81, v241
    v_fmac_f32 v34, v82, v242
    v_fmac_f32 v35, v83, v243
    buffer_load_dwordx4 v31, s[16:19], s77 offen offset:3072 lds
    s_add_u32 s77, s77, 16384
    v_mfma_f32_16x16x32_bf16 v[80:83], v[124:127], v[132:135], 0
    v_mfma_f32_16x16x32_bf16 v[80:83], v[128:131], v[136:139], v[80:83]
    s_add_u32 m0, s80, 0
    v_add_u32_dpp v25, v57, v1 row_newbcast:0 row_mask:0xf bank_mask:0x3
    v_add_u32_dpp v25, v57, v1 row_newbcast:8 row_mask:0xf bank_mask:0xc
    buffer_load_dwordx4 v25, s[12:15], 0 offen offset:0 lds
    v_fmac_f32 v32, v72, v244
    v_fmac_f32 v33, v73, v245
    v_fmac_f32 v34, v74, v246
    v_fmac_f32 v35, v75, v247
    v_add_u32_dpp v26, v61, v1 row_newbcast:0 row_mask:0xf bank_mask:0x3
    v_add_u32_dpp v26, v61, v1 row_newbcast:8 row_mask:0xf bank_mask:0xc
    buffer_load_dwordx4 v26, s[28:31], 0 offen offset:2048 lds
    s_mov_b64 exec, s[36:37]
    v_mov_b64 v[140:141], v[84:85]
    v_mov_b64 v[142:143], v[86:87]
    v_mov_b64 v[144:145], v[88:89]
    v_mov_b64 v[146:147], v[90:91]
    s_mov_b64 exec, -1
    ds_read_b128 v[100:103], v4 offset:2048
    ds_read_b128 v[104:107], v5 offset:2048
    s_mov_b64 exec, s[64:65]
    ds_read_b128 v[148:151], v22 offset:2048
    ds_read_b128 v[152:155], v23 offset:2048
    s_mov_b64 exec, -1
    s_waitcnt vmcnt(20)
    s_barrier
    s_waitcnt lgkmcnt(0)
    s_add_u32 m0, s81, 32768
    s_nop 0
    buffer_load_dwordx4 v28, s[16:19], s77 offen offset:0 lds
    v_mfma_f32_16x16x32_bf16 v[72:75], v[84:87], v[140:143], 0
    v_mfma_f32_16x16x32_bf16 v[72:75], v[88:91], v[144:147], v[72:75]
    buffer_load_dwordx4 v29, s[16:19], s77 offen offset:1024 lds
    v_fmac_f32 v32, v76, v248
    v_fmac_f32 v33, v77, v249
    v_fmac_f32 v34, v78, v250
    v_fmac_f32 v35, v79, v251
    s_add_u32 m0, s82, 2048
    v_add_u32_dpp v27, v36, v2 row_newbcast:2 row_mask:0xf bank_mask:0x3
    v_add_u32_dpp v27, v36, v2 row_newbcast:10 row_mask:0xf bank_mask:0xc
    buffer_load_dwordx4 v27, s[12:15], 0 offen offset:0 lds
    s_mov_b64 exec, s[36:37]
    v_mov_b64 v[140:141], v[92:93]
    v_mov_b64 v[142:143], v[94:95]
    v_mov_b64 v[144:145], v[96:97]
    v_mov_b64 v[146:147], v[98:99]
    s_mov_b64 exec, -1
    v_add_u32_dpp v24, v36, v3 row_newbcast:3 row_mask:0xf bank_mask:0x3
    v_add_u32_dpp v24, v36, v3 row_newbcast:11 row_mask:0xf bank_mask:0xc
    buffer_load_dwordx4 v24, s[24:27], 0 offen offset:1024 lds
    v_mfma_f32_16x16x32_bf16 v[76:79], v[84:87], v[92:95], 0
    v_mfma_f32_16x16x32_bf16 v[76:79], v[88:91], v[96:99], v[76:79]
    s_add_u32 m0, s81, 32768
    s_nop 0
    buffer_load_dwordx4 v30, s[16:19], s77 offen offset:2048 lds
    v_fmac_f32 v32, v80, v252
    v_fmac_f32 v33, v81, v253
    v_fmac_f32 v34, v82, v254
    v_fmac_f32 v35, v83, v255
    v_add_f32 v12, v32, v33
    v_add_f32 v13, v34, v35
    v_add_f32 v12, v12, v13
    v_mfma_f32_16x16x32_bf16 v[80:83], v[92:95], v[140:143], 0
    v_mfma_f32_16x16x32_bf16 v[80:83], v[96:99], v[144:147], v[80:83]
    buffer_load_dwordx4 v31, s[16:19], s77 offen offset:3072 lds
    s_add_u32 s77, s77, 16384
    v_add_f32_dpp v12, v12, v12 row_shr:1 row_mask:0xf bank_mask:0xf bound_ctrl:0
    v_mul_f32 v32, v72, v164
    v_mul_f32 v33, v73, v165
    v_mul_f32 v34, v74, v166
    v_mul_f32 v35, v75, v167
    s_add_u32 m0, s80, 4096
    v_add_u32_dpp v25, v65, v1 row_newbcast:0 row_mask:0xf bank_mask:0x3
    v_add_u32_dpp v25, v65, v1 row_newbcast:8 row_mask:0xf bank_mask:0xc
    buffer_load_dwordx4 v25, s[12:15], 0 offen offset:0 lds
    v_add_f32_dpp v12, v12, v12 row_shr:2 row_mask:0xf bank_mask:0xf bound_ctrl:0
    v_mfma_f32_16x16x32_bf16 v[72:75], v[84:87], v[100:103], 0
    v_mfma_f32_16x16x32_bf16 v[72:75], v[88:91], v[104:107], v[72:75]
    v_add_u32_dpp v26, v69, v1 row_newbcast:0 row_mask:0xf bank_mask:0x3
    v_add_u32_dpp v26, v69, v1 row_newbcast:8 row_mask:0xf bank_mask:0xc
    buffer_load_dwordx4 v26, s[28:31], 0 offen offset:2048 lds
    v_add_f32_dpp v12, v12, v12 row_shr:4 row_mask:0xf bank_mask:0xf bound_ctrl:0
    v_fmac_f32 v32, v76, v168
    v_fmac_f32 v33, v77, v169
    v_fmac_f32 v34, v78, v170
    v_fmac_f32 v35, v79, v171
    v_add_f32_dpp v12, v12, v12 row_shr:8 row_mask:0xf bank_mask:0xf bound_ctrl:0
    ds_read_b128 v[108:111], v4 offset:4096
    ds_read_b128 v[112:115], v5 offset:4096
    s_mov_b64 exec, s[66:67]
    ds_read_b128 v[148:151], v22 offset:4096
    ds_read_b128 v[152:155], v23 offset:4096
    s_mov_b64 exec, -1
    s_waitcnt vmcnt(18)
    s_barrier
    s_waitcnt lgkmcnt(0)
    s_add_u32 m0, s81, 49152
    s_nop 0
    buffer_load_dwordx4 v28, s[16:19], s77 offen offset:0 lds
    s_mov_b64 exec, s[36:37]
    v_mov_b64 v[140:141], v[100:101]
    v_mov_b64 v[142:143], v[102:103]
    v_mov_b64 v[144:145], v[104:105]
    v_mov_b64 v[146:147], v[106:107]
    s_mov_b64 exec, -1
    buffer_load_dwordx4 v29, s[16:19], s77 offen offset:1024 lds
    v_add_f32_dpp v12, v12, v12 row_bcast:15 row_mask:0xa bank_mask:0xf
    v_mfma_f32_16x16x32_bf16 v[76:79], v[92:95], v[100:103], 0
    v_mfma_f32_16x16x32_bf16 v[76:79], v[96:99], v[104:107], v[76:79]
    s_add_u32 m0, s82, 4096
    v_add_u32_dpp v27, v36, v2 row_newbcast:4 row_mask:0xf bank_mask:0x3
    v_add_u32_dpp v27, v36, v2 row_newbcast:12 row_mask:0xf bank_mask:0xc
    buffer_load_dwordx4 v27, s[12:15], 0 offen offset:0 lds
    v_add_f32_dpp v12, v12, v12 row_bcast:31 row_mask:0xc bank_mask:0xf
    v_fmac_f32 v32, v80, v172
    v_fmac_f32 v33, v81, v173
    v_fmac_f32 v34, v82, v174
    v_fmac_f32 v35, v83, v175
    v_add_u32_dpp v24, v36, v3 row_newbcast:5 row_mask:0xf bank_mask:0x3
    v_add_u32_dpp v24, v36, v3 row_newbcast:13 row_mask:0xf bank_mask:0xc
    buffer_load_dwordx4 v24, s[24:27], 0 offen offset:1024 lds
    v_readlane_b32 s38, v12, 63
    v_mfma_f32_16x16x32_bf16 v[80:83], v[84:87], v[108:111], 0
    v_mfma_f32_16x16x32_bf16 v[80:83], v[88:91], v[112:115], v[80:83]
    s_add_u32 m0, s81, 49152
    s_nop 0
    buffer_load_dwordx4 v30, s[16:19], s77 offen offset:2048 lds
    v_writelane_b32 v9, s38, 8
    v_fmac_f32 v32, v72, v176
    v_fmac_f32 v33, v73, v177
    v_fmac_f32 v34, v74, v178
    v_fmac_f32 v35, v75, v179
    v_mfma_f32_16x16x32_bf16 v[72:75], v[100:103], v[140:143], 0
    v_mfma_f32_16x16x32_bf16 v[72:75], v[104:107], v[144:147], v[72:75]
    buffer_load_dwordx4 v31, s[16:19], s77 offen offset:3072 lds
    s_add_u32 s77, s77, 16384
    v_fmac_f32 v32, v76, v180
    v_fmac_f32 v33, v77, v181
    v_fmac_f32 v34, v78, v182
    v_fmac_f32 v35, v79, v183
    s_add_u32 m0, s80, 16384
    v_add_u32_dpp v25, v58, v1 row_newbcast:0 row_mask:0xf bank_mask:0x3
    v_add_u32_dpp v25, v58, v1 row_newbcast:8 row_mask:0xf bank_mask:0xc
    buffer_load_dwordx4 v25, s[12:15], 0 offen offset:0 lds
    v_mfma_f32_16x16x32_bf16 v[76:79], v[92:95], v[108:111], 0
    v_mfma_f32_16x16x32_bf16 v[76:79], v[96:99], v[112:115], v[76:79]
    v_add_u32_dpp v26, v62, v1 row_newbcast:0 row_mask:0xf bank_mask:0x3
    v_add_u32_dpp v26, v62, v1 row_newbcast:8 row_mask:0xf bank_mask:0xc
    buffer_load_dwordx4 v26, s[28:31], 0 offen offset:2048 lds
    v_fmac_f32 v32, v80, v184
    v_fmac_f32 v33, v81, v185
    v_fmac_f32 v34, v82, v186
    v_fmac_f32 v35, v83, v187
    ds_read_b128 v[116:119], v4 offset:6144
    ds_read_b128 v[120:123], v5 offset:6144
    s_mov_b64 exec, s[60:61]
    ds_read_b128 v[156:159], v22 offset:6144
    ds_read_b128 v[160:163], v23 offset:6144
    s_mov_b64 exec, -1
    s_waitcnt vmcnt(18)
    s_barrier
    s_waitcnt lgkmcnt(0)
    s_add_u32 m0, s81, 0
    s_nop 0
    buffer_load_dwordx4 v28, s[16:19], s77 offen offset:0 lds
    v_mfma_f32_16x16x32_bf16 v[80:83], v[148:151], v[148:151], 0
    v_mfma_f32_16x16x32_bf16 v[80:83], v[152:155], v[152:155], v[80:83]
    buffer_load_dwordx4 v29, s[16:19], s77 offen offset:1024 lds
    v_fmac_f32 v32, v72, v188
    v_fmac_f32 v33, v73, v189
    v_fmac_f32 v34, v74, v190
    v_fmac_f32 v35, v75, v191
    s_add_u32 m0, s82, 6144
    v_add_u32_dpp v27, v36, v2 row_newbcast:6 row_mask:0xf bank_mask:0x3
    v_add_u32_dpp v27, v36, v2 row_newbcast:14 row_mask:0xf bank_mask:0xc
    buffer_load_dwordx4 v27, s[12:15], 0 offen offset:0 lds
    v_mfma_f32_16x16x32_bf16 v[72:75], v[84:87], v[116:119], 0
    v_mfma_f32_16x16x32_bf16 v[72:75], v[88:91], v[120:123], v[72:75]
    v_add_u32_dpp v24, v36, v3 row_newbcast:7 row_mask:0xf bank_mask:0x3
    v_add_u32_dpp v24, v36, v3 row_newbcast:15 row_mask:0xf bank_mask:0xc
    buffer_load_dwordx4 v24, s[24:27], 0 offen offset:1024 lds
    v_fmac_f32 v32, v76, v192
    v_fmac_f32 v33, v77, v193
    v_fmac_f32 v34, v78, v194
    v_fmac_f32 v35, v79, v195
    s_add_u32 m0, s81, 0
    s_nop 0
    buffer_load_dwordx4 v30, s[16:19], s77 offen offset:2048 lds
    s_mov_b64 exec, s[36:37]
    v_mov_b64 v[140:141], v[108:109]
    v_mov_b64 v[142:143], v[110:111]
    v_mov_b64 v[144:145], v[112:113]
    v_mov_b64 v[146:147], v[114:115]
    s_mov_b64 exec, -1
    buffer_load_dwordx4 v31, s[16:19], s77 offen offset:3072 lds
    s_add_u32 s77, s77, 16384
    v_mfma_f32_16x16x32_bf16 v[76:79], v[100:103], v[108:111], 0
    v_mfma_f32_16x16x32_bf16 v[76:79], v[104:107], v[112:115], v[76:79]
    s_add_u32 m0, s80, 20480
    v_add_u32_dpp v25, v66, v1 row_newbcast:0 row_mask:0xf bank_mask:0x3
    v_add_u32_dpp v25, v66, v1 row_newbcast:8 row_mask:0xf bank_mask:0xc
    buffer_load_dwordx4 v25, s[12:15], 0 offen offset:0 lds
    v_fmac_f32 v32, v80, v196
    v_fmac_f32 v33, v81, v197
    v_fmac_f32 v34, v82, v198
    v_fmac_f32 v35, v83, v199
    v_add_u32_dpp v26, v70, v1 row_newbcast:0 row_mask:0xf bank_mask:0x3
    v_add_u32_dpp v26, v70, v1 row_newbcast:8 row_mask:0xf bank_mask:0xc
    buffer_load_dwordx4 v26, s[28:31], 0 offen offset:2048 lds
    v_mfma_f32_16x16x32_bf16 v[80:83], v[92:95], v[116:119], 0
    v_mfma_f32_16x16x32_bf16 v[80:83], v[96:99], v[120:123], v[80:83]
    s_add_u32 m0, s82, 10240
    v_add_u32_dpp v27, v37, v2 row_newbcast:4 row_mask:0xf bank_mask:0x3
    v_add_u32_dpp v27, v37, v2 row_newbcast:12 row_mask:0xf bank_mask:0xc
    s_mov_b32 exec_hi, 0
    buffer_load_dwordx4 v27, s[12:15], 0 offen offset:0 lds
    s_mov_b32 exec_hi, -1
    v_fmac_f32 v32, v72, v200
    v_fmac_f32 v33, v73, v201
    v_fmac_f32 v34, v74, v202
    v_fmac_f32 v35, v75, v203
    ds_read_b128 v[124:127], v4 offset:8192
    ds_read_b128 v[128:131], v5 offset:8192
    s_mov_b64 exec, s[62:63]
    ds_read_b128 v[156:159], v22 offset:8192
    ds_read_b128 v[160:163], v23 offset:8192
    s_mov_b64 exec, -1
    s_waitcnt vmcnt(17)
    s_barrier
    s_waitcnt lgkmcnt(0)
    s_add_u32 m0, s81, 16384
    s_nop 0
    buffer_load_dwordx4 v28, s[16:19], s77 offen offset:0 lds
    v_mfma_f32_16x16x32_bf16 v[72:75], v[84:87], v[124:127], 0
    v_mfma_f32_16x16x32_bf16 v[72:75], v[88:91], v[128:131], v[72:75]
    buffer_load_dwordx4 v29, s[16:19], s77 offen offset:1024 lds
    v_fmac_f32 v32, v76, v204
    v_fmac_f32 v33, v77, v205
    v_fmac_f32 v34, v78, v206
    v_fmac_f32 v35, v79, v207
    s_add_u32 m0, s82, 8192
    v_add_u32_dpp v24, v37, v2 row_newbcast:0 row_mask:0xf bank_mask:0x3
    v_add_u32_dpp v24, v37, v2 row_newbcast:8 row_mask:0xf bank_mask:0xc
    buffer_load_dwordx4 v24, s[12:15], 0 offen offset:0 lds
    v_mfma_f32_16x16x32_bf16 v[76:79], v[108:111], v[140:143], 0
    v_mfma_f32_16x16x32_bf16 v[76:79], v[112:115], v[144:147], v[76:79]
    v_add_u32_dpp v25, v37, v3 row_newbcast:1 row_mask:0xf bank_mask:0x3
    v_add_u32_dpp v25, v37, v3 row_newbcast:9 row_mask:0xf bank_mask:0xc
    buffer_load_dwordx4 v25, s[24:27], 0 offen offset:1024 lds
    v_fmac_f32 v32, v80, v208
    v_fmac_f32 v33, v81, v209
    v_fmac_f32 v34, v82, v210
    v_fmac_f32 v35, v83, v211
    s_add_u32 m0, s81, 16384
    s_nop 0
    buffer_load_dwordx4 v30, s[16:19], s77 offen offset:2048 lds
    v_mfma_f32_16x16x32_bf16 v[80:83], v[92:95], v[124:127], 0
    v_mfma_f32_16x16x32_bf16 v[80:83], v[96:99], v[128:131], v[80:83]
    buffer_load_dwordx4 v31, s[16:19], s77 offen offset:3072 lds
    s_add_u32 s77, s77, 16384
    v_fmac_f32 v32, v72, v212
    v_fmac_f32 v33, v73, v213
    v_fmac_f32 v34, v74, v214
    v_fmac_f32 v35, v75, v215
    s_add_u32 m0, s80, 32768
    v_add_u32_dpp v26, v59, v1 row_newbcast:0 row_mask:0xf bank_mask:0x3
    v_add_u32_dpp v26, v59, v1 row_newbcast:8 row_mask:0xf bank_mask:0xc
    buffer_load_dwordx4 v26, s[12:15], 0 offen offset:0 lds
    v_mfma_f32_16x16x32_bf16 v[72:75], v[156:159], v[156:159], 0
    v_mfma_f32_16x16x32_bf16 v[72:75], v[160:163], v[160:163], v[72:75]
    v_add_u32_dpp v27, v63, v1 row_newbcast:0 row_mask:0xf bank_mask:0x3
    v_add_u32_dpp v27, v63, v1 row_newbcast:8 row_mask:0xf bank_mask:0xc
    buffer_load_dwordx4 v27, s[28:31], 0 offen offset:2048 lds
    v_fmac_f32 v32, v76, v216
    v_fmac_f32 v33, v77, v217
    v_fmac_f32 v34, v78, v218
    v_fmac_f32 v35, v79, v219
    ds_read_b128 v[84:87], v4 offset:0
    ds_read_b128 v[88:91], v5 offset:0
    s_mov_b64 exec, s[60:61]
    ds_read_b128 v[148:151], v22 offset:0
    ds_read_b128 v[152:155], v23 offset:0
    s_mov_b64 exec, -1
    s_waitcnt vmcnt(8)
    s_mov_b64 exec, s[60:61]
    ds_read_b128 v[132:135], v4 offset:10240
    ds_read_b128 v[136:139], v5 offset:10240
    s_mov_b64 exec, s[64:65]
    ds_read_b128 v[156:159], v22 offset:10240
    ds_read_b128 v[160:163], v23 offset:10240
    s_mov_b64 exec, -1
    s_barrier
    s_waitcnt lgkmcnt(0)
    s_add_u32 m0, s81, 32768
    s_nop 0
    buffer_load_dwordx4 v28, s[16:19], s77 offen offset:0 lds
    v_mfma_f32_16x16x32_bf16 v[76:79], v[100:103], v[116:119], 0
    v_mfma_f32_16x16x32_bf16 v[76:79], v[104:107], v[120:123], v[76:79]
    buffer_load_dwordx4 v29, s[16:19], s77 offen offset:1024 lds
    v_fmac_f32 v32, v80, v220
    v_fmac_f32 v33, v81, v221
    v_fmac_f32 v34, v82, v222
    v_fmac_f32 v35, v83, v223
    s_add_u32 m0, s82, 0
    v_add_u32_dpp v24, v37, v2 row_newbcast:2 row_mask:0xf bank_mask:0x3
    v_add_u32_dpp v24, v37, v2 row_newbcast:10 row_mask:0xf bank_mask:0xc
    buffer_load_dwordx4 v24, s[12:15], 0 offen offset:0 lds
    s_mov_b64 exec, s[36:37]
    v_mov_b64 v[140:141], v[116:117]
    v_mov_b64 v[142:143], v[118:119]
    v_mov_b64 v[144:145], v[120:121]
    v_mov_b64 v[146:147], v[122:123]
    s_mov_b64 exec, -1
    v_add_u32_dpp v25, v37, v3 row_newbcast:3 row_mask:0xf bank_mask:0x3
    v_add_u32_dpp v25, v37, v3 row_newbcast:11 row_mask:0xf bank_mask:0xc
    buffer_load_dwordx4 v25, s[24:27], 0 offen offset:1024 lds
    v_mfma_f32_16x16x32_bf16 v[80:83], v[108:111], v[116:119], 0
    v_mfma_f32_16x16x32_bf16 v[80:83], v[112:115], v[120:123], v[80:83]
    s_add_u32 m0, s81, 32768
    s_nop 0
    buffer_load_dwordx4 v30, s[16:19], s77 offen offset:2048 lds
    v_fmac_f32 v32, v72, v224
    v_fmac_f32 v33, v73, v225
    v_fmac_f32 v34, v74, v226
    v_fmac_f32 v35, v75, v227
    buffer_load_dwordx4 v31, s[16:19], s77 offen offset:3072 lds
    s_add_u32 s77, s77, 16384
    v_mfma_f32_16x16x32_bf16 v[72:75], v[100:103], v[124:127], 0
    v_mfma_f32_16x16x32_bf16 v[72:75], v[104:107], v[128:131], v[72:75]
    s_add_u32 m0, s80, 36864
    v_add_u32_dpp v26, v67, v1 row_newbcast:0 row_mask:0xf bank_mask:0x3
    v_add_u32_dpp v26, v67, v1 row_newbcast:8 row_mask:0xf bank_mask:0xc
    buffer_load_dwordx4 v26, s[12:15], 0 offen offset:0 lds
    v_fmac_f32 v32, v76, v228
    v_fmac_f32 v33, v77, v229
    v_fmac_f32 v34, v78, v230
    v_fmac_f32 v35, v79, v231
    v_add_u32_dpp v27, v71, v1 row_newbcast:0 row_mask:0xf bank_mask:0x3
    v_add_u32_dpp v27, v71, v1 row_newbcast:8 row_mask:0xf bank_mask:0xc
    buffer_load_dwordx4 v27, s[28:31], 0 offen offset:2048 lds
    v_mfma_f32_16x16x32_bf16 v[76:79], v[116:119], v[140:143], 0
    v_mfma_f32_16x16x32_bf16 v[76:79], v[120:123], v[144:147], v[76:79]
    s_movk_i32 s74, 19200
    buffer_load_dword v36, v8, s[8:11], s74 offen
    buffer_load_dword v37, v8, s[8:11], s74 offen offset:256
    v_fmac_f32 v32, v80, v232
    v_fmac_f32 v33, v81, v233
    v_fmac_f32 v34, v82, v234
    v_fmac_f32 v35, v83, v235
    ds_read_b128 v[92:95], v4 offset:2048
    ds_read_b128 v[96:99], v5 offset:2048
    s_mov_b64 exec, s[62:63]
    ds_read_b128 v[148:151], v22 offset:2048
    ds_read_b128 v[152:155], v23 offset:2048
    s_mov_b64 exec, -1
    s_barrier
    s_waitcnt lgkmcnt(0)
    s_add_u32 m0, s81, 49152
    s_nop 0
    buffer_load_dwordx4 v28, s[16:19], s77 offen offset:0 lds
    v_mfma_f32_16x16x32_bf16 v[80:83], v[108:111], v[124:127], 0
    v_mfma_f32_16x16x32_bf16 v[80:83], v[112:115], v[128:131], v[80:83]
    buffer_load_dwordx4 v29, s[16:19], s77 offen offset:1024 lds
    v_fmac_f32 v32, v72, v236
    v_fmac_f32 v33, v73, v237
    v_fmac_f32 v34, v74, v238
    v_fmac_f32 v35, v75, v239
    v_lshlrev_b32 v38, 7, v38
    v_lshlrev_b32 v39, 7, v39
    s_nop 0
    s_add_u32 m0, s82, 2048
    v_add_u32_dpp v24, v38, v2 row_newbcast:0 row_mask:0xf bank_mask:0x3
    v_add_u32_dpp v24, v38, v2 row_newbcast:8 row_mask:0xf bank_mask:0xc
    buffer_load_dwordx4 v24, s[12:15], 0 offen offset:0 lds
    s_mov_b64 exec, s[36:37]
    v_mov_b64 v[140:141], v[124:125]
    v_mov_b64 v[142:143], v[126:127]
    v_mov_b64 v[144:145], v[128:129]
    v_mov_b64 v[146:147], v[130:131]
    s_mov_b64 exec, -1
    v_add_u32_dpp v25, v38, v3 row_newbcast:1 row_mask:0xf bank_mask:0x3
    v_add_u32_dpp v25, v38, v3 row_newbcast:9 row_mask:0xf bank_mask:0xc
    buffer_load_dwordx4 v25, s[24:27], 0 offen offset:1024 lds
    v_mfma_f32_16x16x32_bf16 v[72:75], v[116:119], v[124:127], 0
    v_mfma_f32_16x16x32_bf16 v[72:75], v[120:123], v[128:131], v[72:75]
    s_add_u32 m0, s81, 49152
    s_nop 0
    buffer_load_dwordx4 v30, s[16:19], s77 offen offset:2048 lds
    v_fmac_f32 v32, v76, v240
    v_fmac_f32 v33, v77, v241
    v_fmac_f32 v34, v78, v242
    v_fmac_f32 v35, v79, v243
    buffer_load_dwordx4 v31, s[16:19], s77 offen offset:3072 lds
    s_add_u32 s77, s77, 16384
    v_mfma_f32_16x16x32_bf16 v[76:79], v[124:127], v[140:143], 0
    v_mfma_f32_16x16x32_bf16 v[76:79], v[128:131], v[144:147], v[76:79]
    s_add_u32 m0, s80, 0
    v_add_u32_dpp v26, v56, v1 row_newbcast:1 row_mask:0xf bank_mask:0x3
    v_add_u32_dpp v26, v56, v1 row_newbcast:9 row_mask:0xf bank_mask:0xc
    buffer_load_dwordx4 v26, s[12:15], 0 offen offset:0 lds
    v_fmac_f32 v32, v80, v244
    v_fmac_f32 v33, v81, v245
    v_fmac_f32 v34, v82, v246
    v_fmac_f32 v35, v83, v247
    v_add_u32_dpp v27, v60, v1 row_newbcast:1 row_mask:0xf bank_mask:0x3
    v_add_u32_dpp v27, v60, v1 row_newbcast:9 row_mask:0xf bank_mask:0xc
    buffer_load_dwordx4 v27, s[28:31], 0 offen offset:2048 lds
    s_mov_b64 exec, s[36:37]
    v_mov_b64 v[132:133], v[84:85]
    v_mov_b64 v[134:135], v[86:87]
    v_mov_b64 v[136:137], v[88:89]
    v_mov_b64 v[138:139], v[90:91]
    s_mov_b64 exec, -1
    ds_read_b128 v[100:103], v4 offset:4096
    ds_read_b128 v[104:107], v5 offset:4096
    s_mov_b64 exec, s[64:65]
    ds_read_b128 v[148:151], v22 offset:4096
    ds_read_b128 v[152:155], v23 offset:4096
    s_mov_b64 exec, -1
    s_waitcnt vmcnt(20)
    s_barrier
    s_waitcnt lgkmcnt(0)
    s_add_u32 m0, s81, 0
    s_nop 0
    buffer_load_dwordx4 v28, s[16:19], s77 offen offset:0 lds
    v_mfma_f32_16x16x32_bf16 v[80:83], v[84:87], v[132:135], 0
    v_mfma_f32_16x16x32_bf16 v[80:83], v[88:91], v[136:139], v[80:83]
    buffer_load_dwordx4 v29, s[16:19], s77 offen offset:1024 lds
    v_fmac_f32 v32, v72, v248
    v_fmac_f32 v33, v73, v249
    v_fmac_f32 v34, v74, v250
    v_fmac_f32 v35, v75, v251
    s_add_u32 m0, s82, 4096
    v_add_u32_dpp v24, v38, v2 row_newbcast:2 row_mask:0xf bank_mask:0x3
    v_add_u32_dpp v24, v38, v2 row_newbcast:10 row_mask:0xf bank_mask:0xc
    buffer_load_dwordx4 v24, s[12:15], 0 offen offset:0 lds
    s_mov_b64 exec, s[36:37]
    v_mov_b64 v[132:133], v[92:93]
    v_mov_b64 v[134:135], v[94:95]
    v_mov_b64 v[136:137], v[96:97]
    v_mov_b64 v[138:139], v[98:99]
    s_mov_b64 exec, -1
    v_add_u32_dpp v25, v38, v3 row_newbcast:3 row_mask:0xf bank_mask:0x3
    v_add_u32_dpp v25, v38, v3 row_newbcast:11 row_mask:0xf bank_mask:0xc
    buffer_load_dwordx4 v25, s[24:27], 0 offen offset:1024 lds
    v_mfma_f32_16x16x32_bf16 v[72:75], v[84:87], v[92:95], 0
    v_mfma_f32_16x16x32_bf16 v[72:75], v[88:91], v[96:99], v[72:75]
    s_add_u32 m0, s81, 0
    s_nop 0
    buffer_load_dwordx4 v30, s[16:19], s77 offen offset:2048 lds
    v_fmac_f32 v32, v76, v252
    v_fmac_f32 v33, v77, v253
    v_fmac_f32 v34, v78, v254
    v_fmac_f32 v35, v79, v255
    v_add_f32 v12, v32, v33
    v_add_f32 v13, v34, v35
    v_add_f32 v12, v12, v13
    v_mfma_f32_16x16x32_bf16 v[76:79], v[92:95], v[132:135], 0
    v_mfma_f32_16x16x32_bf16 v[76:79], v[96:99], v[136:139], v[76:79]
    buffer_load_dwordx4 v31, s[16:19], s77 offen offset:3072 lds
    s_add_u32 s77, s77, 16384
    v_add_f32_dpp v12, v12, v12 row_shr:1 row_mask:0xf bank_mask:0xf bound_ctrl:0
    v_mul_f32 v32, v80, v164
    v_mul_f32 v33, v81, v165
    v_mul_f32 v34, v82, v166
    v_mul_f32 v35, v83, v167
    s_add_u32 m0, s80, 4096
    v_add_u32_dpp v26, v64, v1 row_newbcast:1 row_mask:0xf bank_mask:0x3
    v_add_u32_dpp v26, v64, v1 row_newbcast:9 row_mask:0xf bank_mask:0xc
    buffer_load_dwordx4 v26, s[12:15], 0 offen offset:0 lds
    v_add_f32_dpp v12, v12, v12 row_shr:2 row_mask:0xf bank_mask:0xf bound_ctrl:0
    v_mfma_f32_16x16x32_bf16 v[80:83], v[84:87], v[100:103], 0
    v_mfma_f32_16x16x32_bf16 v[80:83], v[88:91], v[104:107], v[80:83]
    v_add_u32_dpp v27, v68, v1 row_newbcast:1 row_mask:0xf bank_mask:0x3
    v_add_u32_dpp v27, v68, v1 row_newbcast:9 row_mask:0xf bank_mask:0xc
    buffer_load_dwordx4 v27, s[28:31], 0 offen offset:2048 lds
    v_add_f32_dpp v12, v12, v12 row_shr:4 row_mask:0xf bank_mask:0xf bound_ctrl:0
    v_fmac_f32 v32, v72, v168
    v_fmac_f32 v33, v73, v169
    v_fmac_f32 v34, v74, v170
    v_fmac_f32 v35, v75, v171
    v_add_f32_dpp v12, v12, v12 row_shr:8 row_mask:0xf bank_mask:0xf bound_ctrl:0
    ds_read_b128 v[108:111], v4 offset:6144
    ds_read_b128 v[112:115], v5 offset:6144
    s_mov_b64 exec, s[66:67]
    ds_read_b128 v[148:151], v22 offset:6144
    ds_read_b128 v[152:155], v23 offset:6144
    s_mov_b64 exec, -1
    s_waitcnt vmcnt(18)
    s_barrier
    s_waitcnt lgkmcnt(0)
    s_add_u32 m0, s81, 16384
    s_nop 0
    buffer_load_dwordx4 v28, s[16:19], s77 offen offset:0 lds
    s_mov_b64 exec, s[36:37]
    v_mov_b64 v[132:133], v[100:101]
    v_mov_b64 v[134:135], v[102:103]
    v_mov_b64 v[136:137], v[104:105]
    v_mov_b64 v[138:139], v[106:107]
    s_mov_b64 exec, -1
    buffer_load_dwordx4 v29, s[16:19], s77 offen offset:1024 lds
    v_add_f32_dpp v12, v12, v12 row_bcast:15 row_mask:0xa bank_mask:0xf
    v_mfma_f32_16x16x32_bf16 v[72:75], v[92:95], v[100:103], 0
    v_mfma_f32_16x16x32_bf16 v[72:75], v[96:99], v[104:107], v[72:75]
    s_add_u32 m0, s82, 6144
    v_add_u32_dpp v24, v38, v2 row_newbcast:4 row_mask:0xf bank_mask:0x3
    v_add_u32_dpp v24, v38, v2 row_newbcast:12 row_mask:0xf bank_mask:0xc
    buffer_load_dwordx4 v24, s[12:15], 0 offen offset:0 lds
    v_add_f32_dpp v12, v12, v12 row_bcast:31 row_mask:0xc bank_mask:0xf
    v_fmac_f32 v32, v76, v172
    v_fmac_f32 v33, v77, v173
    v_fmac_f32 v34, v78, v174
    v_fmac_f32 v35, v79, v175
    v_add_u32_dpp v25, v38, v3 row_newbcast:5 row_mask:0xf bank_mask:0x3
    v_add_u32_dpp v25, v38, v3 row_newbcast:13 row_mask:0xf bank_mask:0xc
    buffer_load_dwordx4 v25, s[24:27], 0 offen offset:1024 lds
    v_readlane_b32 s38, v12, 63
    v_mfma_f32_16x16x32_bf16 v[76:79], v[84:87], v[108:111], 0
    v_mfma_f32_16x16x32_bf16 v[76:79], v[88:91], v[112:115], v[76:79]
    s_add_u32 m0, s81, 16384
    s_nop 0
    buffer_load_dwordx4 v30, s[16:19], s77 offen offset:2048 lds
    v_writelane_b32 v9, s38, 9
    v_fmac_f32 v32, v80, v176
    v_fmac_f32 v33, v81, v177
    v_fmac_f32 v34, v82, v178
    v_fmac_f32 v35, v83, v179
    v_mfma_f32_16x16x32_bf16 v[80:83], v[100:103], v[132:135], 0
    v_mfma_f32_16x16x32_bf16 v[80:83], v[104:107], v[136:139], v[80:83]
    buffer_load_dwordx4 v31, s[16:19], s77 offen offset:3072 lds
    s_add_u32 s77, s77, 16384
    v_fmac_f32 v32, v72, v180
    v_fmac_f32 v33, v73, v181
    v_fmac_f32 v34, v74, v182
    v_fmac_f32 v35, v75, v183
    s_add_u32 m0, s80, 16384
    v_add_u32_dpp v26, v57, v1 row_newbcast:1 row_mask:0xf bank_mask:0x3
    v_add_u32_dpp v26, v57, v1 row_newbcast:9 row_mask:0xf bank_mask:0xc
    buffer_load_dwordx4 v26, s[12:15], 0 offen offset:0 lds
    v_mfma_f32_16x16x32_bf16 v[72:75], v[92:95], v[108:111], 0
    v_mfma_f32_16x16x32_bf16 v[72:75], v[96:99], v[112:115], v[72:75]
    v_add_u32_dpp v27, v61, v1 row_newbcast:1 row_mask:0xf bank_mask:0x3
    v_add_u32_dpp v27, v61, v1 row_newbcast:9 row_mask:0xf bank_mask:0xc
    buffer_load_dwordx4 v27, s[28:31], 0 offen offset:2048 lds
    v_fmac_f32 v32, v76, v184
    v_fmac_f32 v33, v77, v185
    v_fmac_f32 v34, v78, v186
    v_fmac_f32 v35, v79, v187
    ds_read_b128 v[116:119], v4 offset:8192
    ds_read_b128 v[120:123], v5 offset:8192
    s_mov_b64 exec, s[60:61]
    ds_read_b128 v[156:159], v22 offset:8192
    ds_read_b128 v[160:163], v23 offset:8192
    s_mov_b64 exec, -1
    s_waitcnt vmcnt(18)
    s_barrier
    s_waitcnt lgkmcnt(0)
    s_add_u32 m0, s81, 32768
    s_nop 0
    buffer_load_dwordx4 v28, s[16:19], s77 offen offset:0 lds
    v_mfma_f32_16x16x32_bf16 v[76:79], v[148:151], v[148:151], 0
    v_mfma_f32_16x16x32_bf16 v[76:79], v[152:155], v[152:155], v[76:79]
    buffer_load_dwordx4 v29, s[16:19], s77 offen offset:1024 lds
    v_fmac_f32 v32, v80, v188
    v_fmac_f32 v33, v81, v189
    v_fmac_f32 v34, v82, v190
    v_fmac_f32 v35, v83, v191
    s_add_u32 m0, s82, 8192
    v_add_u32_dpp v24, v38, v2 row_newbcast:6 row_mask:0xf bank_mask:0x3
    v_add_u32_dpp v24, v38, v2 row_newbcast:14 row_mask:0xf bank_mask:0xc
    buffer_load_dwordx4 v24, s[12:15], 0 offen offset:0 lds
    v_mfma_f32_16x16x32_bf16 v[80:83], v[84:87], v[116:119], 0
    v_mfma_f32_16x16x32_bf16 v[80:83], v[88:91], v[120:123], v[80:83]
    v_add_u32_dpp v25, v38, v3 row_newbcast:7 row_mask:0xf bank_mask:0x3
    v_add_u32_dpp v25, v38, v3 row_newbcast:15 row_mask:0xf bank_mask:0xc
    buffer_load_dwordx4 v25, s[24:27], 0 offen offset:1024 lds
    v_fmac_f32 v32, v72, v192
    v_fmac_f32 v33, v73, v193
    v_fmac_f32 v34, v74, v194
    v_fmac_f32 v35, v75, v195
    s_add_u32 m0, s81, 32768
    s_nop 0
    buffer_load_dwordx4 v30, s[16:19], s77 offen offset:2048 lds
    s_mov_b64 exec, s[36:37]
    v_mov_b64 v[132:133], v[108:109]
    v_mov_b64 v[134:135], v[110:111]
    v_mov_b64 v[136:137], v[112:113]
    v_mov_b64 v[138:139], v[114:115]
    s_mov_b64 exec, -1
    buffer_load_dwordx4 v31, s[16:19], s77 offen offset:3072 lds
    s_add_u32 s77, s77, 16384
    v_mfma_f32_16x16x32_bf16 v[72:75], v[100:103], v[108:111], 0
    v_mfma_f32_16x16x32_bf16 v[72:75], v[104:107], v[112:115], v[72:75]
    s_add_u32 m0, s80, 20480
    v_add_u32_dpp v26, v65, v1 row_newbcast:1 row_mask:0xf bank_mask:0x3
    v_add_u32_dpp v26, v65, v1 row_newbcast:9 row_mask:0xf bank_mask:0xc
    buffer_load_dwordx4 v26, s[12:15], 0 offen offset:0 lds
    v_fmac_f32 v32, v76, v196
    v_fmac_f32 v33, v77, v197
    v_fmac_f32 v34, v78, v198
    v_fmac_f32 v35, v79, v199
    v_add_u32_dpp v27, v69, v1 row_newbcast:1 row_mask:0xf bank_mask:0x3
    v_add_u32_dpp v27, v69, v1 row_newbcast:9 row_mask:0xf bank_mask:0xc
    buffer_load_dwordx4 v27, s[28:31], 0 offen offset:2048 lds
    v_mfma_f32_16x16x32_bf16 v[76:79], v[92:95], v[116:119], 0
    v_mfma_f32_16x16x32_bf16 v[76:79], v[96:99], v[120:123], v[76:79]
    s_add_u32 m0, s82, 10240
    v_add_u32_dpp v24, v39, v2 row_newbcast:4 row_mask:0xf bank_mask:0x3
    v_add_u32_dpp v24, v39, v2 row_newbcast:12 row_mask:0xf bank_mask:0xc
    s_mov_b32 exec_hi, 0
    buffer_load_dwordx4 v24, s[12:15], 0 offen offset:0 lds
    s_mov_b32 exec_hi, -1
    v_fmac_f32 v32, v80, v200
    v_fmac_f32 v33, v81, v201
    v_fmac_f32 v34, v82, v202
    v_fmac_f32 v35, v83, v203
    ds_read_b128 v[124:127], v4 offset:0
    ds_read_b128 v[128:131], v5 offset:0
    s_mov_b64 exec, s[62:63]
    ds_read_b128 v[156:159], v22 offset:0
    ds_read_b128 v[160:163], v23 offset:0
    s_mov_b64 exec, -1
    s_waitcnt vmcnt(17)
    s_barrier
    s_waitcnt lgkmcnt(0)
    s_add_u32 m0, s81, 49152
    s_nop 0
    buffer_load_dwordx4 v28, s[16:19], s77 offen offset:0 lds
    v_mfma_f32_16x16x32_bf16 v[80:83], v[84:87], v[124:127], 0
    v_mfma_f32_16x16x32_bf16 v[80:83], v[88:91], v[128:131], v[80:83]
    buffer_load_dwordx4 v29, s[16:19], s77 offen offset:1024 lds
    v_fmac_f32 v32, v72, v204
    v_fmac_f32 v33, v73, v205
    v_fmac_f32 v34, v74, v206
    v_fmac_f32 v35, v75, v207
    s_add_u32 m0, s82, 0
    v_add_u32_dpp v25, v39, v2 row_newbcast:0 row_mask:0xf bank_mask:0x3
    v_add_u32_dpp v25, v39, v2 row_newbcast:8 row_mask:0xf bank_mask:0xc
    buffer_load_dwordx4 v25, s[12:15], 0 offen offset:0 lds
    v_mfma_f32_16x16x32_bf16 v[72:75], v[108:111], v[132:135], 0
    v_mfma_f32_16x16x32_bf16 v[72:75], v[112:115], v[136:139], v[72:75]
    v_add_u32_dpp v26, v39, v3 row_newbcast:1 row_mask:0xf bank_mask:0x3
    v_add_u32_dpp v26, v39, v3 row_newbcast:9 row_mask:0xf bank_mask:0xc
    buffer_load_dwordx4 v26, s[24:27], 0 offen offset:1024 lds
    v_fmac_f32 v32, v76, v208
    v_fmac_f32 v33, v77, v209
    v_fmac_f32 v34, v78, v210
    v_fmac_f32 v35, v79, v211
    s_add_u32 m0, s81, 49152
    s_nop 0
    buffer_load_dwordx4 v30, s[16:19], s77 offen offset:2048 lds
    v_mfma_f32_16x16x32_bf16 v[76:79], v[92:95], v[124:127], 0
    v_mfma_f32_16x16x32_bf16 v[76:79], v[96:99], v[128:131], v[76:79]
    buffer_load_dwordx4 v31, s[16:19], s77 offen offset:3072 lds
    s_add_u32 s77, s77, 16384
    v_fmac_f32 v32, v80, v212
    v_fmac_f32 v33, v81, v213
    v_fmac_f32 v34, v82, v214
    v_fmac_f32 v35, v83, v215
    s_add_u32 m0, s80, 32768
    v_add_u32_dpp v27, v58, v1 row_newbcast:1 row_mask:0xf bank_mask:0x3
    v_add_u32_dpp v27, v58, v1 row_newbcast:9 row_mask:0xf bank_mask:0xc
    buffer_load_dwordx4 v27, s[12:15], 0 offen offset:0 lds
    v_mfma_f32_16x16x32_bf16 v[80:83], v[156:159], v[156:159], 0
    v_mfma_f32_16x16x32_bf16 v[80:83], v[160:163], v[160:163], v[80:83]
    v_add_u32_dpp v24, v62, v1 row_newbcast:1 row_mask:0xf bank_mask:0x3
    v_add_u32_dpp v24, v62, v1 row_newbcast:9 row_mask:0xf bank_mask:0xc
    buffer_load_dwordx4 v24, s[28:31], 0 offen offset:2048 lds
    v_fmac_f32 v32, v72, v216
    v_fmac_f32 v33, v73, v217
    v_fmac_f32 v34, v74, v218
    v_fmac_f32 v35, v75, v219
    ds_read_b128 v[84:87], v4 offset:2048
    ds_read_b128 v[88:91], v5 offset:2048
    s_mov_b64 exec, s[60:61]
    ds_read_b128 v[148:151], v22 offset:2048
    ds_read_b128 v[152:155], v23 offset:2048
    s_mov_b64 exec, -1
    s_waitcnt vmcnt(8)
    s_mov_b64 exec, s[60:61]
    ds_read_b128 v[140:143], v4 offset:10240
    ds_read_b128 v[144:147], v5 offset:10240
    s_mov_b64 exec, s[64:65]
    ds_read_b128 v[156:159], v22 offset:10240
    ds_read_b128 v[160:163], v23 offset:10240
    s_mov_b64 exec, -1
    s_barrier
    s_waitcnt lgkmcnt(0)
    s_add_u32 m0, s81, 0
    s_nop 0
    buffer_load_dwordx4 v28, s[16:19], s77 offen offset:0 lds
    v_mfma_f32_16x16x32_bf16 v[72:75], v[100:103], v[116:119], 0
    v_mfma_f32_16x16x32_bf16 v[72:75], v[104:107], v[120:123], v[72:75]
    buffer_load_dwordx4 v29, s[16:19], s77 offen offset:1024 lds
    v_fmac_f32 v32, v76, v220
    v_fmac_f32 v33, v77, v221
    v_fmac_f32 v34, v78, v222
    v_fmac_f32 v35, v79, v223
    s_add_u32 m0, s82, 2048
    v_add_u32_dpp v25, v39, v2 row_newbcast:2 row_mask:0xf bank_mask:0x3
    v_add_u32_dpp v25, v39, v2 row_newbcast:10 row_mask:0xf bank_mask:0xc
    buffer_load_dwordx4 v25, s[12:15], 0 offen offset:0 lds
    s_mov_b64 exec, s[36:37]
    v_mov_b64 v[132:133], v[116:117]
    v_mov_b64 v[134:135], v[118:119]
    v_mov_b64 v[136:137], v[120:121]
    v_mov_b64 v[138:139], v[122:123]
    s_mov_b64 exec, -1
    v_add_u32_dpp v26, v39, v3 row_newbcast:3 row_mask:0xf bank_mask:0x3
    v_add_u32_dpp v26, v39, v3 row_newbcast:11 row_mask:0xf bank_mask:0xc
    buffer_load_dwordx4 v26, s[24:27], 0 offen offset:1024 lds
    v_mfma_f32_16x16x32_bf16 v[76:79], v[108:111], v[116:119], 0
    v_mfma_f32_16x16x32_bf16 v[76:79], v[112:115], v[120:123], v[76:79]
    s_add_u32 m0, s81, 0
    s_nop 0
    buffer_load_dwordx4 v30, s[16:19], s77 offen offset:2048 lds
    v_fmac_f32 v32, v80, v224
    v_fmac_f32 v33, v81, v225
    v_fmac_f32 v34, v82, v226
    v_fmac_f32 v35, v83, v227
    buffer_load_dwordx4 v31, s[16:19], s77 offen offset:3072 lds
    s_add_u32 s77, s77, 16384
    v_mfma_f32_16x16x32_bf16 v[80:83], v[100:103], v[124:127], 0
    v_mfma_f32_16x16x32_bf16 v[80:83], v[104:107], v[128:131], v[80:83]
    s_add_u32 m0, s80, 36864
    v_add_u32_dpp v27, v66, v1 row_newbcast:1 row_mask:0xf bank_mask:0x3
    v_add_u32_dpp v27, v66, v1 row_newbcast:9 row_mask:0xf bank_mask:0xc
    buffer_load_dwordx4 v27, s[12:15], 0 offen offset:0 lds
    v_fmac_f32 v32, v72, v228
    v_fmac_f32 v33, v73, v229
    v_fmac_f32 v34, v74, v230
    v_fmac_f32 v35, v75, v231
    v_add_u32_dpp v24, v70, v1 row_newbcast:1 row_mask:0xf bank_mask:0x3
    v_add_u32_dpp v24, v70, v1 row_newbcast:9 row_mask:0xf bank_mask:0xc
    buffer_load_dwordx4 v24, s[28:31], 0 offen offset:2048 lds
    v_mfma_f32_16x16x32_bf16 v[72:75], v[116:119], v[132:135], 0
    v_mfma_f32_16x16x32_bf16 v[72:75], v[120:123], v[136:139], v[72:75]
    s_movk_i32 s74, 20800
    buffer_load_dword v38, v8, s[8:11], s74 offen
    buffer_load_dword v39, v8, s[8:11], s74 offen offset:256
    v_fmac_f32 v32, v76, v232
    v_fmac_f32 v33, v77, v233
    v_fmac_f32 v34, v78, v234
    v_fmac_f32 v35, v79, v235
    ds_read_b128 v[92:95], v4 offset:4096
    ds_read_b128 v[96:99], v5 offset:4096
    s_mov_b64 exec, s[62:63]
    ds_read_b128 v[148:151], v22 offset:4096
    ds_read_b128 v[152:155], v23 offset:4096
    s_mov_b64 exec, -1
    s_barrier
    s_waitcnt lgkmcnt(0)
    s_add_u32 m0, s81, 16384
    s_nop 0
    buffer_load_dwordx4 v28, s[16:19], s77 offen offset:0 lds
    v_mfma_f32_16x16x32_bf16 v[76:79], v[108:111], v[124:127], 0
    v_mfma_f32_16x16x32_bf16 v[76:79], v[112:115], v[128:131], v[76:79]
    buffer_load_dwordx4 v29, s[16:19], s77 offen offset:1024 lds
    v_fmac_f32 v32, v80, v236
    v_fmac_f32 v33, v81, v237
    v_fmac_f32 v34, v82, v238
    v_fmac_f32 v35, v83, v239
    v_lshlrev_b32 v36, 7, v36
    v_lshlrev_b32 v37, 7, v37
    s_nop 0
    s_add_u32 m0, s82, 4096
    v_add_u32_dpp v25, v36, v2 row_newbcast:0 row_mask:0xf bank_mask:0x3
    v_add_u32_dpp v25, v36, v2 row_newbcast:8 row_mask:0xf bank_mask:0xc
    buffer_load_dwordx4 v25, s[12:15], 0 offen offset:0 lds
    s_mov_b64 exec, s[36:37]
    v_mov_b64 v[132:133], v[124:125]
    v_mov_b64 v[134:135], v[126:127]
    v_mov_b64 v[136:137], v[128:129]
    v_mov_b64 v[138:139], v[130:131]
    s_mov_b64 exec, -1
    v_add_u32_dpp v26, v36, v3 row_newbcast:1 row_mask:0xf bank_mask:0x3
    v_add_u32_dpp v26, v36, v3 row_newbcast:9 row_mask:0xf bank_mask:0xc
    buffer_load_dwordx4 v26, s[24:27], 0 offen offset:1024 lds
    v_mfma_f32_16x16x32_bf16 v[80:83], v[116:119], v[124:127], 0
    v_mfma_f32_16x16x32_bf16 v[80:83], v[120:123], v[128:131], v[80:83]
    s_add_u32 m0, s81, 16384
    s_nop 0
    buffer_load_dwordx4 v30, s[16:19], s77 offen offset:2048 lds
    v_fmac_f32 v32, v72, v240
    v_fmac_f32 v33, v73, v241
    v_fmac_f32 v34, v74, v242
    v_fmac_f32 v35, v75, v243
    buffer_load_dwordx4 v31, s[16:19], s77 offen offset:3072 lds
    s_add_u32 s77, s77, 16384
    v_mfma_f32_16x16x32_bf16 v[72:75], v[124:127], v[132:135], 0
    v_mfma_f32_16x16x32_bf16 v[72:75], v[128:131], v[136:139], v[72:75]
    s_add_u32 m0, s80, 0
    v_add_u32_dpp v27, v59, v1 row_newbcast:1 row_mask:0xf bank_mask:0x3
    v_add_u32_dpp v27, v59, v1 row_newbcast:9 row_mask:0xf bank_mask:0xc
    buffer_load_dwordx4 v27, s[12:15], 0 offen offset:0 lds
    v_fmac_f32 v32, v76, v244
    v_fmac_f32 v33, v77, v245
    v_fmac_f32 v34, v78, v246
    v_fmac_f32 v35, v79, v247
    v_add_u32_dpp v24, v63, v1 row_newbcast:1 row_mask:0xf bank_mask:0x3
    v_add_u32_dpp v24, v63, v1 row_newbcast:9 row_mask:0xf bank_mask:0xc
    buffer_load_dwordx4 v24, s[28:31], 0 offen offset:2048 lds
    s_mov_b64 exec, s[36:37]
    v_mov_b64 v[140:141], v[84:85]
    v_mov_b64 v[142:143], v[86:87]
    v_mov_b64 v[144:145], v[88:89]
    v_mov_b64 v[146:147], v[90:91]
    s_mov_b64 exec, -1
    ds_read_b128 v[100:103], v4 offset:6144
    ds_read_b128 v[104:107], v5 offset:6144
    s_mov_b64 exec, s[64:65]
    ds_read_b128 v[148:151], v22 offset:6144
    ds_read_b128 v[152:155], v23 offset:6144
    s_mov_b64 exec, -1
    s_waitcnt vmcnt(20)
    s_barrier
    s_waitcnt lgkmcnt(0)
    s_add_u32 m0, s81, 32768
    s_nop 0
    buffer_load_dwordx4 v28, s[16:19], s77 offen offset:0 lds
    v_mfma_f32_16x16x32_bf16 v[76:79], v[84:87], v[140:143], 0
    v_mfma_f32_16x16x32_bf16 v[76:79], v[88:91], v[144:147], v[76:79]
    buffer_load_dwordx4 v29, s[16:19], s77 offen offset:1024 lds
    v_fmac_f32 v32, v80, v248
    v_fmac_f32 v33, v81, v249
    v_fmac_f32 v34, v82, v250
    v_fmac_f32 v35, v83, v251
    s_add_u32 m0, s82, 6144
    v_add_u32_dpp v25, v36, v2 row_newbcast:2 row_mask:0xf bank_mask:0x3
    v_add_u32_dpp v25, v36, v2 row_newbcast:10 row_mask:0xf bank_mask:0xc
    buffer_load_dwordx4 v25, s[12:15], 0 offen offset:0 lds
    s_mov_b64 exec, s[36:37]
    v_mov_b64 v[140:141], v[92:93]
    v_mov_b64 v[142:143], v[94:95]
    v_mov_b64 v[144:145], v[96:97]
    v_mov_b64 v[146:147], v[98:99]
    s_mov_b64 exec, -1
    v_add_u32_dpp v26, v36, v3 row_newbcast:3 row_mask:0xf bank_mask:0x3
    v_add_u32_dpp v26, v36, v3 row_newbcast:11 row_mask:0xf bank_mask:0xc
    buffer_load_dwordx4 v26, s[24:27], 0 offen offset:1024 lds
    v_mfma_f32_16x16x32_bf16 v[80:83], v[84:87], v[92:95], 0
    v_mfma_f32_16x16x32_bf16 v[80:83], v[88:91], v[96:99], v[80:83]
    s_add_u32 m0, s81, 32768
    s_nop 0
    buffer_load_dwordx4 v30, s[16:19], s77 offen offset:2048 lds
    v_fmac_f32 v32, v72, v252
    v_fmac_f32 v33, v73, v253
    v_fmac_f32 v34, v74, v254
    v_fmac_f32 v35, v75, v255
    v_add_f32 v12, v32, v33
    v_add_f32 v13, v34, v35
    v_add_f32 v12, v12, v13
    v_mfma_f32_16x16x32_bf16 v[72:75], v[92:95], v[140:143], 0
    v_mfma_f32_16x16x32_bf16 v[72:75], v[96:99], v[144:147], v[72:75]
    buffer_load_dwordx4 v31, s[16:19], s77 offen offset:3072 lds
    s_add_u32 s77, s77, 16384
    v_add_f32_dpp v12, v12, v12 row_shr:1 row_mask:0xf bank_mask:0xf bound_ctrl:0
    v_mul_f32 v32, v76, v164
    v_mul_f32 v33, v77, v165
    v_mul_f32 v34, v78, v166
    v_mul_f32 v35, v79, v167
    s_add_u32 m0, s80, 4096
    v_add_u32_dpp v27, v67, v1 row_newbcast:1 row_mask:0xf bank_mask:0x3
    v_add_u32_dpp v27, v67, v1 row_newbcast:9 row_mask:0xf bank_mask:0xc
    buffer_load_dwordx4 v27, s[12:15], 0 offen offset:0 lds
    v_add_f32_dpp v12, v12, v12 row_shr:2 row_mask:0xf bank_mask:0xf bound_ctrl:0
    v_mfma_f32_16x16x32_bf16 v[76:79], v[84:87], v[100:103], 0
    v_mfma_f32_16x16x32_bf16 v[76:79], v[88:91], v[104:107], v[76:79]
    v_add_u32_dpp v24, v71, v1 row_newbcast:1 row_mask:0xf bank_mask:0x3
    v_add_u32_dpp v24, v71, v1 row_newbcast:9 row_mask:0xf bank_mask:0xc
    buffer_load_dwordx4 v24, s[28:31], 0 offen offset:2048 lds
    v_add_f32_dpp v12, v12, v12 row_shr:4 row_mask:0xf bank_mask:0xf bound_ctrl:0
    v_fmac_f32 v32, v80, v168
    v_fmac_f32 v33, v81, v169
    v_fmac_f32 v34, v82, v170
    v_fmac_f32 v35, v83, v171
    v_add_f32_dpp v12, v12, v12 row_shr:8 row_mask:0xf bank_mask:0xf bound_ctrl:0
    ds_read_b128 v[108:111], v4 offset:8192
    ds_read_b128 v[112:115], v5 offset:8192
    s_mov_b64 exec, s[66:67]
    ds_read_b128 v[148:151], v22 offset:8192
    ds_read_b128 v[152:155], v23 offset:8192
    s_mov_b64 exec, -1
    s_waitcnt vmcnt(18)
    s_barrier
    s_waitcnt lgkmcnt(0)
    s_add_u32 m0, s81, 49152
    s_nop 0
    buffer_load_dwordx4 v28, s[16:19], s77 offen offset:0 lds
    s_mov_b64 exec, s[36:37]
    v_mov_b64 v[140:141], v[100:101]
    v_mov_b64 v[142:143], v[102:103]
    v_mov_b64 v[144:145], v[104:105]
    v_mov_b64 v[146:147], v[106:107]
    s_mov_b64 exec, -1
    buffer_load_dwordx4 v29, s[16:19], s77 offen offset:1024 lds
    v_add_f32_dpp v12, v12, v12 row_bcast:15 row_mask:0xa bank_mask:0xf
    v_mfma_f32_16x16x32_bf16 v[80:83], v[92:95], v[100:103], 0
    v_mfma_f32_16x16x32_bf16 v[80:83], v[96:99], v[104:107], v[80:83]
    s_add_u32 m0, s82, 8192
    v_add_u32_dpp v25, v36, v2 row_newbcast:4 row_mask:0xf bank_mask:0x3
    v_add_u32_dpp v25, v36, v2 row_newbcast:12 row_mask:0xf bank_mask:0xc
    buffer_load_dwordx4 v25, s[12:15], 0 offen offset:0 lds
    v_add_f32_dpp v12, v12, v12 row_bcast:31 row_mask:0xc bank_mask:0xf
    v_fmac_f32 v32, v72, v172
    v_fmac_f32 v33, v73, v173
    v_fmac_f32 v34, v74, v174
    v_fmac_f32 v35, v75, v175
    v_add_u32_dpp v26, v36, v3 row_newbcast:5 row_mask:0xf bank_mask:0x3
    v_add_u32_dpp v26, v36, v3 row_newbcast:13 row_mask:0xf bank_mask:0xc
    buffer_load_dwordx4 v26, s[24:27], 0 offen offset:1024 lds
    v_readlane_b32 s38, v12, 63
    v_mfma_f32_16x16x32_bf16 v[72:75], v[84:87], v[108:111], 0
    v_mfma_f32_16x16x32_bf16 v[72:75], v[88:91], v[112:115], v[72:75]
    s_add_u32 m0, s81, 49152
    s_nop 0
    buffer_load_dwordx4 v30, s[16:19], s77 offen offset:2048 lds
    v_writelane_b32 v9, s38, 10
    v_fmac_f32 v32, v76, v176
    v_fmac_f32 v33, v77, v177
    v_fmac_f32 v34, v78, v178
    v_fmac_f32 v35, v79, v179
    v_mfma_f32_16x16x32_bf16 v[76:79], v[100:103], v[140:143], 0
    v_mfma_f32_16x16x32_bf16 v[76:79], v[104:107], v[144:147], v[76:79]
    buffer_load_dwordx4 v31, s[16:19], s77 offen offset:3072 lds
    s_add_u32 s77, s77, 16384
    v_fmac_f32 v32, v80, v180
    v_fmac_f32 v33, v81, v181
    v_fmac_f32 v34, v82, v182
    v_fmac_f32 v35, v83, v183
    s_add_u32 m0, s80, 16384
    v_add_u32_dpp v27, v56, v1 row_newbcast:2 row_mask:0xf bank_mask:0x3
    v_add_u32_dpp v27, v56, v1 row_newbcast:10 row_mask:0xf bank_mask:0xc
    buffer_load_dwordx4 v27, s[12:15], 0 offen offset:0 lds
    v_mfma_f32_16x16x32_bf16 v[80:83], v[92:95], v[108:111], 0
    v_mfma_f32_16x16x32_bf16 v[80:83], v[96:99], v[112:115], v[80:83]
    v_add_u32_dpp v24, v60, v1 row_newbcast:2 row_mask:0xf bank_mask:0x3
    v_add_u32_dpp v24, v60, v1 row_newbcast:10 row_mask:0xf bank_mask:0xc
    buffer_load_dwordx4 v24, s[28:31], 0 offen offset:2048 lds
    v_fmac_f32 v32, v72, v184
    v_fmac_f32 v33, v73, v185
    v_fmac_f32 v34, v74, v186
    v_fmac_f32 v35, v75, v187
    ds_read_b128 v[116:119], v4 offset:0
    ds_read_b128 v[120:123], v5 offset:0
    s_mov_b64 exec, s[60:61]
    ds_read_b128 v[156:159], v22 offset:0
    ds_read_b128 v[160:163], v23 offset:0
    s_mov_b64 exec, -1
    s_waitcnt vmcnt(18)
    s_barrier
    s_waitcnt lgkmcnt(0)
    s_add_u32 m0, s81, 0
    s_nop 0
    buffer_load_dwordx4 v28, s[16:19], s77 offen offset:0 lds
    v_mfma_f32_16x16x32_bf16 v[72:75], v[148:151], v[148:151], 0
    v_mfma_f32_16x16x32_bf16 v[72:75], v[152:155], v[152:155], v[72:75]
    buffer_load_dwordx4 v29, s[16:19], s77 offen offset:1024 lds
    v_fmac_f32 v32, v76, v188
    v_fmac_f32 v33, v77, v189
    v_fmac_f32 v34, v78, v190
    v_fmac_f32 v35, v79, v191
    s_add_u32 m0, s82, 0
    v_add_u32_dpp v25, v36, v2 row_newbcast:6 row_mask:0xf bank_mask:0x3
    v_add_u32_dpp v25, v36, v2 row_newbcast:14 row_mask:0xf bank_mask:0xc
    buffer_load_dwordx4 v25, s[12:15], 0 offen offset:0 lds
    v_mfma_f32_16x16x32_bf16 v[76:79], v[84:87], v[116:119], 0
    v_mfma_f32_16x16x32_bf16 v[76:79], v[88:91], v[120:123], v[76:79]
    v_add_u32_dpp v26, v36, v3 row_newbcast:7 row_mask:0xf bank_mask:0x3
    v_add_u32_dpp v26, v36, v3 row_newbcast:15 row_mask:0xf bank_mask:0xc
    buffer_load_dwordx4 v26, s[24:27], 0 offen offset:1024 lds
    v_fmac_f32 v32, v80, v192
    v_fmac_f32 v33, v81, v193
    v_fmac_f32 v34, v82, v194
    v_fmac_f32 v35, v83, v195
    s_add_u32 m0, s81, 0
    s_nop 0
    buffer_load_dwordx4 v30, s[16:19], s77 offen offset:2048 lds
    s_mov_b64 exec, s[36:37]
    v_mov_b64 v[140:141], v[108:109]
    v_mov_b64 v[142:143], v[110:111]
    v_mov_b64 v[144:145], v[112:113]
    v_mov_b64 v[146:147], v[114:115]
    s_mov_b64 exec, -1
    buffer_load_dwordx4 v31, s[16:19], s77 offen offset:3072 lds
    s_add_u32 s77, s77, 16384
    v_mfma_f32_16x16x32_bf16 v[80:83], v[100:103], v[108:111], 0
    v_mfma_f32_16x16x32_bf16 v[80:83], v[104:107], v[112:115], v[80:83]
    s_add_u32 m0, s80, 20480
    v_add_u32_dpp v27, v64, v1 row_newbcast:2 row_mask:0xf bank_mask:0x3
    v_add_u32_dpp v27, v64, v1 row_newbcast:10 row_mask:0xf bank_mask:0xc
    buffer_load_dwordx4 v27, s[12:15], 0 offen offset:0 lds
    v_fmac_f32 v32, v72, v196
    v_fmac_f32 v33, v73, v197
    v_fmac_f32 v34, v74, v198
    v_fmac_f32 v35, v75, v199
    v_add_u32_dpp v24, v68, v1 row_newbcast:2 row_mask:0xf bank_mask:0x3
    v_add_u32_dpp v24, v68, v1 row_newbcast:10 row_mask:0xf bank_mask:0xc
    buffer_load_dwordx4 v24, s[28:31], 0 offen offset:2048 lds
    v_mfma_f32_16x16x32_bf16 v[72:75], v[92:95], v[116:119], 0
    v_mfma_f32_16x16x32_bf16 v[72:75], v[96:99], v[120:123], v[72:75]
    s_add_u32 m0, s82, 10240
    v_add_u32_dpp v25, v37, v2 row_newbcast:4 row_mask:0xf bank_mask:0x3
    v_add_u32_dpp v25, v37, v2 row_newbcast:12 row_mask:0xf bank_mask:0xc
    s_mov_b32 exec_hi, 0
    buffer_load_dwordx4 v25, s[12:15], 0 offen offset:0 lds
    s_mov_b32 exec_hi, -1
    v_fmac_f32 v32, v76, v200
    v_fmac_f32 v33, v77, v201
    v_fmac_f32 v34, v78, v202
    v_fmac_f32 v35, v79, v203
    ds_read_b128 v[124:127], v4 offset:2048
    ds_read_b128 v[128:131], v5 offset:2048
    s_mov_b64 exec, s[62:63]
    ds_read_b128 v[156:159], v22 offset:2048
    ds_read_b128 v[160:163], v23 offset:2048
    s_mov_b64 exec, -1
    s_waitcnt vmcnt(17)
    s_barrier
    s_waitcnt lgkmcnt(0)
    s_add_u32 m0, s81, 16384
    s_nop 0
    buffer_load_dwordx4 v28, s[16:19], s77 offen offset:0 lds
    v_mfma_f32_16x16x32_bf16 v[76:79], v[84:87], v[124:127], 0
    v_mfma_f32_16x16x32_bf16 v[76:79], v[88:91], v[128:131], v[76:79]
    buffer_load_dwordx4 v29, s[16:19], s77 offen offset:1024 lds
    v_fmac_f32 v32, v80, v204
    v_fmac_f32 v33, v81, v205
    v_fmac_f32 v34, v82, v206
    v_fmac_f32 v35, v83, v207
    s_add_u32 m0, s82, 2048
    v_add_u32_dpp v26, v37, v2 row_newbcast:0 row_mask:0xf bank_mask:0x3
    v_add_u32_dpp v26, v37, v2 row_newbcast:8 row_mask:0xf bank_mask:0xc
    buffer_load_dwordx4 v26, s[12:15], 0 offen offset:0 lds
    v_mfma_f32_16x16x32_bf16 v[80:83], v[108:111], v[140:143], 0
    v_mfma_f32_16x16x32_bf16 v[80:83], v[112:115], v[144:147], v[80:83]
    v_add_u32_dpp v27, v37, v3 row_newbcast:1 row_mask:0xf bank_mask:0x3
    v_add_u32_dpp v27, v37, v3 row_newbcast:9 row_mask:0xf bank_mask:0xc
    buffer_load_dwordx4 v27, s[24:27], 0 offen offset:1024 lds
    v_fmac_f32 v32, v72, v208
    v_fmac_f32 v33, v73, v209
    v_fmac_f32 v34, v74, v210
    v_fmac_f32 v35, v75, v211
    s_add_u32 m0, s81, 16384
    s_nop 0
    buffer_load_dwordx4 v30, s[16:19], s77 offen offset:2048 lds
    v_mfma_f32_16x16x32_bf16 v[72:75], v[92:95], v[124:127], 0
    v_mfma_f32_16x16x32_bf16 v[72:75], v[96:99], v[128:131], v[72:75]
    buffer_load_dwordx4 v31, s[16:19], s77 offen offset:3072 lds
    s_add_u32 s77, s77, 16384
    v_fmac_f32 v32, v76, v212
    v_fmac_f32 v33, v77, v213
    v_fmac_f32 v34, v78, v214
    v_fmac_f32 v35, v79, v215
    s_add_u32 m0, s80, 32768
    v_add_u32_dpp v24, v57, v1 row_newbcast:2 row_mask:0xf bank_mask:0x3
    v_add_u32_dpp v24, v57, v1 row_newbcast:10 row_mask:0xf bank_mask:0xc
    buffer_load_dwordx4 v24, s[12:15], 0 offen offset:0 lds
    v_mfma_f32_16x16x32_bf16 v[76:79], v[156:159], v[156:159], 0
    v_mfma_f32_16x16x32_bf16 v[76:79], v[160:163], v[160:163], v[76:79]
    v_add_u32_dpp v25, v61, v1 row_newbcast:2 row_mask:0xf bank_mask:0x3
    v_add_u32_dpp v25, v61, v1 row_newbcast:10 row_mask:0xf bank_mask:0xc
    buffer_load_dwordx4 v25, s[28:31], 0 offen offset:2048 lds
    v_fmac_f32 v32, v80, v216
    v_fmac_f32 v33, v81, v217
    v_fmac_f32 v34, v82, v218
    v_fmac_f32 v35, v83, v219
    ds_read_b128 v[84:87], v4 offset:4096
    ds_read_b128 v[88:91], v5 offset:4096
    s_mov_b64 exec, s[60:61]
    ds_read_b128 v[148:151], v22 offset:4096
    ds_read_b128 v[152:155], v23 offset:4096
    s_mov_b64 exec, -1
    s_waitcnt vmcnt(8)
    s_mov_b64 exec, s[60:61]
    ds_read_b128 v[132:135], v4 offset:10240
    ds_read_b128 v[136:139], v5 offset:10240
    s_mov_b64 exec, s[64:65]
    ds_read_b128 v[156:159], v22 offset:10240
    ds_read_b128 v[160:163], v23 offset:10240
    s_mov_b64 exec, -1
    s_barrier
    s_waitcnt lgkmcnt(0)
    s_add_u32 m0, s81, 32768
    s_nop 0
    buffer_load_dwordx4 v28, s[16:19], s77 offen offset:0 lds
    v_mfma_f32_16x16x32_bf16 v[80:83], v[100:103], v[116:119], 0
    v_mfma_f32_16x16x32_bf16 v[80:83], v[104:107], v[120:123], v[80:83]
    buffer_load_dwordx4 v29, s[16:19], s77 offen offset:1024 lds
    v_fmac_f32 v32, v72, v220
    v_fmac_f32 v33, v73, v221
    v_fmac_f32 v34, v74, v222
    v_fmac_f32 v35, v75, v223
    s_add_u32 m0, s82, 4096
    v_add_u32_dpp v26, v37, v2 row_newbcast:2 row_mask:0xf bank_mask:0x3
    v_add_u32_dpp v26, v37, v2 row_newbcast:10 row_mask:0xf bank_mask:0xc
    buffer_load_dwordx4 v26, s[12:15], 0 offen offset:0 lds
    s_mov_b64 exec, s[36:37]
    v_mov_b64 v[140:141], v[116:117]
    v_mov_b64 v[142:143], v[118:119]
    v_mov_b64 v[144:145], v[120:121]
    v_mov_b64 v[146:147], v[122:123]
    s_mov_b64 exec, -1
    v_add_u32_dpp v27, v37, v3 row_newbcast:3 row_mask:0xf bank_mask:0x3
    v_add_u32_dpp v27, v37, v3 row_newbcast:11 row_mask:0xf bank_mask:0xc
    buffer_load_dwordx4 v27, s[24:27], 0 offen offset:1024 lds
    v_mfma_f32_16x16x32_bf16 v[72:75], v[108:111], v[116:119], 0
    v_mfma_f32_16x16x32_bf16 v[72:75], v[112:115], v[120:123], v[72:75]
    s_add_u32 m0, s81, 32768
    s_nop 0
    buffer_load_dwordx4 v30, s[16:19], s77 offen offset:2048 lds
    v_fmac_f32 v32, v76, v224
    v_fmac_f32 v33, v77, v225
    v_fmac_f32 v34, v78, v226
    v_fmac_f32 v35, v79, v227
    buffer_load_dwordx4 v31, s[16:19], s77 offen offset:3072 lds
    s_add_u32 s77, s77, 16384
    v_mfma_f32_16x16x32_bf16 v[76:79], v[100:103], v[124:127], 0
    v_mfma_f32_16x16x32_bf16 v[76:79], v[104:107], v[128:131], v[76:79]
    s_add_u32 m0, s80, 36864
    v_add_u32_dpp v24, v65, v1 row_newbcast:2 row_mask:0xf bank_mask:0x3
    v_add_u32_dpp v24, v65, v1 row_newbcast:10 row_mask:0xf bank_mask:0xc
    buffer_load_dwordx4 v24, s[12:15], 0 offen offset:0 lds
    v_fmac_f32 v32, v80, v228
    v_fmac_f32 v33, v81, v229
    v_fmac_f32 v34, v82, v230
    v_fmac_f32 v35, v83, v231
    v_add_u32_dpp v25, v69, v1 row_newbcast:2 row_mask:0xf bank_mask:0x3
    v_add_u32_dpp v25, v69, v1 row_newbcast:10 row_mask:0xf bank_mask:0xc
    buffer_load_dwordx4 v25, s[28:31], 0 offen offset:2048 lds
    v_mfma_f32_16x16x32_bf16 v[80:83], v[116:119], v[140:143], 0
    v_mfma_f32_16x16x32_bf16 v[80:83], v[120:123], v[144:147], v[80:83]
    s_movk_i32 s74, 22400
    buffer_load_dword v36, v8, s[8:11], s74 offen
    buffer_load_dword v37, v8, s[8:11], s74 offen offset:256
    v_fmac_f32 v32, v72, v232
    v_fmac_f32 v33, v73, v233
    v_fmac_f32 v34, v74, v234
    v_fmac_f32 v35, v75, v235
    ds_read_b128 v[92:95], v4 offset:6144
    ds_read_b128 v[96:99], v5 offset:6144
    s_mov_b64 exec, s[62:63]
    ds_read_b128 v[148:151], v22 offset:6144
    ds_read_b128 v[152:155], v23 offset:6144
    s_mov_b64 exec, -1
    s_barrier
    s_waitcnt lgkmcnt(0)
    s_add_u32 m0, s81, 49152
    s_nop 0
    buffer_load_dwordx4 v28, s[16:19], s77 offen offset:0 lds
    v_mfma_f32_16x16x32_bf16 v[72:75], v[108:111], v[124:127], 0
    v_mfma_f32_16x16x32_bf16 v[72:75], v[112:115], v[128:131], v[72:75]
    buffer_load_dwordx4 v29, s[16:19], s77 offen offset:1024 lds
    v_fmac_f32 v32, v76, v236
    v_fmac_f32 v33, v77, v237
    v_fmac_f32 v34, v78, v238
    v_fmac_f32 v35, v79, v239
    v_lshlrev_b32 v38, 7, v38
    v_lshlrev_b32 v39, 7, v39
    s_nop 0
    s_add_u32 m0, s82, 6144
    v_add_u32_dpp v26, v38, v2 row_newbcast:0 row_mask:0xf bank_mask:0x3
    v_add_u32_dpp v26, v38, v2 row_newbcast:8 row_mask:0xf bank_mask:0xc
    buffer_load_dwordx4 v26, s[12:15], 0 offen offset:0 lds
    s_mov_b64 exec, s[36:37]
    v_mov_b64 v[140:141], v[124:125]
    v_mov_b64 v[142:143], v[126:127]
    v_mov_b64 v[144:145], v[128:129]
    v_mov_b64 v[146:147], v[130:131]
    s_mov_b64 exec, -1
    v_add_u32_dpp v27, v38, v3 row_newbcast:1 row_mask:0xf bank_mask:0x3
    v_add_u32_dpp v27, v38, v3 row_newbcast:9 row_mask:0xf bank_mask:0xc
    buffer_load_dwordx4 v27, s[24:27], 0 offen offset:1024 lds
    v_mfma_f32_16x16x32_bf16 v[76:79], v[116:119], v[124:127], 0
    v_mfma_f32_16x16x32_bf16 v[76:79], v[120:123], v[128:131], v[76:79]
    s_add_u32 m0, s81, 49152
    s_nop 0
    buffer_load_dwordx4 v30, s[16:19], s77 offen offset:2048 lds
    v_fmac_f32 v32, v80, v240
    v_fmac_f32 v33, v81, v241
    v_fmac_f32 v34, v82, v242
    v_fmac_f32 v35, v83, v243
    buffer_load_dwordx4 v31, s[16:19], s77 offen offset:3072 lds
    s_add_u32 s77, s77, 16384
    v_mfma_f32_16x16x32_bf16 v[80:83], v[124:127], v[140:143], 0
    v_mfma_f32_16x16x32_bf16 v[80:83], v[128:131], v[144:147], v[80:83]
    s_add_u32 m0, s80, 0
    v_add_u32_dpp v24, v58, v1 row_newbcast:2 row_mask:0xf bank_mask:0x3
    v_add_u32_dpp v24, v58, v1 row_newbcast:10 row_mask:0xf bank_mask:0xc
    buffer_load_dwordx4 v24, s[12:15], 0 offen offset:0 lds
    v_fmac_f32 v32, v72, v244
    v_fmac_f32 v33, v73, v245
    v_fmac_f32 v34, v74, v246
    v_fmac_f32 v35, v75, v247
    v_add_u32_dpp v25, v62, v1 row_newbcast:2 row_mask:0xf bank_mask:0x3
    v_add_u32_dpp v25, v62, v1 row_newbcast:10 row_mask:0xf bank_mask:0xc
    buffer_load_dwordx4 v25, s[28:31], 0 offen offset:2048 lds
    s_mov_b64 exec, s[36:37]
    v_mov_b64 v[132:133], v[84:85]
    v_mov_b64 v[134:135], v[86:87]
    v_mov_b64 v[136:137], v[88:89]
    v_mov_b64 v[138:139], v[90:91]
    s_mov_b64 exec, -1
    ds_read_b128 v[100:103], v4 offset:8192
    ds_read_b128 v[104:107], v5 offset:8192
    s_mov_b64 exec, s[64:65]
    ds_read_b128 v[148:151], v22 offset:8192
    ds_read_b128 v[152:155], v23 offset:8192
    s_mov_b64 exec, -1
    s_waitcnt vmcnt(20)
    s_barrier
    s_waitcnt lgkmcnt(0)
    s_add_u32 m0, s81, 0
    s_nop 0
    buffer_load_dwordx4 v28, s[16:19], s77 offen offset:0 lds
    v_mfma_f32_16x16x32_bf16 v[72:75], v[84:87], v[132:135], 0
    v_mfma_f32_16x16x32_bf16 v[72:75], v[88:91], v[136:139], v[72:75]
    buffer_load_dwordx4 v29, s[16:19], s77 offen offset:1024 lds
    v_fmac_f32 v32, v76, v248
    v_fmac_f32 v33, v77, v249
    v_fmac_f32 v34, v78, v250
    v_fmac_f32 v35, v79, v251
    s_add_u32 m0, s82, 8192
    v_add_u32_dpp v26, v38, v2 row_newbcast:2 row_mask:0xf bank_mask:0x3
    v_add_u32_dpp v26, v38, v2 row_newbcast:10 row_mask:0xf bank_mask:0xc
    buffer_load_dwordx4 v26, s[12:15], 0 offen offset:0 lds
    s_mov_b64 exec, s[36:37]
    v_mov_b64 v[132:133], v[92:93]
    v_mov_b64 v[134:135], v[94:95]
    v_mov_b64 v[136:137], v[96:97]
    v_mov_b64 v[138:139], v[98:99]
    s_mov_b64 exec, -1
    v_add_u32_dpp v27, v38, v3 row_newbcast:3 row_mask:0xf bank_mask:0x3
    v_add_u32_dpp v27, v38, v3 row_newbcast:11 row_mask:0xf bank_mask:0xc
    buffer_load_dwordx4 v27, s[24:27], 0 offen offset:1024 lds
    v_mfma_f32_16x16x32_bf16 v[76:79], v[84:87], v[92:95], 0
    v_mfma_f32_16x16x32_bf16 v[76:79], v[88:91], v[96:99], v[76:79]
    s_add_u32 m0, s81, 0
    s_nop 0
    buffer_load_dwordx4 v30, s[16:19], s77 offen offset:2048 lds
    v_fmac_f32 v32, v80, v252
    v_fmac_f32 v33, v81, v253
    v_fmac_f32 v34, v82, v254
    v_fmac_f32 v35, v83, v255
    v_add_f32 v12, v32, v33
    v_add_f32 v13, v34, v35
    v_add_f32 v12, v12, v13
    v_mfma_f32_16x16x32_bf16 v[80:83], v[92:95], v[132:135], 0
    v_mfma_f32_16x16x32_bf16 v[80:83], v[96:99], v[136:139], v[80:83]
    buffer_load_dwordx4 v31, s[16:19], s77 offen offset:3072 lds
    s_add_u32 s77, s77, 16384
    v_add_f32_dpp v12, v12, v12 row_shr:1 row_mask:0xf bank_mask:0xf bound_ctrl:0
    v_mul_f32 v32, v72, v164
    v_mul_f32 v33, v73, v165
    v_mul_f32 v34, v74, v166
    v_mul_f32 v35, v75, v167
    s_add_u32 m0, s80, 4096
    v_add_u32_dpp v24, v66, v1 row_newbcast:2 row_mask:0xf bank_mask:0x3
    v_add_u32_dpp v24, v66, v1 row_newbcast:10 row_mask:0xf bank_mask:0xc
    buffer_load_dwordx4 v24, s[12:15], 0 offen offset:0 lds
    v_add_f32_dpp v12, v12, v12 row_shr:2 row_mask:0xf bank_mask:0xf bound_ctrl:0
    v_mfma_f32_16x16x32_bf16 v[72:75], v[84:87], v[100:103], 0
    v_mfma_f32_16x16x32_bf16 v[72:75], v[88:91], v[104:107], v[72:75]
    v_add_u32_dpp v25, v70, v1 row_newbcast:2 row_mask:0xf bank_mask:0x3
    v_add_u32_dpp v25, v70, v1 row_newbcast:10 row_mask:0xf bank_mask:0xc
    buffer_load_dwordx4 v25, s[28:31], 0 offen offset:2048 lds
    v_add_f32_dpp v12, v12, v12 row_shr:4 row_mask:0xf bank_mask:0xf bound_ctrl:0
    v_fmac_f32 v32, v76, v168
    v_fmac_f32 v33, v77, v169
    v_fmac_f32 v34, v78, v170
    v_fmac_f32 v35, v79, v171
    v_add_f32_dpp v12, v12, v12 row_shr:8 row_mask:0xf bank_mask:0xf bound_ctrl:0
    ds_read_b128 v[108:111], v4 offset:0
    ds_read_b128 v[112:115], v5 offset:0
    s_mov_b64 exec, s[66:67]
    ds_read_b128 v[148:151], v22 offset:0
    ds_read_b128 v[152:155], v23 offset:0
    s_mov_b64 exec, -1
    s_waitcnt vmcnt(18)
    s_barrier
    s_waitcnt lgkmcnt(0)
    s_add_u32 m0, s81, 16384
    s_nop 0
    buffer_load_dwordx4 v28, s[16:19], s77 offen offset:0 lds
    s_mov_b64 exec, s[36:37]
    v_mov_b64 v[132:133], v[100:101]
    v_mov_b64 v[134:135], v[102:103]
    v_mov_b64 v[136:137], v[104:105]
    v_mov_b64 v[138:139], v[106:107]
    s_mov_b64 exec, -1
    buffer_load_dwordx4 v29, s[16:19], s77 offen offset:1024 lds
    v_add_f32_dpp v12, v12, v12 row_bcast:15 row_mask:0xa bank_mask:0xf
    v_mfma_f32_16x16x32_bf16 v[76:79], v[92:95], v[100:103], 0
    v_mfma_f32_16x16x32_bf16 v[76:79], v[96:99], v[104:107], v[76:79]
    s_add_u32 m0, s82, 0
    v_add_u32_dpp v26, v38, v2 row_newbcast:4 row_mask:0xf bank_mask:0x3
    v_add_u32_dpp v26, v38, v2 row_newbcast:12 row_mask:0xf bank_mask:0xc
    buffer_load_dwordx4 v26, s[12:15], 0 offen offset:0 lds
    v_add_f32_dpp v12, v12, v12 row_bcast:31 row_mask:0xc bank_mask:0xf
    v_fmac_f32 v32, v80, v172
    v_fmac_f32 v33, v81, v173
    v_fmac_f32 v34, v82, v174
    v_fmac_f32 v35, v83, v175
    v_add_u32_dpp v27, v38, v3 row_newbcast:5 row_mask:0xf bank_mask:0x3
    v_add_u32_dpp v27, v38, v3 row_newbcast:13 row_mask:0xf bank_mask:0xc
    buffer_load_dwordx4 v27, s[24:27], 0 offen offset:1024 lds
    v_readlane_b32 s38, v12, 63
    v_mfma_f32_16x16x32_bf16 v[80:83], v[84:87], v[108:111], 0
    v_mfma_f32_16x16x32_bf16 v[80:83], v[88:91], v[112:115], v[80:83]
    s_add_u32 m0, s81, 16384
    s_nop 0
    buffer_load_dwordx4 v30, s[16:19], s77 offen offset:2048 lds
    v_writelane_b32 v9, s38, 11
    v_fmac_f32 v32, v72, v176
    v_fmac_f32 v33, v73, v177
    v_fmac_f32 v34, v74, v178
    v_fmac_f32 v35, v75, v179
    v_mfma_f32_16x16x32_bf16 v[72:75], v[100:103], v[132:135], 0
    v_mfma_f32_16x16x32_bf16 v[72:75], v[104:107], v[136:139], v[72:75]
    buffer_load_dwordx4 v31, s[16:19], s77 offen offset:3072 lds
    s_add_u32 s77, s77, 16384
    v_fmac_f32 v32, v76, v180
    v_fmac_f32 v33, v77, v181
    v_fmac_f32 v34, v78, v182
    v_fmac_f32 v35, v79, v183
    s_add_u32 m0, s80, 16384
    v_add_u32_dpp v24, v59, v1 row_newbcast:2 row_mask:0xf bank_mask:0x3
    v_add_u32_dpp v24, v59, v1 row_newbcast:10 row_mask:0xf bank_mask:0xc
    buffer_load_dwordx4 v24, s[12:15], 0 offen offset:0 lds
    v_mfma_f32_16x16x32_bf16 v[76:79], v[92:95], v[108:111], 0
    v_mfma_f32_16x16x32_bf16 v[76:79], v[96:99], v[112:115], v[76:79]
    v_add_u32_dpp v25, v63, v1 row_newbcast:2 row_mask:0xf bank_mask:0x3
    v_add_u32_dpp v25, v63, v1 row_newbcast:10 row_mask:0xf bank_mask:0xc
    buffer_load_dwordx4 v25, s[28:31], 0 offen offset:2048 lds
    v_fmac_f32 v32, v80, v184
    v_fmac_f32 v33, v81, v185
    v_fmac_f32 v34, v82, v186
    v_fmac_f32 v35, v83, v187
    ds_read_b128 v[116:119], v4 offset:2048
    ds_read_b128 v[120:123], v5 offset:2048
    s_mov_b64 exec, s[60:61]
    ds_read_b128 v[156:159], v22 offset:2048
    ds_read_b128 v[160:163], v23 offset:2048
    s_mov_b64 exec, -1
    s_waitcnt vmcnt(18)
    s_barrier
    s_waitcnt lgkmcnt(0)
    s_add_u32 m0, s81, 32768
    s_nop 0
    buffer_load_dwordx4 v28, s[16:19], s77 offen offset:0 lds
    v_mfma_f32_16x16x32_bf16 v[80:83], v[148:151], v[148:151], 0
    v_mfma_f32_16x16x32_bf16 v[80:83], v[152:155], v[152:155], v[80:83]
    buffer_load_dwordx4 v29, s[16:19], s77 offen offset:1024 lds
    v_fmac_f32 v32, v72, v188
    v_fmac_f32 v33, v73, v189
    v_fmac_f32 v34, v74, v190
    v_fmac_f32 v35, v75, v191
    s_add_u32 m0, s82, 2048
    v_add_u32_dpp v26, v38, v2 row_newbcast:6 row_mask:0xf bank_mask:0x3
    v_add_u32_dpp v26, v38, v2 row_newbcast:14 row_mask:0xf bank_mask:0xc
    buffer_load_dwordx4 v26, s[12:15], 0 offen offset:0 lds
    v_mfma_f32_16x16x32_bf16 v[72:75], v[84:87], v[116:119], 0
    v_mfma_f32_16x16x32_bf16 v[72:75], v[88:91], v[120:123], v[72:75]
    v_add_u32_dpp v27, v38, v3 row_newbcast:7 row_mask:0xf bank_mask:0x3
    v_add_u32_dpp v27, v38, v3 row_newbcast:15 row_mask:0xf bank_mask:0xc
    buffer_load_dwordx4 v27, s[24:27], 0 offen offset:1024 lds
    v_fmac_f32 v32, v76, v192
    v_fmac_f32 v33, v77, v193
    v_fmac_f32 v34, v78, v194
    v_fmac_f32 v35, v79, v195
    s_add_u32 m0, s81, 32768
    s_nop 0
    buffer_load_dwordx4 v30, s[16:19], s77 offen offset:2048 lds
    s_mov_b64 exec, s[36:37]
    v_mov_b64 v[132:133], v[108:109]
    v_mov_b64 v[134:135], v[110:111]
    v_mov_b64 v[136:137], v[112:113]
    v_mov_b64 v[138:139], v[114:115]
    s_mov_b64 exec, -1
    buffer_load_dwordx4 v31, s[16:19], s77 offen offset:3072 lds
    s_add_u32 s77, s77, 16384
    v_mfma_f32_16x16x32_bf16 v[76:79], v[100:103], v[108:111], 0
    v_mfma_f32_16x16x32_bf16 v[76:79], v[104:107], v[112:115], v[76:79]
    s_add_u32 m0, s80, 20480
    v_add_u32_dpp v24, v67, v1 row_newbcast:2 row_mask:0xf bank_mask:0x3
    v_add_u32_dpp v24, v67, v1 row_newbcast:10 row_mask:0xf bank_mask:0xc
    buffer_load_dwordx4 v24, s[12:15], 0 offen offset:0 lds
    v_fmac_f32 v32, v80, v196
    v_fmac_f32 v33, v81, v197
    v_fmac_f32 v34, v82, v198
    v_fmac_f32 v35, v83, v199
    v_add_u32_dpp v25, v71, v1 row_newbcast:2 row_mask:0xf bank_mask:0x3
    v_add_u32_dpp v25, v71, v1 row_newbcast:10 row_mask:0xf bank_mask:0xc
    buffer_load_dwordx4 v25, s[28:31], 0 offen offset:2048 lds
    v_mfma_f32_16x16x32_bf16 v[80:83], v[92:95], v[116:119], 0
    v_mfma_f32_16x16x32_bf16 v[80:83], v[96:99], v[120:123], v[80:83]
    s_add_u32 m0, s82, 10240
    v_add_u32_dpp v26, v39, v2 row_newbcast:4 row_mask:0xf bank_mask:0x3
    v_add_u32_dpp v26, v39, v2 row_newbcast:12 row_mask:0xf bank_mask:0xc
    s_mov_b32 exec_hi, 0
    buffer_load_dwordx4 v26, s[12:15], 0 offen offset:0 lds
    s_mov_b32 exec_hi, -1
    v_fmac_f32 v32, v72, v200
    v_fmac_f32 v33, v73, v201
    v_fmac_f32 v34, v74, v202
    v_fmac_f32 v35, v75, v203
    ds_read_b128 v[124:127], v4 offset:4096
    ds_read_b128 v[128:131], v5 offset:4096
    s_mov_b64 exec, s[62:63]
    ds_read_b128 v[156:159], v22 offset:4096
    ds_read_b128 v[160:163], v23 offset:4096
    s_mov_b64 exec, -1
    s_waitcnt vmcnt(17)
    s_barrier
    s_waitcnt lgkmcnt(0)
    s_add_u32 m0, s81, 49152
    s_nop 0
    buffer_load_dwordx4 v28, s[16:19], s77 offen offset:0 lds
    v_mfma_f32_16x16x32_bf16 v[72:75], v[84:87], v[124:127], 0
    v_mfma_f32_16x16x32_bf16 v[72:75], v[88:91], v[128:131], v[72:75]
    buffer_load_dwordx4 v29, s[16:19], s77 offen offset:1024 lds
    v_fmac_f32 v32, v76, v204
    v_fmac_f32 v33, v77, v205
    v_fmac_f32 v34, v78, v206
    v_fmac_f32 v35, v79, v207
    s_add_u32 m0, s82, 4096
    v_add_u32_dpp v27, v39, v2 row_newbcast:0 row_mask:0xf bank_mask:0x3
    v_add_u32_dpp v27, v39, v2 row_newbcast:8 row_mask:0xf bank_mask:0xc
    buffer_load_dwordx4 v27, s[12:15], 0 offen offset:0 lds
    v_mfma_f32_16x16x32_bf16 v[76:79], v[108:111], v[132:135], 0
    v_mfma_f32_16x16x32_bf16 v[76:79], v[112:115], v[136:139], v[76:79]
    v_add_u32_dpp v24, v39, v3 row_newbcast:1 row_mask:0xf bank_mask:0x3
    v_add_u32_dpp v24, v39, v3 row_newbcast:9 row_mask:0xf bank_mask:0xc
    buffer_load_dwordx4 v24, s[24:27], 0 offen offset:1024 lds
    v_fmac_f32 v32, v80, v208
    v_fmac_f32 v33, v81, v209
    v_fmac_f32 v34, v82, v210
    v_fmac_f32 v35, v83, v211
    s_add_u32 m0, s81, 49152
    s_nop 0
    buffer_load_dwordx4 v30, s[16:19], s77 offen offset:2048 lds
    v_mfma_f32_16x16x32_bf16 v[80:83], v[92:95], v[124:127], 0
    v_mfma_f32_16x16x32_bf16 v[80:83], v[96:99], v[128:131], v[80:83]
    buffer_load_dwordx4 v31, s[16:19], s77 offen offset:3072 lds
    s_add_u32 s77, s77, 16384
    v_fmac_f32 v32, v72, v212
    v_fmac_f32 v33, v73, v213
    v_fmac_f32 v34, v74, v214
    v_fmac_f32 v35, v75, v215
    s_add_u32 m0, s80, 32768
    v_add_u32_dpp v25, v56, v1 row_newbcast:3 row_mask:0xf bank_mask:0x3
    v_add_u32_dpp v25, v56, v1 row_newbcast:11 row_mask:0xf bank_mask:0xc
    buffer_load_dwordx4 v25, s[12:15], 0 offen offset:0 lds
    v_mfma_f32_16x16x32_bf16 v[72:75], v[156:159], v[156:159], 0
    v_mfma_f32_16x16x32_bf16 v[72:75], v[160:163], v[160:163], v[72:75]
    v_add_u32_dpp v26, v60, v1 row_newbcast:3 row_mask:0xf bank_mask:0x3
    v_add_u32_dpp v26, v60, v1 row_newbcast:11 row_mask:0xf bank_mask:0xc
    buffer_load_dwordx4 v26, s[28:31], 0 offen offset:2048 lds
    v_fmac_f32 v32, v76, v216
    v_fmac_f32 v33, v77, v217
    v_fmac_f32 v34, v78, v218
    v_fmac_f32 v35, v79, v219
    ds_read_b128 v[84:87], v4 offset:6144
    ds_read_b128 v[88:91], v5 offset:6144
    s_mov_b64 exec, s[60:61]
    ds_read_b128 v[148:151], v22 offset:6144
    ds_read_b128 v[152:155], v23 offset:6144
    s_mov_b64 exec, -1
    s_waitcnt vmcnt(8)
    s_mov_b64 exec, s[60:61]
    ds_read_b128 v[140:143], v4 offset:10240
    ds_read_b128 v[144:147], v5 offset:10240
    s_mov_b64 exec, s[64:65]
    ds_read_b128 v[156:159], v22 offset:10240
    ds_read_b128 v[160:163], v23 offset:10240
    s_mov_b64 exec, -1
    s_barrier
    s_waitcnt lgkmcnt(0)
    s_add_u32 m0, s81, 0
    s_nop 0
    buffer_load_dwordx4 v28, s[16:19], s77 offen offset:0 lds
    v_mfma_f32_16x16x32_bf16 v[76:79], v[100:103], v[116:119], 0
    v_mfma_f32_16x16x32_bf16 v[76:79], v[104:107], v[120:123], v[76:79]
    buffer_load_dwordx4 v29, s[16:19], s77 offen offset:1024 lds
    v_fmac_f32 v32, v80, v220
    v_fmac_f32 v33, v81, v221
    v_fmac_f32 v34, v82, v222
    v_fmac_f32 v35, v83, v223
    s_add_u32 m0, s82, 6144
    v_add_u32_dpp v27, v39, v2 row_newbcast:2 row_mask:0xf bank_mask:0x3
    v_add_u32_dpp v27, v39, v2 row_newbcast:10 row_mask:0xf bank_mask:0xc
    buffer_load_dwordx4 v27, s[12:15], 0 offen offset:0 lds
    s_mov_b64 exec, s[36:37]
    v_mov_b64 v[132:133], v[116:117]
    v_mov_b64 v[134:135], v[118:119]
    v_mov_b64 v[136:137], v[120:121]
    v_mov_b64 v[138:139], v[122:123]
    s_mov_b64 exec, -1
    v_add_u32_dpp v24, v39, v3 row_newbcast:3 row_mask:0xf bank_mask:0x3
    v_add_u32_dpp v24, v39, v3 row_newbcast:11 row_mask:0xf bank_mask:0xc
    buffer_load_dwordx4 v24, s[24:27], 0 offen offset:1024 lds
    v_mfma_f32_16x16x32_bf16 v[80:83], v[108:111], v[116:119], 0
    v_mfma_f32_16x16x32_bf16 v[80:83], v[112:115], v[120:123], v[80:83]
    s_add_u32 m0, s81, 0
    s_nop 0
    buffer_load_dwordx4 v30, s[16:19], s77 offen offset:2048 lds
    v_fmac_f32 v32, v72, v224
    v_fmac_f32 v33, v73, v225
    v_fmac_f32 v34, v74, v226
    v_fmac_f32 v35, v75, v227
    buffer_load_dwordx4 v31, s[16:19], s77 offen offset:3072 lds
    s_add_u32 s77, s77, 16384
    v_mfma_f32_16x16x32_bf16 v[72:75], v[100:103], v[124:127], 0
    v_mfma_f32_16x16x32_bf16 v[72:75], v[104:107], v[128:131], v[72:75]
    s_add_u32 m0, s80, 36864
    v_add_u32_dpp v25, v64, v1 row_newbcast:3 row_mask:0xf bank_mask:0x3
    v_add_u32_dpp v25, v64, v1 row_newbcast:11 row_mask:0xf bank_mask:0xc
    buffer_load_dwordx4 v25, s[12:15], 0 offen offset:0 lds
    v_fmac_f32 v32, v76, v228
    v_fmac_f32 v33, v77, v229
    v_fmac_f32 v34, v78, v230
    v_fmac_f32 v35, v79, v231
    v_add_u32_dpp v26, v68, v1 row_newbcast:3 row_mask:0xf bank_mask:0x3
    v_add_u32_dpp v26, v68, v1 row_newbcast:11 row_mask:0xf bank_mask:0xc
    buffer_load_dwordx4 v26, s[28:31], 0 offen offset:2048 lds
    v_mfma_f32_16x16x32_bf16 v[76:79], v[116:119], v[132:135], 0
    v_mfma_f32_16x16x32_bf16 v[76:79], v[120:123], v[136:139], v[76:79]
    s_movk_i32 s74, 24000
    buffer_load_dword v38, v8, s[8:11], s74 offen
    buffer_load_dword v39, v8, s[8:11], s74 offen offset:256
    v_fmac_f32 v32, v80, v232
    v_fmac_f32 v33, v81, v233
    v_fmac_f32 v34, v82, v234
    v_fmac_f32 v35, v83, v235
    ds_read_b128 v[92:95], v4 offset:8192
    ds_read_b128 v[96:99], v5 offset:8192
    s_mov_b64 exec, s[62:63]
    ds_read_b128 v[148:151], v22 offset:8192
    ds_read_b128 v[152:155], v23 offset:8192
    s_mov_b64 exec, -1
    s_barrier
    s_waitcnt lgkmcnt(0)
    s_add_u32 m0, s81, 16384
    s_nop 0
    buffer_load_dwordx4 v28, s[16:19], s77 offen offset:0 lds
    v_mfma_f32_16x16x32_bf16 v[80:83], v[108:111], v[124:127], 0
    v_mfma_f32_16x16x32_bf16 v[80:83], v[112:115], v[128:131], v[80:83]
    buffer_load_dwordx4 v29, s[16:19], s77 offen offset:1024 lds
    v_fmac_f32 v32, v72, v236
    v_fmac_f32 v33, v73, v237
    v_fmac_f32 v34, v74, v238
    v_fmac_f32 v35, v75, v239
    v_lshlrev_b32 v36, 7, v36
    v_lshlrev_b32 v37, 7, v37
    s_nop 0
    s_add_u32 m0, s82, 8192
    v_add_u32_dpp v27, v36, v2 row_newbcast:0 row_mask:0xf bank_mask:0x3
    v_add_u32_dpp v27, v36, v2 row_newbcast:8 row_mask:0xf bank_mask:0xc
    buffer_load_dwordx4 v27, s[12:15], 0 offen offset:0 lds
    s_mov_b64 exec, s[36:37]
    v_mov_b64 v[132:133], v[124:125]
    v_mov_b64 v[134:135], v[126:127]
    v_mov_b64 v[136:137], v[128:129]
    v_mov_b64 v[138:139], v[130:131]
    s_mov_b64 exec, -1
    v_add_u32_dpp v24, v36, v3 row_newbcast:1 row_mask:0xf bank_mask:0x3
    v_add_u32_dpp v24, v36, v3 row_newbcast:9 row_mask:0xf bank_mask:0xc
    buffer_load_dwordx4 v24, s[24:27], 0 offen offset:1024 lds
    v_mfma_f32_16x16x32_bf16 v[72:75], v[116:119], v[124:127], 0
    v_mfma_f32_16x16x32_bf16 v[72:75], v[120:123], v[128:131], v[72:75]
    s_add_u32 m0, s81, 16384
    s_nop 0
    buffer_load_dwordx4 v30, s[16:19], s77 offen offset:2048 lds
    v_fmac_f32 v32, v76, v240
    v_fmac_f32 v33, v77, v241
    v_fmac_f32 v34, v78, v242
    v_fmac_f32 v35, v79, v243
    buffer_load_dwordx4 v31, s[16:19], s77 offen offset:3072 lds
    s_add_u32 s77, s77, 16384
    v_mfma_f32_16x16x32_bf16 v[76:79], v[124:127], v[132:135], 0
    v_mfma_f32_16x16x32_bf16 v[76:79], v[128:131], v[136:139], v[76:79]
    s_add_u32 m0, s80, 0
    v_add_u32_dpp v25, v57, v1 row_newbcast:3 row_mask:0xf bank_mask:0x3
    v_add_u32_dpp v25, v57, v1 row_newbcast:11 row_mask:0xf bank_mask:0xc
    buffer_load_dwordx4 v25, s[12:15], 0 offen offset:0 lds
    v_fmac_f32 v32, v80, v244
    v_fmac_f32 v33, v81, v245
    v_fmac_f32 v34, v82, v246
    v_fmac_f32 v35, v83, v247
    v_add_u32_dpp v26, v61, v1 row_newbcast:3 row_mask:0xf bank_mask:0x3
    v_add_u32_dpp v26, v61, v1 row_newbcast:11 row_mask:0xf bank_mask:0xc
    buffer_load_dwordx4 v26, s[28:31], 0 offen offset:2048 lds
    s_mov_b64 exec, s[36:37]
    v_mov_b64 v[140:141], v[84:85]
    v_mov_b64 v[142:143], v[86:87]
    v_mov_b64 v[144:145], v[88:89]
    v_mov_b64 v[146:147], v[90:91]
    s_mov_b64 exec, -1
    ds_read_b128 v[100:103], v4 offset:0
    ds_read_b128 v[104:107], v5 offset:0
    s_mov_b64 exec, s[64:65]
    ds_read_b128 v[148:151], v22 offset:0
    ds_read_b128 v[152:155], v23 offset:0
    s_mov_b64 exec, -1
    s_waitcnt vmcnt(20)
    s_barrier
    s_waitcnt lgkmcnt(0)
    s_add_u32 m0, s81, 32768
    s_nop 0
    buffer_load_dwordx4 v28, s[16:19], s77 offen offset:0 lds
    v_mfma_f32_16x16x32_bf16 v[80:83], v[84:87], v[140:143], 0
    v_mfma_f32_16x16x32_bf16 v[80:83], v[88:91], v[144:147], v[80:83]
    buffer_load_dwordx4 v29, s[16:19], s77 offen offset:1024 lds
    v_fmac_f32 v32, v72, v248
    v_fmac_f32 v33, v73, v249
    v_fmac_f32 v34, v74, v250
    v_fmac_f32 v35, v75, v251
    s_add_u32 m0, s82, 0
    v_add_u32_dpp v27, v36, v2 row_newbcast:2 row_mask:0xf bank_mask:0x3
    v_add_u32_dpp v27, v36, v2 row_newbcast:10 row_mask:0xf bank_mask:0xc
    buffer_load_dwordx4 v27, s[12:15], 0 offen offset:0 lds
    s_mov_b64 exec, s[36:37]
    v_mov_b64 v[140:141], v[92:93]
    v_mov_b64 v[142:143], v[94:95]
    v_mov_b64 v[144:145], v[96:97]
    v_mov_b64 v[146:147], v[98:99]
    s_mov_b64 exec, -1
    v_add_u32_dpp v24, v36, v3 row_newbcast:3 row_mask:0xf bank_mask:0x3
    v_add_u32_dpp v24, v36, v3 row_newbcast:11 row_mask:0xf bank_mask:0xc
    buffer_load_dwordx4 v24, s[24:27], 0 offen offset:1024 lds
    v_mfma_f32_16x16x32_bf16 v[72:75], v[84:87], v[92:95], 0
    v_mfma_f32_16x16x32_bf16 v[72:75], v[88:91], v[96:99], v[72:75]
    s_add_u32 m0, s81, 32768
    s_nop 0
    buffer_load_dwordx4 v30, s[16:19], s77 offen offset:2048 lds
    v_fmac_f32 v32, v76, v252
    v_fmac_f32 v33, v77, v253
    v_fmac_f32 v34, v78, v254
    v_fmac_f32 v35, v79, v255
    v_add_f32 v12, v32, v33
    v_add_f32 v13, v34, v35
    v_add_f32 v12, v12, v13
    v_mfma_f32_16x16x32_bf16 v[76:79], v[92:95], v[140:143], 0
    v_mfma_f32_16x16x32_bf16 v[76:79], v[96:99], v[144:147], v[76:79]
    buffer_load_dwordx4 v31, s[16:19], s77 offen offset:3072 lds
    s_add_u32 s77, s77, 16384
    v_add_f32_dpp v12, v12, v12 row_shr:1 row_mask:0xf bank_mask:0xf bound_ctrl:0
    v_mul_f32 v32, v80, v164
    v_mul_f32 v33, v81, v165
    v_mul_f32 v34, v82, v166
    v_mul_f32 v35, v83, v167
    s_add_u32 m0, s80, 4096
    v_add_u32_dpp v25, v65, v1 row_newbcast:3 row_mask:0xf bank_mask:0x3
    v_add_u32_dpp v25, v65, v1 row_newbcast:11 row_mask:0xf bank_mask:0xc
    buffer_load_dwordx4 v25, s[12:15], 0 offen offset:0 lds
    v_add_f32_dpp v12, v12, v12 row_shr:2 row_mask:0xf bank_mask:0xf bound_ctrl:0
    v_mfma_f32_16x16x32_bf16 v[80:83], v[84:87], v[100:103], 0
    v_mfma_f32_16x16x32_bf16 v[80:83], v[88:91], v[104:107], v[80:83]
    v_add_u32_dpp v26, v69, v1 row_newbcast:3 row_mask:0xf bank_mask:0x3
    v_add_u32_dpp v26, v69, v1 row_newbcast:11 row_mask:0xf bank_mask:0xc
    buffer_load_dwordx4 v26, s[28:31], 0 offen offset:2048 lds
    v_add_f32_dpp v12, v12, v12 row_shr:4 row_mask:0xf bank_mask:0xf bound_ctrl:0
    v_fmac_f32 v32, v72, v168
    v_fmac_f32 v33, v73, v169
    v_fmac_f32 v34, v74, v170
    v_fmac_f32 v35, v75, v171
    v_add_f32_dpp v12, v12, v12 row_shr:8 row_mask:0xf bank_mask:0xf bound_ctrl:0
    ds_read_b128 v[108:111], v4 offset:2048
    ds_read_b128 v[112:115], v5 offset:2048
    s_mov_b64 exec, s[66:67]
    ds_read_b128 v[148:151], v22 offset:2048
    ds_read_b128 v[152:155], v23 offset:2048
    s_mov_b64 exec, -1
    s_waitcnt vmcnt(18)
    s_barrier
    s_waitcnt lgkmcnt(0)
    s_add_u32 m0, s81, 49152
    s_nop 0
    buffer_load_dwordx4 v28, s[16:19], s77 offen offset:0 lds
    s_mov_b64 exec, s[36:37]
    v_mov_b64 v[140:141], v[100:101]
    v_mov_b64 v[142:143], v[102:103]
    v_mov_b64 v[144:145], v[104:105]
    v_mov_b64 v[146:147], v[106:107]
    s_mov_b64 exec, -1
    buffer_load_dwordx4 v29, s[16:19], s77 offen offset:1024 lds
    v_add_f32_dpp v12, v12, v12 row_bcast:15 row_mask:0xa bank_mask:0xf
    v_mfma_f32_16x16x32_bf16 v[72:75], v[92:95], v[100:103], 0
    v_mfma_f32_16x16x32_bf16 v[72:75], v[96:99], v[104:107], v[72:75]
    s_add_u32 m0, s82, 2048
    v_add_u32_dpp v27, v36, v2 row_newbcast:4 row_mask:0xf bank_mask:0x3
    v_add_u32_dpp v27, v36, v2 row_newbcast:12 row_mask:0xf bank_mask:0xc
    buffer_load_dwordx4 v27, s[12:15], 0 offen offset:0 lds
    v_add_f32_dpp v12, v12, v12 row_bcast:31 row_mask:0xc bank_mask:0xf
    v_fmac_f32 v32, v76, v172
    v_fmac_f32 v33, v77, v173
    v_fmac_f32 v34, v78, v174
    v_fmac_f32 v35, v79, v175
    v_add_u32_dpp v24, v36, v3 row_newbcast:5 row_mask:0xf bank_mask:0x3
    v_add_u32_dpp v24, v36, v3 row_newbcast:13 row_mask:0xf bank_mask:0xc
    buffer_load_dwordx4 v24, s[24:27], 0 offen offset:1024 lds
    v_readlane_b32 s38, v12, 63
    v_mfma_f32_16x16x32_bf16 v[76:79], v[84:87], v[108:111], 0
    v_mfma_f32_16x16x32_bf16 v[76:79], v[88:91], v[112:115], v[76:79]
    s_add_u32 m0, s81, 49152
    s_nop 0
    buffer_load_dwordx4 v30, s[16:19], s77 offen offset:2048 lds
    v_writelane_b32 v9, s38, 12
    v_fmac_f32 v32, v80, v176
    v_fmac_f32 v33, v81, v177
    v_fmac_f32 v34, v82, v178
    v_fmac_f32 v35, v83, v179
    v_mfma_f32_16x16x32_bf16 v[80:83], v[100:103], v[140:143], 0
    v_mfma_f32_16x16x32_bf16 v[80:83], v[104:107], v[144:147], v[80:83]
    buffer_load_dwordx4 v31, s[16:19], s77 offen offset:3072 lds
    s_add_u32 s77, s77, 16384
    v_fmac_f32 v32, v72, v180
    v_fmac_f32 v33, v73, v181
    v_fmac_f32 v34, v74, v182
    v_fmac_f32 v35, v75, v183
    s_add_u32 m0, s80, 16384
    v_add_u32_dpp v25, v58, v1 row_newbcast:3 row_mask:0xf bank_mask:0x3
    v_add_u32_dpp v25, v58, v1 row_newbcast:11 row_mask:0xf bank_mask:0xc
    buffer_load_dwordx4 v25, s[12:15], 0 offen offset:0 lds
    v_mfma_f32_16x16x32_bf16 v[72:75], v[92:95], v[108:111], 0
    v_mfma_f32_16x16x32_bf16 v[72:75], v[96:99], v[112:115], v[72:75]
    v_add_u32_dpp v26, v62, v1 row_newbcast:3 row_mask:0xf bank_mask:0x3
    v_add_u32_dpp v26, v62, v1 row_newbcast:11 row_mask:0xf bank_mask:0xc
    buffer_load_dwordx4 v26, s[28:31], 0 offen offset:2048 lds
    v_fmac_f32 v32, v76, v184
    v_fmac_f32 v33, v77, v185
    v_fmac_f32 v34, v78, v186
    v_fmac_f32 v35, v79, v187
    ds_read_b128 v[116:119], v4 offset:4096
    ds_read_b128 v[120:123], v5 offset:4096
    s_mov_b64 exec, s[60:61]
    ds_read_b128 v[156:159], v22 offset:4096
    ds_read_b128 v[160:163], v23 offset:4096
    s_mov_b64 exec, -1
    s_waitcnt vmcnt(18)
    s_barrier
    s_waitcnt lgkmcnt(0)
    s_add_u32 m0, s81, 0
    s_nop 0
    buffer_load_dwordx4 v28, s[16:19], s77 offen offset:0 lds
    v_mfma_f32_16x16x32_bf16 v[76:79], v[148:151], v[148:151], 0
    v_mfma_f32_16x16x32_bf16 v[76:79], v[152:155], v[152:155], v[76:79]
    buffer_load_dwordx4 v29, s[16:19], s77 offen offset:1024 lds
    v_fmac_f32 v32, v80, v188
    v_fmac_f32 v33, v81, v189
    v_fmac_f32 v34, v82, v190
    v_fmac_f32 v35, v83, v191
    s_add_u32 m0, s82, 4096
    v_add_u32_dpp v27, v36, v2 row_newbcast:6 row_mask:0xf bank_mask:0x3
    v_add_u32_dpp v27, v36, v2 row_newbcast:14 row_mask:0xf bank_mask:0xc
    buffer_load_dwordx4 v27, s[12:15], 0 offen offset:0 lds
    v_mfma_f32_16x16x32_bf16 v[80:83], v[84:87], v[116:119], 0
    v_mfma_f32_16x16x32_bf16 v[80:83], v[88:91], v[120:123], v[80:83]
    v_add_u32_dpp v24, v36, v3 row_newbcast:7 row_mask:0xf bank_mask:0x3
    v_add_u32_dpp v24, v36, v3 row_newbcast:15 row_mask:0xf bank_mask:0xc
    buffer_load_dwordx4 v24, s[24:27], 0 offen offset:1024 lds
    v_fmac_f32 v32, v72, v192
    v_fmac_f32 v33, v73, v193
    v_fmac_f32 v34, v74, v194
    v_fmac_f32 v35, v75, v195
    s_add_u32 m0, s81, 0
    s_nop 0
    buffer_load_dwordx4 v30, s[16:19], s77 offen offset:2048 lds
    s_mov_b64 exec, s[36:37]
    v_mov_b64 v[140:141], v[108:109]
    v_mov_b64 v[142:143], v[110:111]
    v_mov_b64 v[144:145], v[112:113]
    v_mov_b64 v[146:147], v[114:115]
    s_mov_b64 exec, -1
    buffer_load_dwordx4 v31, s[16:19], s77 offen offset:3072 lds
    s_add_u32 s77, s77, 16384
    v_mfma_f32_16x16x32_bf16 v[72:75], v[100:103], v[108:111], 0
    v_mfma_f32_16x16x32_bf16 v[72:75], v[104:107], v[112:115], v[72:75]
    s_add_u32 m0, s80, 20480
    v_add_u32_dpp v25, v66, v1 row_newbcast:3 row_mask:0xf bank_mask:0x3
    v_add_u32_dpp v25, v66, v1 row_newbcast:11 row_mask:0xf bank_mask:0xc
    buffer_load_dwordx4 v25, s[12:15], 0 offen offset:0 lds
    v_fmac_f32 v32, v76, v196
    v_fmac_f32 v33, v77, v197
    v_fmac_f32 v34, v78, v198
    v_fmac_f32 v35, v79, v199
    v_add_u32_dpp v26, v70, v1 row_newbcast:3 row_mask:0xf bank_mask:0x3
    v_add_u32_dpp v26, v70, v1 row_newbcast:11 row_mask:0xf bank_mask:0xc
    buffer_load_dwordx4 v26, s[28:31], 0 offen offset:2048 lds
    v_mfma_f32_16x16x32_bf16 v[76:79], v[92:95], v[116:119], 0
    v_mfma_f32_16x16x32_bf16 v[76:79], v[96:99], v[120:123], v[76:79]
    s_add_u32 m0, s82, 10240
    v_add_u32_dpp v27, v37, v2 row_newbcast:4 row_mask:0xf bank_mask:0x3
    v_add_u32_dpp v27, v37, v2 row_newbcast:12 row_mask:0xf bank_mask:0xc
    s_mov_b32 exec_hi, 0
    buffer_load_dwordx4 v27, s[12:15], 0 offen offset:0 lds
    s_mov_b32 exec_hi, -1
    v_fmac_f32 v32, v80, v200
    v_fmac_f32 v33, v81, v201
    v_fmac_f32 v34, v82, v202
    v_fmac_f32 v35, v83, v203
    ds_read_b128 v[124:127], v4 offset:6144
    ds_read_b128 v[128:131], v5 offset:6144
    s_mov_b64 exec, s[62:63]
    ds_read_b128 v[156:159], v22 offset:6144
    ds_read_b128 v[160:163], v23 offset:6144
    s_mov_b64 exec, -1
    s_waitcnt vmcnt(17)
    s_barrier
    s_waitcnt lgkmcnt(0)
    s_add_u32 m0, s81, 16384
    s_nop 0
    buffer_load_dwordx4 v28, s[16:19], s77 offen offset:0 lds
    v_mfma_f32_16x16x32_bf16 v[80:83], v[84:87], v[124:127], 0
    v_mfma_f32_16x16x32_bf16 v[80:83], v[88:91], v[128:131], v[80:83]
    buffer_load_dwordx4 v29, s[16:19], s77 offen offset:1024 lds
    v_fmac_f32 v32, v72, v204
    v_fmac_f32 v33, v73, v205
    v_fmac_f32 v34, v74, v206
    v_fmac_f32 v35, v75, v207
    s_add_u32 m0, s82, 6144
    v_add_u32_dpp v24, v37, v2 row_newbcast:0 row_mask:0xf bank_mask:0x3
    v_add_u32_dpp v24, v37, v2 row_newbcast:8 row_mask:0xf bank_mask:0xc
    buffer_load_dwordx4 v24, s[12:15], 0 offen offset:0 lds
    v_mfma_f32_16x16x32_bf16 v[72:75], v[108:111], v[140:143], 0
    v_mfma_f32_16x16x32_bf16 v[72:75], v[112:115], v[144:147], v[72:75]
    v_add_u32_dpp v25, v37, v3 row_newbcast:1 row_mask:0xf bank_mask:0x3
    v_add_u32_dpp v25, v37, v3 row_newbcast:9 row_mask:0xf bank_mask:0xc
    buffer_load_dwordx4 v25, s[24:27], 0 offen offset:1024 lds
    v_fmac_f32 v32, v76, v208
    v_fmac_f32 v33, v77, v209
    v_fmac_f32 v34, v78, v210
    v_fmac_f32 v35, v79, v211
    s_add_u32 m0, s81, 16384
    s_nop 0
    buffer_load_dwordx4 v30, s[16:19], s77 offen offset:2048 lds
    v_mfma_f32_16x16x32_bf16 v[76:79], v[92:95], v[124:127], 0
    v_mfma_f32_16x16x32_bf16 v[76:79], v[96:99], v[128:131], v[76:79]
    buffer_load_dwordx4 v31, s[16:19], s77 offen offset:3072 lds
    s_add_u32 s77, s77, 16384
    v_fmac_f32 v32, v80, v212
    v_fmac_f32 v33, v81, v213
    v_fmac_f32 v34, v82, v214
    v_fmac_f32 v35, v83, v215
    s_add_u32 m0, s80, 32768
    v_add_u32_dpp v26, v59, v1 row_newbcast:3 row_mask:0xf bank_mask:0x3
    v_add_u32_dpp v26, v59, v1 row_newbcast:11 row_mask:0xf bank_mask:0xc
    buffer_load_dwordx4 v26, s[12:15], 0 offen offset:0 lds
    v_mfma_f32_16x16x32_bf16 v[80:83], v[156:159], v[156:159], 0
    v_mfma_f32_16x16x32_bf16 v[80:83], v[160:163], v[160:163], v[80:83]
    v_add_u32_dpp v27, v63, v1 row_newbcast:3 row_mask:0xf bank_mask:0x3
    v_add_u32_dpp v27, v63, v1 row_newbcast:11 row_mask:0xf bank_mask:0xc
    buffer_load_dwordx4 v27, s[28:31], 0 offen offset:2048 lds
    v_fmac_f32 v32, v72, v216
    v_fmac_f32 v33, v73, v217
    v_fmac_f32 v34, v74, v218
    v_fmac_f32 v35, v75, v219
    ds_read_b128 v[84:87], v4 offset:8192
    ds_read_b128 v[88:91], v5 offset:8192
    s_mov_b64 exec, s[60:61]
    ds_read_b128 v[148:151], v22 offset:8192
    ds_read_b128 v[152:155], v23 offset:8192
    s_mov_b64 exec, -1
    s_waitcnt vmcnt(8)
    s_mov_b64 exec, s[60:61]
    ds_read_b128 v[132:135], v4 offset:10240
    ds_read_b128 v[136:139], v5 offset:10240
    s_mov_b64 exec, s[64:65]
    ds_read_b128 v[156:159], v22 offset:10240
    ds_read_b128 v[160:163], v23 offset:10240
    s_mov_b64 exec, -1
    s_barrier
    s_waitcnt lgkmcnt(0)
    s_add_u32 m0, s81, 32768
    s_nop 0
    buffer_load_dwordx4 v28, s[16:19], s77 offen offset:0 lds
    v_mfma_f32_16x16x32_bf16 v[72:75], v[100:103], v[116:119], 0
    v_mfma_f32_16x16x32_bf16 v[72:75], v[104:107], v[120:123], v[72:75]
    buffer_load_dwordx4 v29, s[16:19], s77 offen offset:1024 lds
    v_fmac_f32 v32, v76, v220
    v_fmac_f32 v33, v77, v221
    v_fmac_f32 v34, v78, v222
    v_fmac_f32 v35, v79, v223
    s_add_u32 m0, s82, 8192
    v_add_u32_dpp v24, v37, v2 row_newbcast:2 row_mask:0xf bank_mask:0x3
    v_add_u32_dpp v24, v37, v2 row_newbcast:10 row_mask:0xf bank_mask:0xc
    buffer_load_dwordx4 v24, s[12:15], 0 offen offset:0 lds
    s_mov_b64 exec, s[36:37]
    v_mov_b64 v[140:141], v[116:117]
    v_mov_b64 v[142:143], v[118:119]
    v_mov_b64 v[144:145], v[120:121]
    v_mov_b64 v[146:147], v[122:123]
    s_mov_b64 exec, -1
    v_add_u32_dpp v25, v37, v3 row_newbcast:3 row_mask:0xf bank_mask:0x3
    v_add_u32_dpp v25, v37, v3 row_newbcast:11 row_mask:0xf bank_mask:0xc
    buffer_load_dwordx4 v25, s[24:27], 0 offen offset:1024 lds
    v_mfma_f32_16x16x32_bf16 v[76:79], v[108:111], v[116:119], 0
    v_mfma_f32_16x16x32_bf16 v[76:79], v[112:115], v[120:123], v[76:79]
    s_add_u32 m0, s81, 32768
    s_nop 0
    buffer_load_dwordx4 v30, s[16:19], s77 offen offset:2048 lds
    v_fmac_f32 v32, v80, v224
    v_fmac_f32 v33, v81, v225
    v_fmac_f32 v34, v82, v226
    v_fmac_f32 v35, v83, v227
    v_mfma_f32_16x16x32_bf16 v[80:83], v[100:103], v[124:127], 0
    v_mfma_f32_16x16x32_bf16 v[80:83], v[104:107], v[128:131], v[80:83]
    buffer_load_dwordx4 v31, s[16:19], s77 offen offset:3072 lds
    s_add_u32 s77, s77, 16384
    v_fmac_f32 v32, v72, v228
    v_fmac_f32 v33, v73, v229
    v_fmac_f32 v34, v74, v230
    v_fmac_f32 v35, v75, v231
    s_add_u32 m0, s80, 36864
    v_add_u32_dpp v26, v67, v1 row_newbcast:3 row_mask:0xf bank_mask:0x3
    v_add_u32_dpp v26, v67, v1 row_newbcast:11 row_mask:0xf bank_mask:0xc
    buffer_load_dwordx4 v26, s[12:15], 0 offen offset:0 lds
    v_mfma_f32_16x16x32_bf16 v[72:75], v[116:119], v[140:143], 0
    v_mfma_f32_16x16x32_bf16 v[72:75], v[120:123], v[144:147], v[72:75]
    v_add_u32_dpp v27, v71, v1 row_newbcast:3 row_mask:0xf bank_mask:0x3
    v_add_u32_dpp v27, v71, v1 row_newbcast:11 row_mask:0xf bank_mask:0xc
    buffer_load_dwordx4 v27, s[28:31], 0 offen offset:2048 lds
    v_fmac_f32 v32, v76, v232
    v_fmac_f32 v33, v77, v233
    v_fmac_f32 v34, v78, v234
    v_fmac_f32 v35, v79, v235
    ds_read_b128 v[92:95], v4 offset:0
    ds_read_b128 v[96:99], v5 offset:0
    s_mov_b64 exec, s[62:63]
    ds_read_b128 v[148:151], v22 offset:0
    ds_read_b128 v[152:155], v23 offset:0
    s_mov_b64 exec, -1
    s_barrier
    s_waitcnt lgkmcnt(0)
    s_add_u32 m0, s81, 49152
    s_nop 0
    buffer_load_dwordx4 v28, s[16:19], s77 offen offset:0 lds
    v_mfma_f32_16x16x32_bf16 v[76:79], v[108:111], v[124:127], 0
    v_mfma_f32_16x16x32_bf16 v[76:79], v[112:115], v[128:131], v[76:79]
    buffer_load_dwordx4 v29, s[16:19], s77 offen offset:1024 lds
    v_fmac_f32 v32, v80, v236
    v_fmac_f32 v33, v81, v237
    v_fmac_f32 v34, v82, v238
    v_fmac_f32 v35, v83, v239
    v_lshlrev_b32 v38, 7, v38
    v_lshlrev_b32 v39, 7, v39
    s_nop 0
    s_add_u32 m0, s82, 0
    v_add_u32_dpp v24, v38, v2 row_newbcast:0 row_mask:0xf bank_mask:0x3
    v_add_u32_dpp v24, v38, v2 row_newbcast:8 row_mask:0xf bank_mask:0xc
    buffer_load_dwordx4 v24, s[12:15], 0 offen offset:0 lds
    s_mov_b64 exec, s[36:37]
    v_mov_b64 v[140:141], v[124:125]
    v_mov_b64 v[142:143], v[126:127]
    v_mov_b64 v[144:145], v[128:129]
    v_mov_b64 v[146:147], v[130:131]
    s_mov_b64 exec, -1
    v_add_u32_dpp v25, v38, v3 row_newbcast:1 row_mask:0xf bank_mask:0x3
    v_add_u32_dpp v25, v38, v3 row_newbcast:9 row_mask:0xf bank_mask:0xc
    buffer_load_dwordx4 v25, s[24:27], 0 offen offset:1024 lds
    v_mfma_f32_16x16x32_bf16 v[80:83], v[116:119], v[124:127], 0
    v_mfma_f32_16x16x32_bf16 v[80:83], v[120:123], v[128:131], v[80:83]
    s_add_u32 m0, s81, 49152
    s_nop 0
    buffer_load_dwordx4 v30, s[16:19], s77 offen offset:2048 lds
    v_fmac_f32 v32, v72, v240
    v_fmac_f32 v33, v73, v241
    v_fmac_f32 v34, v74, v242
    v_fmac_f32 v35, v75, v243
    buffer_load_dwordx4 v31, s[16:19], s77 offen offset:3072 lds
    s_add_u32 s77, s77, 16384
    v_mfma_f32_16x16x32_bf16 v[72:75], v[124:127], v[140:143], 0
    v_mfma_f32_16x16x32_bf16 v[72:75], v[128:131], v[144:147], v[72:75]
    s_add_u32 m0, s80, 0
    v_add_u32_dpp v26, v56, v1 row_newbcast:4 row_mask:0xf bank_mask:0x3
    v_add_u32_dpp v26, v56, v1 row_newbcast:12 row_mask:0xf bank_mask:0xc
    buffer_load_dwordx4 v26, s[12:15], 0 offen offset:0 lds
    v_fmac_f32 v32, v76, v244
    v_fmac_f32 v33, v77, v245
    v_fmac_f32 v34, v78, v246
    v_fmac_f32 v35, v79, v247
    v_add_u32_dpp v27, v60, v1 row_newbcast:4 row_mask:0xf bank_mask:0x3
    v_add_u32_dpp v27, v60, v1 row_newbcast:12 row_mask:0xf bank_mask:0xc
    buffer_load_dwordx4 v27, s[28:31], 0 offen offset:2048 lds
    s_mov_b64 exec, s[36:37]
    v_mov_b64 v[132:133], v[84:85]
    v_mov_b64 v[134:135], v[86:87]
    v_mov_b64 v[136:137], v[88:89]
    v_mov_b64 v[138:139], v[90:91]
    s_mov_b64 exec, -1
    ds_read_b128 v[100:103], v4 offset:2048
    ds_read_b128 v[104:107], v5 offset:2048
    s_mov_b64 exec, s[64:65]
    ds_read_b128 v[148:151], v22 offset:2048
    ds_read_b128 v[152:155], v23 offset:2048
    s_mov_b64 exec, -1
    s_waitcnt vmcnt(18)
    s_barrier
    s_waitcnt lgkmcnt(0)
    s_add_u32 m0, s81, 0
    s_nop 0
    buffer_load_dwordx4 v28, s[16:19], s77 offen offset:0 lds
    v_mfma_f32_16x16x32_bf16 v[76:79], v[84:87], v[132:135], 0
    v_mfma_f32_16x16x32_bf16 v[76:79], v[88:91], v[136:139], v[76:79]
    buffer_load_dwordx4 v29, s[16:19], s77 offen offset:1024 lds
    v_fmac_f32 v32, v80, v248
    v_fmac_f32 v33, v81, v249
    v_fmac_f32 v34, v82, v250
    v_fmac_f32 v35, v83, v251
    s_add_u32 m0, s82, 2048
    v_add_u32_dpp v24, v38, v2 row_newbcast:2 row_mask:0xf bank_mask:0x3
    v_add_u32_dpp v24, v38, v2 row_newbcast:10 row_mask:0xf bank_mask:0xc
    buffer_load_dwordx4 v24, s[12:15], 0 offen offset:0 lds
    s_mov_b64 exec, s[36:37]
    v_mov_b64 v[132:133], v[92:93]
    v_mov_b64 v[134:135], v[94:95]
    v_mov_b64 v[136:137], v[96:97]
    v_mov_b64 v[138:139], v[98:99]
    s_mov_b64 exec, -1
    v_add_u32_dpp v25, v38, v3 row_newbcast:3 row_mask:0xf bank_mask:0x3
    v_add_u32_dpp v25, v38, v3 row_newbcast:11 row_mask:0xf bank_mask:0xc
    buffer_load_dwordx4 v25, s[24:27], 0 offen offset:1024 lds
    v_mfma_f32_16x16x32_bf16 v[80:83], v[84:87], v[92:95], 0
    v_mfma_f32_16x16x32_bf16 v[80:83], v[88:91], v[96:99], v[80:83]
    s_add_u32 m0, s81, 0
    s_nop 0
    buffer_load_dwordx4 v30, s[16:19], s77 offen offset:2048 lds
    v_fmac_f32 v32, v72, v252
    v_fmac_f32 v33, v73, v253
    v_fmac_f32 v34, v74, v254
    v_fmac_f32 v35, v75, v255
    v_add_f32 v12, v32, v33
    v_add_f32 v13, v34, v35
    v_add_f32 v12, v12, v13
    v_mfma_f32_16x16x32_bf16 v[72:75], v[92:95], v[132:135], 0
    v_mfma_f32_16x16x32_bf16 v[72:75], v[96:99], v[136:139], v[72:75]
    buffer_load_dwordx4 v31, s[16:19], s77 offen offset:3072 lds
    s_add_u32 s77, s77, 16384
    v_add_f32_dpp v12, v12, v12 row_shr:1 row_mask:0xf bank_mask:0xf bound_ctrl:0
    v_mul_f32 v32, v76, v164
    v_mul_f32 v33, v77, v165
    v_mul_f32 v34, v78, v166
    v_mul_f32 v35, v79, v167
    s_add_u32 m0, s80, 4096
    v_add_u32_dpp v26, v64, v1 row_newbcast:4 row_mask:0xf bank_mask:0x3
    v_add_u32_dpp v26, v64, v1 row_newbcast:12 row_mask:0xf bank_mask:0xc
    buffer_load_dwordx4 v26, s[12:15], 0 offen offset:0 lds
    v_add_f32_dpp v12, v12, v12 row_shr:2 row_mask:0xf bank_mask:0xf bound_ctrl:0
    v_mfma_f32_16x16x32_bf16 v[76:79], v[84:87], v[100:103], 0
    v_mfma_f32_16x16x32_bf16 v[76:79], v[88:91], v[104:107], v[76:79]
    v_add_u32_dpp v27, v68, v1 row_newbcast:4 row_mask:0xf bank_mask:0x3
    v_add_u32_dpp v27, v68, v1 row_newbcast:12 row_mask:0xf bank_mask:0xc
    buffer_load_dwordx4 v27, s[28:31], 0 offen offset:2048 lds
    v_add_f32_dpp v12, v12, v12 row_shr:4 row_mask:0xf bank_mask:0xf bound_ctrl:0
    v_fmac_f32 v32, v80, v168
    v_fmac_f32 v33, v81, v169
    v_fmac_f32 v34, v82, v170
    v_fmac_f32 v35, v83, v171
    v_add_f32_dpp v12, v12, v12 row_shr:8 row_mask:0xf bank_mask:0xf bound_ctrl:0
    ds_read_b128 v[108:111], v4 offset:4096
    ds_read_b128 v[112:115], v5 offset:4096
    s_mov_b64 exec, s[66:67]
    ds_read_b128 v[148:151], v22 offset:4096
    ds_read_b128 v[152:155], v23 offset:4096
    s_mov_b64 exec, -1
    s_waitcnt vmcnt(16)
    s_barrier
    s_waitcnt lgkmcnt(0)
    s_add_u32 m0, s81, 16384
    s_nop 0
    buffer_load_dwordx4 v28, s[16:19], s77 offen offset:0 lds
    s_mov_b64 exec, s[36:37]
    v_mov_b64 v[132:133], v[100:101]
    v_mov_b64 v[134:135], v[102:103]
    v_mov_b64 v[136:137], v[104:105]
    v_mov_b64 v[138:139], v[106:107]
    s_mov_b64 exec, -1
    buffer_load_dwordx4 v29, s[16:19], s77 offen offset:1024 lds
    v_add_f32_dpp v12, v12, v12 row_bcast:15 row_mask:0xa bank_mask:0xf
    v_mfma_f32_16x16x32_bf16 v[80:83], v[92:95], v[100:103], 0
    v_mfma_f32_16x16x32_bf16 v[80:83], v[96:99], v[104:107], v[80:83]
    s_add_u32 m0, s82, 4096
    v_add_u32_dpp v24, v38, v2 row_newbcast:4 row_mask:0xf bank_mask:0x3
    v_add_u32_dpp v24, v38, v2 row_newbcast:12 row_mask:0xf bank_mask:0xc
    buffer_load_dwordx4 v24, s[12:15], 0 offen offset:0 lds
    v_add_f32_dpp v12, v12, v12 row_bcast:31 row_mask:0xc bank_mask:0xf
    v_fmac_f32 v32, v72, v172
    v_fmac_f32 v33, v73, v173
    v_fmac_f32 v34, v74, v174
    v_fmac_f32 v35, v75, v175
    v_add_u32_dpp v25, v38, v3 row_newbcast:5 row_mask:0xf bank_mask:0x3
    v_add_u32_dpp v25, v38, v3 row_newbcast:13 row_mask:0xf bank_mask:0xc
    buffer_load_dwordx4 v25, s[24:27], 0 offen offset:1024 lds
    v_readlane_b32 s38, v12, 63
    v_mfma_f32_16x16x32_bf16 v[72:75], v[84:87], v[108:111], 0
    v_mfma_f32_16x16x32_bf16 v[72:75], v[88:91], v[112:115], v[72:75]
    s_add_u32 m0, s81, 16384
    s_nop 0
    buffer_load_dwordx4 v30, s[16:19], s77 offen offset:2048 lds
    v_writelane_b32 v9, s38, 13
    v_fmac_f32 v32, v76, v176
    v_fmac_f32 v33, v77, v177
    v_fmac_f32 v34, v78, v178
    v_fmac_f32 v35, v79, v179
    v_mfma_f32_16x16x32_bf16 v[76:79], v[100:103], v[132:135], 0
    v_mfma_f32_16x16x32_bf16 v[76:79], v[104:107], v[136:139], v[76:79]
    buffer_load_dwordx4 v31, s[16:19], s77 offen offset:3072 lds
    s_add_u32 s77, s77, 16384
    v_fmac_f32 v32, v80, v180
    v_fmac_f32 v33, v81, v181
    v_fmac_f32 v34, v82, v182
    v_fmac_f32 v35, v83, v183
    s_cbranch_vccnz L_sk49_0
    s_add_u32 m0, s80, 16384
    v_add_u32_dpp v26, v56, v1 row_newbcast:5 row_mask:0xf bank_mask:0x3
    v_add_u32_dpp v26, v56, v1 row_newbcast:13 row_mask:0xf bank_mask:0xc
    buffer_load_dwordx4 v26, s[12:15], 0 offen offset:0 lds
L_sk49_0:
    v_mfma_f32_16x16x32_bf16 v[80:83], v[92:95], v[108:111], 0
    v_mfma_f32_16x16x32_bf16 v[80:83], v[96:99], v[112:115], v[80:83]
    s_cbranch_vccnz L_sk49_1
    s_add_u32 m0, s80, 16384
    v_add_u32_dpp v27, v60, v1 row_newbcast:5 row_mask:0xf bank_mask:0x3
    v_add_u32_dpp v27, v60, v1 row_newbcast:13 row_mask:0xf bank_mask:0xc
    buffer_load_dwordx4 v27, s[28:31], 0 offen offset:2048 lds
L_sk49_1:
    v_fmac_f32 v32, v72, v184
    v_fmac_f32 v33, v73, v185
    v_fmac_f32 v34, v74, v186
    v_fmac_f32 v35, v75, v187
    ds_read_b128 v[116:119], v4 offset:6144
    ds_read_b128 v[120:123], v5 offset:6144
    s_mov_b64 exec, s[60:61]
    ds_read_b128 v[156:159], v22 offset:6144
    ds_read_b128 v[160:163], v23 offset:6144
    s_mov_b64 exec, -1
    s_waitcnt vmcnt(16)
    s_barrier
    s_waitcnt lgkmcnt(0)
    s_mov_b32 s77, 1605632
    s_add_u32 m0, s81, 32768
    s_nop 0
    buffer_load_dwordx4 v28, s[16:19], s77 offen offset:0 lds
    v_mfma_f32_16x16x32_bf16 v[72:75], v[148:151], v[148:151], 0
    v_mfma_f32_16x16x32_bf16 v[72:75], v[152:155], v[152:155], v[72:75]
    buffer_load_dwordx4 v29, s[16:19], s77 offen offset:1024 lds
    v_fmac_f32 v32, v76, v188
    v_fmac_f32 v33, v77, v189
    v_fmac_f32 v34, v78, v190
    v_fmac_f32 v35, v79, v191
    s_add_u32 m0, s82, 6144
    v_add_u32_dpp v24, v38, v2 row_newbcast:6 row_mask:0xf bank_mask:0x3
    v_add_u32_dpp v24, v38, v2 row_newbcast:14 row_mask:0xf bank_mask:0xc
    buffer_load_dwordx4 v24, s[12:15], 0 offen offset:0 lds
    v_mfma_f32_16x16x32_bf16 v[76:79], v[84:87], v[116:119], 0
    v_mfma_f32_16x16x32_bf16 v[76:79], v[88:91], v[120:123], v[76:79]
    v_add_u32_dpp v25, v38, v3 row_newbcast:7 row_mask:0xf bank_mask:0x3
    v_add_u32_dpp v25, v38, v3 row_newbcast:15 row_mask:0xf bank_mask:0xc
    buffer_load_dwordx4 v25, s[24:27], 0 offen offset:1024 lds
    v_fmac_f32 v32, v80, v192
    v_fmac_f32 v33, v81, v193
    v_fmac_f32 v34, v82, v194
    v_fmac_f32 v35, v83, v195
    s_add_u32 m0, s81, 32768
    s_nop 0
    buffer_load_dwordx4 v30, s[16:19], s77 offen offset:2048 lds
    s_mov_b64 exec, s[36:37]
    v_mov_b64 v[132:133], v[108:109]
    v_mov_b64 v[134:135], v[110:111]
    v_mov_b64 v[136:137], v[112:113]
    v_mov_b64 v[138:139], v[114:115]
    s_mov_b64 exec, -1
    buffer_load_dwordx4 v31, s[16:19], s77 offen offset:3072 lds
    s_add_u32 s77, s77, 16384
    v_mfma_f32_16x16x32_bf16 v[80:83], v[100:103], v[108:111], 0
    v_mfma_f32_16x16x32_bf16 v[80:83], v[104:107], v[112:115], v[80:83]
    s_cbranch_vccnz L_sk49_2
    s_add_u32 m0, s80, 20480
    v_add_u32_dpp v26, v64, v1 row_newbcast:5 row_mask:0xf bank_mask:0x3
    v_add_u32_dpp v26, v64, v1 row_newbcast:13 row_mask:0xf bank_mask:0xc
    buffer_load_dwordx4 v26, s[12:15], 0 offen offset:0 lds
L_sk49_2:
    v_fmac_f32 v32, v72, v196
    v_fmac_f32 v33, v73, v197
    v_fmac_f32 v34, v74, v198
    v_fmac_f32 v35, v75, v199
    s_cbranch_vccnz L_sk49_3
    s_add_u32 m0, s80, 20480
    v_add_u32_dpp v27, v68, v1 row_newbcast:5 row_mask:0xf bank_mask:0x3
    v_add_u32_dpp v27, v68, v1 row_newbcast:13 row_mask:0xf bank_mask:0xc
    buffer_load_dwordx4 v27, s[28:31], 0 offen offset:2048 lds
L_sk49_3:
    v_mfma_f32_16x16x32_bf16 v[72:75], v[92:95], v[116:119], 0
    v_mfma_f32_16x16x32_bf16 v[72:75], v[96:99], v[120:123], v[72:75]
    s_add_u32 m0, s82, 10240
    v_add_u32_dpp v24, v39, v2 row_newbcast:4 row_mask:0xf bank_mask:0x3
    v_add_u32_dpp v24, v39, v2 row_newbcast:12 row_mask:0xf bank_mask:0xc
    s_mov_b32 exec_hi, 0
    buffer_load_dwordx4 v24, s[12:15], 0 offen offset:0 lds
    s_mov_b32 exec_hi, -1
    v_fmac_f32 v32, v76, v200
    v_fmac_f32 v33, v77, v201
    v_fmac_f32 v34, v78, v202
    v_fmac_f32 v35, v79, v203
    ds_read_b128 v[124:127], v4 offset:8192
    ds_read_b128 v[128:131], v5 offset:8192
    s_mov_b64 exec, s[62:63]
    ds_read_b128 v[156:159], v22 offset:8192
    ds_read_b128 v[160:163], v23 offset:8192
    s_mov_b64 exec, -1
    s_waitcnt vmcnt(7)
    s_barrier
    s_waitcnt lgkmcnt(0)
    s_add_u32 m0, s81, 49152
    s_nop 0
    buffer_load_dwordx4 v28, s[16:19], s77 offen offset:0 lds
    v_mfma_f32_16x16x32_bf16 v[76:79], v[84:87], v[124:127], 0
    v_mfma_f32_16x16x32_bf16 v[76:79], v[88:91], v[128:131], v[76:79]
    buffer_load_dwordx4 v29, s[16:19], s77 offen offset:1024 lds
    s_add_u32 m0, s82, 8192
    v_add_u32_dpp v25, v39, v2 row_newbcast:0 row_mask:0xf bank_mask:0x3
    v_add_u32_dpp v25, v39, v2 row_newbcast:8 row_mask:0xf bank_mask:0xc
    buffer_load_dwordx4 v25, s[12:15], 0 offen offset:0 lds
    v_fmac_f32 v32, v80, v204
    v_fmac_f32 v33, v81, v205
    v_fmac_f32 v34, v82, v206
    v_fmac_f32 v35, v83, v207
    v_add_u32_dpp v26, v39, v3 row_newbcast:1 row_mask:0xf bank_mask:0x3
    v_add_u32_dpp v26, v39, v3 row_newbcast:9 row_mask:0xf bank_mask:0xc
    buffer_load_dwordx4 v26, s[24:27], 0 offen offset:1024 lds
    v_mfma_f32_16x16x32_bf16 v[80:83], v[108:111], v[132:135], 0
    v_mfma_f32_16x16x32_bf16 v[80:83], v[112:115], v[136:139], v[80:83]
    s_add_u32 m0, s81, 49152
    s_nop 0
    buffer_load_dwordx4 v30, s[16:19], s77 offen offset:2048 lds
    v_fmac_f32 v32, v72, v208
    v_fmac_f32 v33, v73, v209
    v_fmac_f32 v34, v74, v210
    v_fmac_f32 v35, v75, v211
    buffer_load_dwordx4 v31, s[16:19], s77 offen offset:3072 lds
    s_add_u32 s77, s77, 16384
    v_mfma_f32_16x16x32_bf16 v[72:75], v[92:95], v[124:127], 0
    v_mfma_f32_16x16x32_bf16 v[72:75], v[96:99], v[128:131], v[72:75]
    s_cbranch_vccnz L_sk50_0
    s_add_u32 m0, s80, 32768
    v_add_u32_dpp v27, v57, v1 row_newbcast:5 row_mask:0xf bank_mask:0x3
    v_add_u32_dpp v27, v57, v1 row_newbcast:13 row_mask:0xf bank_mask:0xc
    buffer_load_dwordx4 v27, s[12:15], 0 offen offset:0 lds
L_sk50_0:
    v_fmac_f32 v32, v76, v212
    v_fmac_f32 v33, v77, v213
    v_fmac_f32 v34, v78, v214
    v_fmac_f32 v35, v79, v215
    s_cbranch_vccnz L_sk50_1
    s_add_u32 m0, s80, 32768
    v_add_u32_dpp v24, v61, v1 row_newbcast:5 row_mask:0xf bank_mask:0x3
    v_add_u32_dpp v24, v61, v1 row_newbcast:13 row_mask:0xf bank_mask:0xc
    buffer_load_dwordx4 v24, s[28:31], 0 offen offset:2048 lds
L_sk50_1:
    v_mfma_f32_16x16x32_bf16 v[76:79], v[156:159], v[156:159], 0
    v_mfma_f32_16x16x32_bf16 v[76:79], v[160:163], v[160:163], v[76:79]
    s_cbranch_vccnz L_sk50_2
    s_add_u32 m0, s80, 36864
    v_add_u32_dpp v25, v65, v1 row_newbcast:5 row_mask:0xf bank_mask:0x3
    v_add_u32_dpp v25, v65, v1 row_newbcast:13 row_mask:0xf bank_mask:0xc
    buffer_load_dwordx4 v25, s[12:15], 0 offen offset:0 lds
L_sk50_2:
    v_fmac_f32 v32, v80, v216
    v_fmac_f32 v33, v81, v217
    v_fmac_f32 v34, v82, v218
    v_fmac_f32 v35, v83, v219
    s_cbranch_vccnz L_sk50_3
    s_add_u32 m0, s80, 36864
    v_add_u32_dpp v26, v69, v1 row_newbcast:5 row_mask:0xf bank_mask:0x3
    v_add_u32_dpp v26, v69, v1 row_newbcast:13 row_mask:0xf bank_mask:0xc
    buffer_load_dwordx4 v26, s[28:31], 0 offen offset:2048 lds
L_sk50_3:
    ds_read_b128 v[84:87], v4 offset:0
    ds_read_b128 v[88:91], v5 offset:0
    s_mov_b64 exec, s[60:61]
    ds_read_b128 v[148:151], v22 offset:0
    ds_read_b128 v[152:155], v23 offset:0
    s_mov_b64 exec, -1
    s_waitcnt vmcnt(6)
    s_mov_b64 exec, s[60:61]
    ds_read_b128 v[140:143], v4 offset:10240
    ds_read_b128 v[144:147], v5 offset:10240
    s_mov_b64 exec, s[64:65]
    ds_read_b128 v[156:159], v22 offset:10240
    ds_read_b128 v[160:163], v23 offset:10240
    s_mov_b64 exec, -1
    s_barrier
    s_add_u32 m0, s81, 0
    s_nop 0
    buffer_load_dwordx4 v28, s[16:19], s77 offen offset:0 lds
    buffer_load_dwordx4 v29, s[16:19], s77 offen offset:1024 lds
    buffer_load_dwordx4 v30, s[16:19], s77 offen offset:2048 lds
    buffer_load_dwordx4 v31, s[16:19], s77 offen offset:3072 lds
    s_add_u32 s77, s77, 16384
    s_add_u32 m0, s81, 16384
    s_nop 0
    buffer_load_dwordx4 v28, s[16:19], s77 offen offset:0 lds
    buffer_load_dwordx4 v29, s[16:19], s77 offen offset:1024 lds
    buffer_load_dwordx4 v30, s[16:19], s77 offen offset:2048 lds
    buffer_load_dwordx4 v31, s[16:19], s77 offen offset:3072 lds
    s_add_u32 s77, s77, 16384
    s_waitcnt lgkmcnt(0)
    s_add_u32 m0, s82, 0
    v_add_u32_dpp v27, v39, v2 row_newbcast:2 row_mask:0xf bank_mask:0x3
    v_add_u32_dpp v27, v39, v2 row_newbcast:10 row_mask:0xf bank_mask:0xc
    buffer_load_dwordx4 v27, s[12:15], 0 offen offset:0 lds
    v_mfma_f32_16x16x32_bf16 v[80:83], v[100:103], v[116:119], 0
    v_mfma_f32_16x16x32_bf16 v[80:83], v[104:107], v[120:123], v[80:83]
    v_add_u32_dpp v24, v39, v3 row_newbcast:3 row_mask:0xf bank_mask:0x3
    v_add_u32_dpp v24, v39, v3 row_newbcast:11 row_mask:0xf bank_mask:0xc
    buffer_load_dwordx4 v24, s[24:27], 0 offen offset:1024 lds
    v_fmac_f32 v32, v72, v220
    v_fmac_f32 v33, v73, v221
    v_fmac_f32 v34, v74, v222
    v_fmac_f32 v35, v75, v223
    s_mov_b64 exec, s[36:37]
    v_mov_b64 v[132:133], v[116:117]
    v_mov_b64 v[134:135], v[118:119]
    v_mov_b64 v[136:137], v[120:121]
    v_mov_b64 v[138:139], v[122:123]
    s_mov_b64 exec, -1
    v_mfma_f32_16x16x32_bf16 v[72:75], v[108:111], v[116:119], 0
    v_mfma_f32_16x16x32_bf16 v[72:75], v[112:115], v[120:123], v[72:75]
    v_fmac_f32 v32, v76, v224
    v_fmac_f32 v33, v77, v225
    v_fmac_f32 v34, v78, v226
    v_fmac_f32 v35, v79, v227
    v_mfma_f32_16x16x32_bf16 v[76:79], v[100:103], v[124:127], 0
    v_mfma_f32_16x16x32_bf16 v[76:79], v[104:107], v[128:131], v[76:79]
    v_fmac_f32 v32, v80, v228
    v_fmac_f32 v33, v81, v229
    v_fmac_f32 v34, v82, v230
    v_fmac_f32 v35, v83, v231
    v_mfma_f32_16x16x32_bf16 v[80:83], v[116:119], v[132:135], 0
    v_mfma_f32_16x16x32_bf16 v[80:83], v[120:123], v[136:139], v[80:83]
    v_fmac_f32 v32, v72, v232
    v_fmac_f32 v33, v73, v233
    v_fmac_f32 v34, v74, v234
    v_fmac_f32 v35, v75, v235
    ds_read_b128 v[92:95], v4 offset:2048
    ds_read_b128 v[96:99], v5 offset:2048
    s_mov_b64 exec, s[62:63]
    ds_read_b128 v[148:151], v22 offset:2048
    ds_read_b128 v[152:155], v23 offset:2048
    s_mov_b64 exec, -1
    s_waitcnt vmcnt(10)
    s_barrier
    s_waitcnt vmcnt(2)
    s_barrier
    s_waitcnt lgkmcnt(0)
    v_mfma_f32_16x16x32_bf16 v[72:75], v[108:111], v[124:127], 0
    v_mfma_f32_16x16x32_bf16 v[72:75], v[112:115], v[128:131], v[72:75]
    v_fmac_f32 v32, v76, v236
    v_fmac_f32 v33, v77, v237
    v_fmac_f32 v34, v78, v238
    v_fmac_f32 v35, v79, v239
    s_mov_b64 exec, s[36:37]
    v_mov_b64 v[132:133], v[124:125]
    v_mov_b64 v[134:135], v[126:127]
    v_mov_b64 v[136:137], v[128:129]
    v_mov_b64 v[138:139], v[130:131]
    s_mov_b64 exec, -1
    v_mfma_f32_16x16x32_bf16 v[76:79], v[116:119], v[124:127], 0
    v_mfma_f32_16x16x32_bf16 v[76:79], v[120:123], v[128:131], v[76:79]
    v_fmac_f32 v32, v80, v240
    v_fmac_f32 v33, v81, v241
    v_fmac_f32 v34, v82, v242
    v_fmac_f32 v35, v83, v243
    v_mfma_f32_16x16x32_bf16 v[80:83], v[124:127], v[132:135], 0
    v_mfma_f32_16x16x32_bf16 v[80:83], v[128:131], v[136:139], v[80:83]
    v_fmac_f32 v32, v72, v244
    v_fmac_f32 v33, v73, v245
    v_fmac_f32 v34, v74, v246
    v_fmac_f32 v35, v75, v247
    s_mov_b64 exec, s[36:37]
    v_mov_b64 v[140:141], v[84:85]
    v_mov_b64 v[142:143], v[86:87]
    v_mov_b64 v[144:145], v[88:89]
    v_mov_b64 v[146:147], v[90:91]
    s_mov_b64 exec, -1
    ds_read_b128 v[100:103], v4 offset:4096
    ds_read_b128 v[104:107], v5 offset:4096
    s_mov_b64 exec, s[64:65]
    ds_read_b128 v[148:151], v22 offset:4096
    ds_read_b128 v[152:155], v23 offset:4096
    s_mov_b64 exec, -1
    s_waitcnt lgkmcnt(0)
    v_mfma_f32_16x16x32_bf16 v[72:75], v[84:87], v[140:143], 0
    v_mfma_f32_16x16x32_bf16 v[72:75], v[88:91], v[144:147], v[72:75]
    v_fmac_f32 v32, v76, v248
    v_fmac_f32 v33, v77, v249
    v_fmac_f32 v34, v78, v250
    v_fmac_f32 v35, v79, v251
    s_mov_b64 exec, s[36:37]
    v_mov_b64 v[140:141], v[92:93]
    v_mov_b64 v[142:143], v[94:95]
    v_mov_b64 v[144:145], v[96:97]
    v_mov_b64 v[146:147], v[98:99]
    s_mov_b64 exec, -1
    v_mfma_f32_16x16x32_bf16 v[76:79], v[84:87], v[92:95], 0
    v_mfma_f32_16x16x32_bf16 v[76:79], v[88:91], v[96:99], v[76:79]
    v_fmac_f32 v32, v80, v252
    v_fmac_f32 v33, v81, v253
    v_fmac_f32 v34, v82, v254
    v_fmac_f32 v35, v83, v255
    v_add_f32 v12, v32, v33
    v_add_f32 v13, v34, v35
    v_add_f32 v12, v12, v13
    v_mfma_f32_16x16x32_bf16 v[80:83], v[92:95], v[140:143], 0
    v_mfma_f32_16x16x32_bf16 v[80:83], v[96:99], v[144:147], v[80:83]
    v_add_f32_dpp v12, v12, v12 row_shr:1 row_mask:0xf bank_mask:0xf bound_ctrl:0
    v_mul_f32 v32, v72, v164
    v_mul_f32 v33, v73, v165
    v_mul_f32 v34, v74, v166
    v_mul_f32 v35, v75, v167
    v_add_f32_dpp v12, v12, v12 row_shr:2 row_mask:0xf bank_mask:0xf bound_ctrl:0
    v_mfma_f32_16x16x32_bf16 v[72:75], v[84:87], v[100:103], 0
    v_mfma_f32_16x16x32_bf16 v[72:75], v[88:91], v[104:107], v[72:75]
    v_add_f32_dpp v12, v12, v12 row_shr:4 row_mask:0xf bank_mask:0xf bound_ctrl:0
    v_fmac_f32 v32, v76, v168
    v_fmac_f32 v33, v77, v169
    v_fmac_f32 v34, v78, v170
    v_fmac_f32 v35, v79, v171
    v_add_f32_dpp v12, v12, v12 row_shr:8 row_mask:0xf bank_mask:0xf bound_ctrl:0
    ds_read_b128 v[108:111], v4 offset:6144
    ds_read_b128 v[112:115], v5 offset:6144
    s_mov_b64 exec, s[66:67]
    ds_read_b128 v[148:151], v22 offset:6144
    ds_read_b128 v[152:155], v23 offset:6144
    s_mov_b64 exec, -1
    s_waitcnt lgkmcnt(0)
    s_mov_b64 exec, s[36:37]
    v_mov_b64 v[140:141], v[100:101]
    v_mov_b64 v[142:143], v[102:103]
    v_mov_b64 v[144:145], v[104:105]
    v_mov_b64 v[146:147], v[106:107]
    s_mov_b64 exec, -1
    v_add_f32_dpp v12, v12, v12 row_bcast:15 row_mask:0xa bank_mask:0xf
    v_mfma_f32_16x16x32_bf16 v[76:79], v[92:95], v[100:103], 0
    v_mfma_f32_16x16x32_bf16 v[76:79], v[96:99], v[104:107], v[76:79]
    v_add_f32_dpp v12, v12, v12 row_bcast:31 row_mask:0xc bank_mask:0xf
    v_fmac_f32 v32, v80, v172
    v_fmac_f32 v33, v81, v173
    v_fmac_f32 v34, v82, v174
    v_fmac_f32 v35, v83, v175
    v_readlane_b32 s38, v12, 63
    v_mfma_f32_16x16x32_bf16 v[80:83], v[84:87], v[108:111], 0
    v_mfma_f32_16x16x32_bf16 v[80:83], v[88:91], v[112:115], v[80:83]
    v_writelane_b32 v9, s38, 14
    v_fmac_f32 v32, v72, v176
    v_fmac_f32 v33, v73, v177
    v_fmac_f32 v34, v74, v178
    v_fmac_f32 v35, v75, v179
    v_mfma_f32_16x16x32_bf16 v[72:75], v[100:103], v[140:143], 0
    v_mfma_f32_16x16x32_bf16 v[72:75], v[104:107], v[144:147], v[72:75]
    v_fmac_f32 v32, v76, v180
    v_fmac_f32 v33, v77, v181
    v_fmac_f32 v34, v78, v182
    v_fmac_f32 v35, v79, v183
    v_mfma_f32_16x16x32_bf16 v[76:79], v[92:95], v[108:111], 0
    v_mfma_f32_16x16x32_bf16 v[76:79], v[96:99], v[112:115], v[76:79]
    v_fmac_f32 v32, v80, v184
    v_fmac_f32 v33, v81, v185
    v_fmac_f32 v34, v82, v186
    v_fmac_f32 v35, v83, v187
    ds_read_b128 v[116:119], v4 offset:8192
    ds_read_b128 v[120:123], v5 offset:8192
    s_mov_b64 exec, s[60:61]
    ds_read_b128 v[156:159], v22 offset:8192
    ds_read_b128 v[160:163], v23 offset:8192
    s_mov_b64 exec, -1
    s_waitcnt lgkmcnt(0)
    v_mfma_f32_16x16x32_bf16 v[80:83], v[148:151], v[148:151], 0
    v_mfma_f32_16x16x32_bf16 v[80:83], v[152:155], v[152:155], v[80:83]
    v_fmac_f32 v32, v72, v188
    v_fmac_f32 v33, v73, v189
    v_fmac_f32 v34, v74, v190
    v_fmac_f32 v35, v75, v191
    v_mfma_f32_16x16x32_bf16 v[72:75], v[84:87], v[116:119], 0
    v_mfma_f32_16x16x32_bf16 v[72:75], v[88:91], v[120:123], v[72:75]
    v_fmac_f32 v32, v76, v192
    v_fmac_f32 v33, v77, v193
    v_fmac_f32 v34, v78, v194
    v_fmac_f32 v35, v79, v195
    s_mov_b64 exec, s[36:37]
    v_mov_b64 v[140:141], v[108:109]
    v_mov_b64 v[142:143], v[110:111]
    v_mov_b64 v[144:145], v[112:113]
    v_mov_b64 v[146:147], v[114:115]
    s_mov_b64 exec, -1
    v_mfma_f32_16x16x32_bf16 v[76:79], v[100:103], v[108:111], 0
    v_mfma_f32_16x16x32_bf16 v[76:79], v[104:107], v[112:115], v[76:79]
    v_fmac_f32 v32, v80, v196
    v_fmac_f32 v33, v81, v197
    v_fmac_f32 v34, v82, v198
    v_fmac_f32 v35, v83, v199
    v_mfma_f32_16x16x32_bf16 v[80:83], v[92:95], v[116:119], 0
    v_mfma_f32_16x16x32_bf16 v[80:83], v[96:99], v[120:123], v[80:83]
    v_fmac_f32 v32, v72, v200
    v_fmac_f32 v33, v73, v201
    v_fmac_f32 v34, v74, v202
    v_fmac_f32 v35, v75, v203
    s_waitcnt vmcnt(0)
    ds_read_b128 v[124:127], v4 offset:0
    ds_read_b128 v[128:131], v5 offset:0
    s_mov_b64 exec, s[62:63]
    ds_read_b128 v[156:159], v22 offset:0
    ds_read_b128 v[160:163], v23 offset:0
    s_mov_b64 exec, -1
    s_waitcnt lgkmcnt(0)
    v_mfma_f32_16x16x32_bf16 v[72:75], v[84:87], v[124:127], 0
    v_mfma_f32_16x16x32_bf16 v[72:75], v[88:91], v[128:131], v[72:75]
    v_fmac_f32 v32, v76, v204
    v_fmac_f32 v33, v77, v205
    v_fmac_f32 v34, v78, v206
    v_fmac_f32 v35, v79, v207
    v_mfma_f32_16x16x32_bf16 v[76:79], v[108:111], v[140:143], 0
    v_mfma_f32_16x16x32_bf16 v[76:79], v[112:115], v[144:147], v[76:79]
    v_fmac_f32 v32, v80, v208
    v_fmac_f32 v33, v81, v209
    v_fmac_f32 v34, v82, v210
    v_fmac_f32 v35, v83, v211
    v_mfma_f32_16x16x32_bf16 v[80:83], v[92:95], v[124:127], 0
    v_mfma_f32_16x16x32_bf16 v[80:83], v[96:99], v[128:131], v[80:83]
    v_fmac_f32 v32, v72, v212
    v_fmac_f32 v33, v73, v213
    v_fmac_f32 v34, v74, v214
    v_fmac_f32 v35, v75, v215
    v_mfma_f32_16x16x32_bf16 v[72:75], v[156:159], v[156:159], 0
    v_mfma_f32_16x16x32_bf16 v[72:75], v[160:163], v[160:163], v[72:75]
    v_fmac_f32 v32, v76, v216
    v_fmac_f32 v33, v77, v217
    v_fmac_f32 v34, v78, v218
    v_fmac_f32 v35, v79, v219
    v_mfma_f32_16x16x32_bf16 v[76:79], v[100:103], v[116:119], 0
    v_mfma_f32_16x16x32_bf16 v[76:79], v[104:107], v[120:123], v[76:79]
    v_fmac_f32 v32, v80, v220
    v_fmac_f32 v33, v81, v221
    v_fmac_f32 v34, v82, v222
    v_fmac_f32 v35, v83, v223
    s_mov_b64 exec, s[36:37]
    v_mov_b64 v[140:141], v[116:117]
    v_mov_b64 v[142:143], v[118:119]
    v_mov_b64 v[144:145], v[120:121]
    v_mov_b64 v[146:147], v[122:123]
    s_mov_b64 exec, -1
    v_mfma_f32_16x16x32_bf16 v[80:83], v[108:111], v[116:119], 0
    v_mfma_f32_16x16x32_bf16 v[80:83], v[112:115], v[120:123], v[80:83]
    v_fmac_f32 v32, v72, v224
    v_fmac_f32 v33, v73, v225
    v_fmac_f32 v34, v74, v226
    v_fmac_f32 v35, v75, v227
    v_mfma_f32_16x16x32_bf16 v[72:75], v[100:103], v[124:127], 0
    v_mfma_f32_16x16x32_bf16 v[72:75], v[104:107], v[128:131], v[72:75]
    v_fmac_f32 v32, v76, v228
    v_fmac_f32 v33, v77, v229
    v_fmac_f32 v34, v78, v230
    v_fmac_f32 v35, v79, v231
    v_mfma_f32_16x16x32_bf16 v[76:79], v[116:119], v[140:143], 0
    v_mfma_f32_16x16x32_bf16 v[76:79], v[120:123], v[144:147], v[76:79]
    v_fmac_f32 v32, v80, v232
    v_fmac_f32 v33, v81, v233
    v_fmac_f32 v34, v82, v234
    v_fmac_f32 v35, v83, v235
    v_mfma_f32_16x16x32_bf16 v[80:83], v[108:111], v[124:127], 0
    v_mfma_f32_16x16x32_bf16 v[80:83], v[112:115], v[128:131], v[80:83]
    v_fmac_f32 v32, v72, v236
    v_fmac_f32 v33, v73, v237
    v_fmac_f32 v34, v74, v238
    v_fmac_f32 v35, v75, v239
    s_mov_b64 exec, s[36:37]
    v_mov_b64 v[140:141], v[124:125]
    v_mov_b64 v[142:143], v[126:127]
    v_mov_b64 v[144:145], v[128:129]
    v_mov_b64 v[146:147], v[130:131]
    s_mov_b64 exec, -1
    v_mfma_f32_16x16x32_bf16 v[72:75], v[116:119], v[124:127], 0
    v_mfma_f32_16x16x32_bf16 v[72:75], v[120:123], v[128:131], v[72:75]
    v_fmac_f32 v32, v76, v240
    v_fmac_f32 v33, v77, v241
    v_fmac_f32 v34, v78, v242
    v_fmac_f32 v35, v79, v243
    v_mfma_f32_16x16x32_bf16 v[76:79], v[124:127], v[140:143], 0
    v_mfma_f32_16x16x32_bf16 v[76:79], v[128:131], v[144:147], v[76:79]
    v_fmac_f32 v32, v80, v244
    v_fmac_f32 v33, v81, v245
    v_fmac_f32 v34, v82, v246
    v_fmac_f32 v35, v83, v247
    s_nop 7
    v_fmac_f32 v32, v72, v248
    v_fmac_f32 v33, v73, v249
    v_fmac_f32 v34, v74, v250
    v_fmac_f32 v35, v75, v251
    s_nop 7
    v_fmac_f32 v32, v76, v252
    v_fmac_f32 v33, v77, v253
    v_fmac_f32 v34, v78, v254
    v_fmac_f32 v35, v79, v255
    v_add_f32 v12, v32, v33
    v_add_f32 v13, v34, v35
    v_add_f32 v12, v12, v13
    s_nop 3
    v_add_f32_dpp v12, v12, v12 row_shr:1 row_mask:0xf bank_mask:0xf bound_ctrl:0
    s_nop 3
    v_add_f32_dpp v12, v12, v12 row_shr:2 row_mask:0xf bank_mask:0xf bound_ctrl:0
    s_nop 3
    v_add_f32_dpp v12, v12, v12 row_shr:4 row_mask:0xf bank_mask:0xf bound_ctrl:0
    s_nop 3
    v_add_f32_dpp v12, v12, v12 row_shr:8 row_mask:0xf bank_mask:0xf bound_ctrl:0
    s_nop 3
    v_add_f32_dpp v12, v12, v12 row_bcast:15 row_mask:0xa bank_mask:0xf
    s_nop 3
    v_add_f32_dpp v12, v12, v12 row_bcast:31 row_mask:0xc bank_mask:0xf
    s_nop 3
    v_readlane_b32 s38, v12, 63
    s_nop 3
    v_writelane_b32 v9, s38, 15
    s_lshl_b32 s74, s3, 2
    s_add_u32 s74, s74, 161792
    v_add_u32 v12, s74, v10
    v_lshlrev_b32 v17, 16, v17
    v_add_f32 v9, v9, v17
    s_mov_b64 exec, 0xffff
    ds_write_b32 v12, v9
    s_mov_b64 exec, -1
    s_waitcnt lgkmcnt(0)
    s_barrier
L_end:
    s_endpgm
.p2align 6
L_gemm:
    v_and_b32 v10, 15, v0
    v_lshrrev_b32 v11, 4, v0
    v_lshlrev_b32 v12, 4, v0
    s_lshl_b32 s75, s3, 7
    v_lshlrev_b32 v13, 3, v11
    v_add_u32 v13, s75, v13
    v_add_u32 v13, 162112, v13
    v_lshrrev_b32 v15, 1, v10
    v_xor_b32 v15, v15, v11
    v_lshlrev_b32 v15, 4, v15
    v_lshl_add_u32 v6, v10, 7, v15
    v_xor_b32 v7, 64, v6
    v_bfe_u32 v15, v0, 2, 2
    v_lshlrev_b32 v2, 7, v15
    v_bfe_u32 v15, v0, 3, 2
    v_lshl_add_u32 v2, v15, 5, v2
    v_and_b32 v15, 3, v0
    v_lshl_add_u32 v2, v15, 3, v2
    v_lshl_add_u32 v2, v11, 10, v2
    s_lshl_b32 s74, s3, 12
    s_add_u32 s74, s74, 49152
    v_add_u32 v2, s74, v2
    v_xor_b32 v3, 32, v2
    v_xor_b32 v4, 64, v2
    v_xor_b32 v5, 96, v2
    v_mov_b32 v8, v6
    v_mov_b32 v9, v7
    s_mov_b32 s79, 0
    s_mov_b32 s20, 0
    s_mov_b32 s27, 0
    s_lshr_b32 s81, s2, 4
    s_mul_i32 s81, s81, 4
    s_lshr_b32 s81, s81, 2
    s_sub_u32 s81, 22, s81
    s_mov_b32 s26, 0
    s_lshl_b32 s75, s3, 13
    s_lshl_b32 s16, s2, 15
    s_add_u32 s16, s16, s75
    s_lshl_b32 s17, s83, 15
    s_add_u32 s17, s17, s75
    s_add_u32 s18, s16, 4096
    s_add_u32 s19, s17, 4096
    s_mov_b32 s21, 0x10001
    s_mov_b32 s22, 0xffff
    s_mov_b32 s23, 0x10000
    v_mov_b32 v14, 0
    v_mov_b32 v15, 1
    s_waitcnt lgkmcnt(0)
    s_mov_b32 s68, s58
    s_and_b32 s69, s59, 0xffff
    s_mov_b32 s70, 8388608
    s_mov_b32 s71, 0x20000
    s_mov_b32 s60, s54
    s_and_b32 s61, s55, 0xffff
    s_mov_b32 s62, 32768
    s_mov_b32 s63, 0x20000
    s_mov_b32 s64, s56
    s_and_b32 s65, s57, 0xffff
    s_mov_b32 s66, 256
    s_mov_b32 s67, 0x20000
    s_mov_b32 s28, s48
    s_and_b32 s29, s49, 0xffff
    s_mov_b32 s30, 512
    s_mov_b32 s31, 0x20000
    v_subrev_u32 v16, 162112, v13
    buffer_load_dwordx2 v[48:49], v16, s[28:31], 0 offen offset:0
    buffer_load_dwordx2 v[50:51], v16, s[28:31], 0 offen offset:32
    buffer_load_dwordx2 v[52:53], v16, s[28:31], 0 offen offset:64
    buffer_load_dwordx2 v[54:55], v16, s[28:31], 0 offen offset:96
    s_mov_b64 vcc, 0
    v_mov_b64 v[20:21], 0
    v_mov_b64 v[22:23], 0
L_ginit:
    s_mov_b64 exec, -1
    s_mov_b32 s78, 24
    s_mov_b32 s79, 0
    v_mov_b32 v14, 0
    v_mov_b32 v8, v6
    v_mov_b32 v9, v7
    s_nop 7
    v_mov_b64 v[192:193], 0
    v_mov_b64 v[194:195], 0
    v_mov_b64 v[196:197], 0
    v_mov_b64 v[198:199], 0
    v_mov_b64 v[200:201], 0
    v_mov_b64 v[202:203], 0
    v_mov_b64 v[204:205], 0
    v_mov_b64 v[206:207], 0
    v_mov_b64 v[208:209], 0
    v_mov_b64 v[210:211], 0
    v_mov_b64 v[212:213], 0
    v_mov_b64 v[214:215], 0
    v_mov_b64 v[216:217], 0
    v_mov_b64 v[218:219], 0
    v_mov_b64 v[220:221], 0
    v_mov_b64 v[222:223], 0
    v_mov_b64 v[224:225], 0
    v_mov_b64 v[226:227], 0
    v_mov_b64 v[228:229], 0
    v_mov_b64 v[230:231], 0
    v_mov_b64 v[232:233], 0
    v_mov_b64 v[234:235], 0
    v_mov_b64 v[236:237], 0
    v_mov_b64 v[238:239], 0
    v_mov_b64 v[240:241], 0
    v_mov_b64 v[242:243], 0
    v_mov_b64 v[244:245], 0
    v_mov_b64 v[246:247], 0
    v_mov_b64 v[248:249], 0
    v_mov_b64 v[250:251], 0
    v_mov_b64 v[252:253], 0
    v_mov_b64 v[254:255], 0
    s_waitcnt vmcnt(0)
    v_lshlrev_b32 v128, 16, v48
    v_and_b32 v129, s33, v48
    v_lshlrev_b32 v130, 16, v49
    v_and_b32 v131, s33, v49
    v_lshlrev_b32 v132, 16, v50
    v_and_b32 v133, s33, v50
    v_lshlrev_b32 v134, 16, v51
    v_and_b32 v135, s33, v51
    v_lshlrev_b32 v136, 16, v52
    v_and_b32 v137, s33, v52
    v_lshlrev_b32 v138, 16, v53
    v_and_b32 v139, s33, v53
    v_lshlrev_b32 v140, 16, v54
    v_and_b32 v141, s33, v54
    v_lshlrev_b32 v142, 16, v55
    v_and_b32 v143, s33, v55
    v_mov_b64 v[144:145], v[128:129]
    v_mov_b64 v[146:147], v[130:131]
    v_mov_b64 v[148:149], v[132:133]
    v_mov_b64 v[150:151], v[134:135]
    v_mov_b64 v[152:153], v[136:137]
    v_mov_b64 v[154:155], v[138:139]
    v_mov_b64 v[156:157], v[140:141]
    v_mov_b64 v[158:159], v[142:143]
    v_mov_b64 v[160:161], v[128:129]
    v_mov_b64 v[162:163], v[130:131]
    v_mov_b64 v[164:165], v[132:133]
    v_mov_b64 v[166:167], v[134:135]
    v_mov_b64 v[168:169], v[136:137]
    v_mov_b64 v[170:171], v[138:139]
    v_mov_b64 v[172:173], v[140:141]
    v_mov_b64 v[174:175], v[142:143]
    v_mov_b64 v[176:177], v[128:129]
    v_mov_b64 v[178:179], v[130:131]
    v_mov_b64 v[180:181], v[132:133]
    v_mov_b64 v[182:183], v[134:135]
    v_mov_b64 v[184:185], v[136:137]
    v_mov_b64 v[186:187], v[138:139]
    v_mov_b64 v[188:189], v[140:141]
    v_mov_b64 v[190:191], v[142:143]
    s_waitcnt lgkmcnt(0)
    s_barrier
    ds_read_b128 v[96:99], v8 offset:0
    ds_read_b64_tr_b16 v[64:65], v2 offset:0
    ds_read_b64_tr_b16 v[66:67], v2 offset:512
    ds_read_b64_tr_b16 v[68:69], v3 offset:0
    ds_read_b64_tr_b16 v[70:71], v3 offset:512
    ds_read_b64_tr_b16 v[72:73], v4 offset:0
    ds_read_b64_tr_b16 v[74:75], v4 offset:512
    ds_read_b64_tr_b16 v[76:77], v5 offset:0
    ds_read_b64_tr_b16 v[78:79], v5 offset:512
    ds_read_b128 v[100:103], v8 offset:2048
    ds_read_b128 v[104:107], v8 offset:4096
    ds_read_b128 v[108:111], v8 offset:6144
    ds_read_b128 v[112:115], v8 offset:8192
    ds_read_b128 v[116:119], v8 offset:10240
    ds_read_b128 v[120:123], v8 offset:12288
.p2align 6
L_gloop:
    s_waitcnt lgkmcnt(6)
    v_mfma_f32_16x16x32_bf16 v[128:131], v[64:67], v[96:99], v[128:131]
    ds_read_b128 v[124:127], v8 offset:14336
    v_mfma_f32_16x16x32_bf16 v[132:135], v[68:71], v[96:99], v[132:135]
    v_mfma_f32_16x16x32_bf16 v[136:139], v[72:75], v[96:99], v[136:139]
    v_mfma_f32_16x16x32_bf16 v[140:143], v[76:79], v[96:99], v[140:143]
    s_waitcnt lgkmcnt(4)
    v_mfma_f32_16x16x32_bf16 v[156:159], v[76:79], v[100:103], v[156:159]
    v_mfma_f32_16x16x32_bf16 v[152:155], v[72:75], v[100:103], v[152:155]
    v_mfma_f32_16x16x32_bf16 v[148:151], v[68:71], v[100:103], v[148:151]
    v_mfma_f32_16x16x32_bf16 v[144:147], v[64:67], v[100:103], v[144:147]
    v_mfma_f32_16x16x32_bf16 v[160:163], v[64:67], v[104:107], v[160:163]
    v_mfma_f32_16x16x32_bf16 v[164:167], v[68:71], v[104:107], v[164:167]
    v_mfma_f32_16x16x32_bf16 v[168:171], v[72:75], v[104:107], v[168:171]
    s_cmp_eq_u32 s78, s81
    s_cbranch_scc1 L_event
L_evret:
    v_mfma_f32_16x16x32_bf16 v[172:175], v[76:79], v[104:107], v[172:175]
    v_mfma_f32_16x16x32_bf16 v[188:191], v[76:79], v[108:111], v[188:191]
    v_mfma_f32_16x16x32_bf16 v[184:187], v[72:75], v[108:111], v[184:187]
    v_mfma_f32_16x16x32_bf16 v[180:183], v[68:71], v[108:111], v[180:183]
    v_mfma_f32_16x16x32_bf16 v[176:179], v[64:67], v[108:111], v[176:179]
    s_waitcnt lgkmcnt(0)
    v_mfma_f32_16x16x32_bf16 v[192:195], v[64:67], v[112:115], v[192:195]
    s_barrier
    ds_read_b128 v[96:99], v9 offset:0
    v_mfma_f32_16x16x32_bf16 v[196:199], v[68:71], v[112:115], v[196:199]
    ds_read_b64_tr_b16 v[80:81], v2 offset:16384
    v_mfma_f32_16x16x32_bf16 v[200:203], v[72:75], v[112:115], v[200:203]
    ds_read_b64_tr_b16 v[82:83], v2 offset:16896
    v_mfma_f32_16x16x32_bf16 v[204:207], v[76:79], v[112:115], v[204:207]
    ds_read_b64_tr_b16 v[84:85], v3 offset:16384
    v_mfma_f32_16x16x32_bf16 v[220:223], v[76:79], v[116:119], v[220:223]
    ds_read_b64_tr_b16 v[86:87], v3 offset:16896
    v_mfma_f32_16x16x32_bf16 v[216:219], v[72:75], v[116:119], v[216:219]
    ds_read_b64_tr_b16 v[88:89], v4 offset:16384
    v_mfma_f32_16x16x32_bf16 v[212:215], v[68:71], v[116:119], v[212:215]
    ds_read_b64_tr_b16 v[90:91], v4 offset:16896
    v_mfma_f32_16x16x32_bf16 v[208:211], v[64:67], v[116:119], v[208:211]
    ds_read_b64_tr_b16 v[92:93], v5 offset:16384
    v_mfma_f32_16x16x32_bf16 v[224:227], v[64:67], v[120:123], v[224:227]
    ds_read_b64_tr_b16 v[94:95], v5 offset:16896
    v_mfma_f32_16x16x32_bf16 v[228:231], v[68:71], v[120:123], v[228:231]
    ds_read_b128 v[100:103], v9 offset:2048
    v_mfma_f32_16x16x32_bf16 v[232:235], v[72:75], v[120:123], v[232:235]
    ds_read_b128 v[104:107], v9 offset:4096
    v_mfma_f32_16x16x32_bf16 v[236:239], v[76:79], v[120:123], v[236:239]
    ds_read_b128 v[108:111], v9 offset:6144
    v_mfma_f32_16x16x32_bf16 v[252:255], v[76:79], v[124:127], v[252:255]
    ds_read_b128 v[112:115], v9 offset:8192
    v_mfma_f32_16x16x32_bf16 v[248:251], v[72:75], v[124:127], v[248:251]
    ds_read_b128 v[116:119], v9 offset:10240
    v_mfma_f32_16x16x32_bf16 v[244:247], v[68:71], v[124:127], v[244:247]
    ds_read_b128 v[120:123], v9 offset:12288
    v_mfma_f32_16x16x32_bf16 v[240:243], v[64:67], v[124:127], v[240:243]
    s_waitcnt lgkmcnt(6)
    v_mfma_f32_16x16x32_bf16 v[128:131], v[80:83], v[96:99], v[128:131]
    ds_read_b128 v[124:127], v9 offset:14336
    v_mfma_f32_16x16x32_bf16 v[132:135], v[84:87], v[96:99], v[132:135]
    v_mfma_f32_16x16x32_bf16 v[136:139], v[88:91], v[96:99], v[136:139]
    v_mfma_f32_16x16x32_bf16 v[140:143], v[92:95], v[96:99], v[140:143]
    s_waitcnt lgkmcnt(4)
    v_mfma_f32_16x16x32_bf16 v[156:159], v[92:95], v[100:103], v[156:159]
    v_mfma_f32_16x16x32_bf16 v[152:155], v[88:91], v[100:103], v[152:155]
    v_mfma_f32_16x16x32_bf16 v[148:151], v[84:87], v[100:103], v[148:151]
    v_mfma_f32_16x16x32_bf16 v[144:147], v[80:83], v[100:103], v[144:147]
    v_mfma_f32_16x16x32_bf16 v[160:163], v[80:83], v[104:107], v[160:163]
    s_add_u32 s79, s79, 16384
    v_mfma_f32_16x16x32_bf16 v[164:167], v[84:87], v[104:107], v[164:167]
    s_cmp_eq_u32 s79, 49152
    v_mfma_f32_16x16x32_bf16 v[168:171], v[88:91], v[104:107], v[168:171]
    s_cselect_b32 s79, 0, s79
    v_mfma_f32_16x16x32_bf16 v[172:175], v[92:95], v[104:107], v[172:175]
    v_mfma_f32_16x16x32_bf16 v[188:191], v[92:95], v[108:111], v[188:191]
    v_add_u32 v8, s79, v6
    v_mfma_f32_16x16x32_bf16 v[184:187], v[88:91], v[108:111], v[184:187]
    v_add_u32 v9, s79, v7
    v_mfma_f32_16x16x32_bf16 v[180:183], v[84:87], v[108:111], v[180:183]
    v_mfma_f32_16x16x32_bf16 v[176:179], v[80:83], v[108:111], v[176:179]
    s_waitcnt lgkmcnt(0)
    v_mfma_f32_16x16x32_bf16 v[192:195], v[80:83], v[112:115], v[192:195]
    s_barrier
    ds_read_b128 v[96:99], v8 offset:0
    v_mfma_f32_16x16x32_bf16 v[196:199], v[84:87], v[112:115], v[196:199]
    ds_read_b64_tr_b16 v[64:65], v2 offset:32768
    v_mfma_f32_16x16x32_bf16 v[200:203], v[88:91], v[112:115], v[200:203]
    ds_read_b64_tr_b16 v[66:67], v2 offset:33280
    v_mfma_f32_16x16x32_bf16 v[204:207], v[92:95], v[112:115], v[204:207]
    ds_read_b64_tr_b16 v[68:69], v3 offset:32768
    v_mfma_f32_16x16x32_bf16 v[220:223], v[92:95], v[116:119], v[220:223]
    ds_read_b64_tr_b16 v[70:71], v3 offset:33280
    v_mfma_f32_16x16x32_bf16 v[216:219], v[88:91], v[116:119], v[216:219]
    ds_read_b64_tr_b16 v[72:73], v4 offset:32768
    v_mfma_f32_16x16x32_bf16 v[212:215], v[84:87], v[116:119], v[212:215]
    ds_read_b64_tr_b16 v[74:75], v4 offset:33280
    v_mfma_f32_16x16x32_bf16 v[208:211], v[80:83], v[116:119], v[208:211]
    ds_read_b64_tr_b16 v[76:77], v5 offset:32768
    v_mfma_f32_16x16x32_bf16 v[224:227], v[80:83], v[120:123], v[224:227]
    ds_read_b64_tr_b16 v[78:79], v5 offset:33280
    v_mfma_f32_16x16x32_bf16 v[228:231], v[84:87], v[120:123], v[228:231]
    ds_read_b128 v[100:103], v8 offset:2048
    v_mfma_f32_16x16x32_bf16 v[232:235], v[88:91], v[120:123], v[232:235]
    ds_read_b128 v[104:107], v8 offset:4096
    v_mfma_f32_16x16x32_bf16 v[236:239], v[92:95], v[120:123], v[236:239]
    ds_read_b128 v[108:111], v8 offset:6144
    v_mfma_f32_16x16x32_bf16 v[252:255], v[92:95], v[124:127], v[252:255]
    ds_read_b128 v[112:115], v8 offset:8192
    v_mfma_f32_16x16x32_bf16 v[248:251], v[88:91], v[124:127], v[248:251]
    ds_read_b128 v[116:119], v8 offset:10240
    v_mfma_f32_16x16x32_bf16 v[244:247], v[84:87], v[124:127], v[244:247]
    ds_read_b128 v[120:123], v8 offset:12288
    v_mfma_f32_16x16x32_bf16 v[240:243], v[80:83], v[124:127], v[240:243]
    s_waitcnt lgkmcnt(6)
    v_mfma_f32_16x16x32_bf16 v[128:131], v[64:67], v[96:99], v[128:131]
    ds_read_b128 v[124:127], v8 offset:14336
    v_mfma_f32_16x16x32_bf16 v[132:135], v[68:71], v[96:99], v[132:135]
    v_mfma_f32_16x16x32_bf16 v[136:139], v[72:75], v[96:99], v[136:139]
    v_mfma_f32_16x16x32_bf16 v[140:143], v[76:79], v[96:99], v[140:143]
    s_waitcnt lgkmcnt(4)
    v_mfma_f32_16x16x32_bf16 v[156:159], v[76:79], v[100:103], v[156:159]
    v_mfma_f32_16x16x32_bf16 v[152:155], v[72:75], v[100:103], v[152:155]
    v_mfma_f32_16x16x32_bf16 v[148:151], v[68:71], v[100:103], v[148:151]
    v_mfma_f32_16x16x32_bf16 v[144:147], v[64:67], v[100:103], v[144:147]
    v_mfma_f32_16x16x32_bf16 v[160:163], v[64:67], v[104:107], v[160:163]
    v_mfma_f32_16x16x32_bf16 v[164:167], v[68:71], v[104:107], v[164:167]
    v_mfma_f32_16x16x32_bf16 v[168:171], v[72:75], v[104:107], v[168:171]
    v_mfma_f32_16x16x32_bf16 v[172:175], v[76:79], v[104:107], v[172:175]
    v_mfma_f32_16x16x32_bf16 v[188:191], v[76:79], v[108:111], v[188:191]
    v_mfma_f32_16x16x32_bf16 v[184:187], v[72:75], v[108:111], v[184:187]
    v_mfma_f32_16x16x32_bf16 v[180:183], v[68:71], v[108:111], v[180:183]
    v_mfma_f32_16x16x32_bf16 v[176:179], v[64:67], v[108:111], v[176:179]
    s_waitcnt lgkmcnt(0)
    v_mfma_f32_16x16x32_bf16 v[192:195], v[64:67], v[112:115], v[192:195]
    s_barrier
    ds_read_b128 v[96:99], v9 offset:0
    v_mfma_f32_16x16x32_bf16 v[196:199], v[68:71], v[112:115], v[196:199]
    ds_read_b64_tr_b16 v[80:81], v2 offset:49152
    v_mfma_f32_16x16x32_bf16 v[200:203], v[72:75], v[112:115], v[200:203]
    ds_read_b64_tr_b16 v[82:83], v2 offset:49664
    v_mfma_f32_16x16x32_bf16 v[204:207], v[76:79], v[112:115], v[204:207]
    ds_read_b64_tr_b16 v[84:85], v3 offset:49152
    v_mfma_f32_16x16x32_bf16 v[220:223], v[76:79], v[116:119], v[220:223]
    ds_read_b64_tr_b16 v[86:87], v3 offset:49664
    v_mfma_f32_16x16x32_bf16 v[216:219], v[72:75], v[116:119], v[216:219]
    ds_read_b64_tr_b16 v[88:89], v4 offset:49152
    v_mfma_f32_16x16x32_bf16 v[212:215], v[68:71], v[116:119], v[212:215]
    ds_read_b64_tr_b16 v[90:91], v4 offset:49664
    v_mfma_f32_16x16x32_bf16 v[208:211], v[64:67], v[116:119], v[208:211]
    ds_read_b64_tr_b16 v[92:93], v5 offset:49152
    v_mfma_f32_16x16x32_bf16 v[224:227], v[64:67], v[120:123], v[224:227]
    ds_read_b64_tr_b16 v[94:95], v5 offset:49664
    v_mfma_f32_16x16x32_bf16 v[228:231], v[68:71], v[120:123], v[228:231]
    ds_read_b128 v[100:103], v9 offset:2048
    v_mfma_f32_16x16x32_bf16 v[232:235], v[72:75], v[120:123], v[232:235]
    ds_read_b128 v[104:107], v9 offset:4096
    v_mfma_f32_16x16x32_bf16 v[236:239], v[76:79], v[120:123], v[236:239]
    ds_read_b128 v[108:111], v9 offset:6144
    v_mfma_f32_16x16x32_bf16 v[252:255], v[76:79], v[124:127], v[252:255]
    ds_read_b128 v[112:115], v9 offset:8192
    v_mfma_f32_16x16x32_bf16 v[248:251], v[72:75], v[124:127], v[248:251]
    ds_read_b128 v[116:119], v9 offset:10240
    v_mfma_f32_16x16x32_bf16 v[244:247], v[68:71], v[124:127], v[244:247]
    ds_read_b128 v[120:123], v9 offset:12288
    v_mfma_f32_16x16x32_bf16 v[240:243], v[64:67], v[124:127], v[240:243]
    s_waitcnt lgkmcnt(6)
    v_mfma_f32_16x16x32_bf16 v[128:131], v[80:83], v[96:99], v[128:131]
    ds_read_b128 v[124:127], v9 offset:14336
    v_mfma_f32_16x16x32_bf16 v[132:135], v[84:87], v[96:99], v[132:135]
    v_mfma_f32_16x16x32_bf16 v[136:139], v[88:91], v[96:99], v[136:139]
    v_mfma_f32_16x16x32_bf16 v[140:143], v[92:95], v[96:99], v[140:143]
    s_waitcnt lgkmcnt(4)
    v_mfma_f32_16x16x32_bf16 v[156:159], v[92:95], v[100:103], v[156:159]
    v_mfma_f32_16x16x32_bf16 v[152:155], v[88:91], v[100:103], v[152:155]
    v_mfma_f32_16x16x32_bf16 v[148:151], v[84:87], v[100:103], v[148:151]
    v_mfma_f32_16x16x32_bf16 v[144:147], v[80:83], v[100:103], v[144:147]
    v_mfma_f32_16x16x32_bf16 v[160:163], v[80:83], v[104:107], v[160:163]
    s_add_u32 s79, s79, 16384
    v_mfma_f32_16x16x32_bf16 v[164:167], v[84:87], v[104:107], v[164:167]
    s_cmp_eq_u32 s79, 49152
    v_mfma_f32_16x16x32_bf16 v[168:171], v[88:91], v[104:107], v[168:171]
    s_cselect_b32 s79, 0, s79
    v_mfma_f32_16x16x32_bf16 v[172:175], v[92:95], v[104:107], v[172:175]
    v_mfma_f32_16x16x32_bf16 v[188:191], v[92:95], v[108:111], v[188:191]
    v_add_u32 v8, s79, v6
    v_mfma_f32_16x16x32_bf16 v[184:187], v[88:91], v[108:111], v[184:187]
    v_add_u32 v9, s79, v7
    v_mfma_f32_16x16x32_bf16 v[180:183], v[84:87], v[108:111], v[180:183]
    v_mfma_f32_16x16x32_bf16 v[176:179], v[80:83], v[108:111], v[176:179]
    s_waitcnt lgkmcnt(0)
    v_mfma_f32_16x16x32_bf16 v[192:195], v[80:83], v[112:115], v[192:195]
    s_barrier
    ds_read_b128 v[96:99], v8 offset:0
    v_mfma_f32_16x16x32_bf16 v[196:199], v[84:87], v[112:115], v[196:199]
    ds_read_b64_tr_b16 v[64:65], v2 offset:0
    v_mfma_f32_16x16x32_bf16 v[200:203], v[88:91], v[112:115], v[200:203]
    ds_read_b64_tr_b16 v[66:67], v2 offset:512
    v_mfma_f32_16x16x32_bf16 v[204:207], v[92:95], v[112:115], v[204:207]
    ds_read_b64_tr_b16 v[68:69], v3 offset:0
    v_mfma_f32_16x16x32_bf16 v[220:223], v[92:95], v[116:119], v[220:223]
    ds_read_b64_tr_b16 v[70:71], v3 offset:512
    v_mfma_f32_16x16x32_bf16 v[216:219], v[88:91], v[116:119], v[216:219]
    ds_read_b64_tr_b16 v[72:73], v4 offset:0
    v_mfma_f32_16x16x32_bf16 v[212:215], v[84:87], v[116:119], v[212:215]
    ds_read_b64_tr_b16 v[74:75], v4 offset:512
    v_mfma_f32_16x16x32_bf16 v[208:211], v[80:83], v[116:119], v[208:211]
    ds_read_b64_tr_b16 v[76:77], v5 offset:0
    v_mfma_f32_16x16x32_bf16 v[224:227], v[80:83], v[120:123], v[224:227]
    ds_read_b64_tr_b16 v[78:79], v5 offset:512
    v_mfma_f32_16x16x32_bf16 v[228:231], v[84:87], v[120:123], v[228:231]
    ds_read_b128 v[100:103], v8 offset:2048
    v_mfma_f32_16x16x32_bf16 v[232:235], v[88:91], v[120:123], v[232:235]
    ds_read_b128 v[104:107], v8 offset:4096
    v_mfma_f32_16x16x32_bf16 v[236:239], v[92:95], v[120:123], v[236:239]
    ds_read_b128 v[108:111], v8 offset:6144
    v_mfma_f32_16x16x32_bf16 v[252:255], v[92:95], v[124:127], v[252:255]
    ds_read_b128 v[112:115], v8 offset:8192
    v_mfma_f32_16x16x32_bf16 v[248:251], v[88:91], v[124:127], v[248:251]
    ds_read_b128 v[116:119], v8 offset:10240
    v_mfma_f32_16x16x32_bf16 v[244:247], v[84:87], v[124:127], v[244:247]
    ds_read_b128 v[120:123], v8 offset:12288
    s_sub_u32 s78, s78, 1
    s_cmp_lg_u32 s78, 0
    v_mfma_f32_16x16x32_bf16 v[240:243], v[80:83], v[124:127], v[240:243]
    s_cbranch_scc1 L_gloop
L_tail:
    s_waitcnt lgkmcnt(12)
    v_mfma_f32_16x16x32_bf16 v[128:131], v[64:67], v[96:99], v[128:131]
    ds_read_b128 v[124:127], v8 offset:14336
    s_waitcnt lgkmcnt(11)
    v_mfma_f32_16x16x32_bf16 v[132:135], v[68:71], v[96:99], v[132:135]
    ds_read_b128 v[48:51], v9 offset:8192
    s_waitcnt lgkmcnt(10)
    v_mfma_f32_16x16x32_bf16 v[136:139], v[72:75], v[96:99], v[136:139]
    ds_read_b64_tr_b16 v[80:81], v2 offset:16384
    s_waitcnt lgkmcnt(9)
    v_mfma_f32_16x16x32_bf16 v[140:143], v[76:79], v[96:99], v[140:143]
    ds_read_b64_tr_b16 v[82:83], v2 offset:16896
    s_waitcnt lgkmcnt(6)
    v_mfma_f32_16x16x32_bf16 v[192:195], v[64:67], v[112:115], v[192:195]
    ds_read_b64_tr_b16 v[84:85], v3 offset:16384
    v_mfma_f32_16x16x32_bf16 v[196:199], v[68:71], v[112:115], v[196:199]
    ds_read_b64_tr_b16 v[86:87], v3 offset:16896
    v_mfma_f32_16x16x32_bf16 v[200:203], v[72:75], v[112:115], v[200:203]
    ds_read_b64_tr_b16 v[88:89], v4 offset:16384
    v_mfma_f32_16x16x32_bf16 v[204:207], v[76:79], v[112:115], v[204:207]
    ds_read_b64_tr_b16 v[90:91], v4 offset:16896
    s_waitcnt lgkmcnt(9)
    v_mfma_f32_16x16x32_bf16 v[208:211], v[64:67], v[116:119], v[208:211]
    ds_read_b64_tr_b16 v[92:93], v5 offset:16384
    v_mfma_f32_16x16x32_bf16 v[212:215], v[68:71], v[116:119], v[212:215]
    ds_read_b64_tr_b16 v[94:95], v5 offset:16896
    v_mfma_f32_16x16x32_bf16 v[216:219], v[72:75], v[116:119], v[216:219]
    ds_read_b128 v[52:55], v9 offset:10240
    v_mfma_f32_16x16x32_bf16 v[220:223], v[76:79], v[116:119], v[220:223]
    ds_read_b128 v[56:59], v9 offset:12288
    s_waitcnt lgkmcnt(12)
    v_mfma_f32_16x16x32_bf16 v[224:227], v[64:67], v[120:123], v[224:227]
    ds_read_b128 v[60:63], v9 offset:14336
    v_mfma_f32_16x16x32_bf16 v[228:231], v[68:71], v[120:123], v[228:231]
    v_mfma_f32_16x16x32_bf16 v[232:235], v[72:75], v[120:123], v[232:235]
    v_mfma_f32_16x16x32_bf16 v[236:239], v[76:79], v[120:123], v[236:239]
    s_waitcnt lgkmcnt(12)
    v_mfma_f32_16x16x32_bf16 v[240:243], v[64:67], v[124:127], v[240:243]
    v_mfma_f32_16x16x32_bf16 v[244:247], v[68:71], v[124:127], v[244:247]
    v_mfma_f32_16x16x32_bf16 v[248:251], v[72:75], v[124:127], v[248:251]
    v_mfma_f32_16x16x32_bf16 v[252:255], v[76:79], v[124:127], v[252:255]
    s_waitcnt lgkmcnt(3)
    v_mfma_f32_16x16x32_bf16 v[192:195], v[80:83], v[48:51], v[192:195]
    s_barrier
    ds_read_b128 v[112:115], v9 offset:0
    s_waitcnt vmcnt(0)
    v_mfma_f32_16x16x32_bf16 v[196:199], v[84:87], v[48:51], v[196:199]
    ds_read_b128 v[116:119], v9 offset:2048
    v_readfirstlane_b32 s75, v14
    v_mfma_f32_16x16x32_bf16 v[200:203], v[88:91], v[48:51], v[200:203]
    ds_read_b128 v[120:123], v9 offset:4096
    v_mfma_f32_16x16x32_bf16 v[204:207], v[92:95], v[48:51], v[204:207]
    ds_read_b128 v[124:127], v9 offset:6144
    s_waitcnt lgkmcnt(6)
    v_mfma_f32_16x16x32_bf16 v[208:211], v[80:83], v[52:55], v[208:211]
    v_mfma_f32_16x16x32_bf16 v[212:215], v[84:87], v[52:55], v[212:215]
    v_mfma_f32_16x16x32_bf16 v[216:219], v[88:91], v[52:55], v[216:219]
    v_mfma_f32_16x16x32_bf16 v[220:223], v[92:95], v[52:55], v[220:223]
    s_waitcnt lgkmcnt(5)
    v_mfma_f32_16x16x32_bf16 v[224:227], v[80:83], v[56:59], v[224:227]
    v_mfma_f32_16x16x32_bf16 v[228:231], v[84:87], v[56:59], v[228:231]
    v_mfma_f32_16x16x32_bf16 v[232:235], v[88:91], v[56:59], v[232:235]
    v_mfma_f32_16x16x32_bf16 v[236:239], v[92:95], v[56:59], v[236:239]
    s_waitcnt lgkmcnt(4)
    v_mfma_f32_16x16x32_bf16 v[240:243], v[80:83], v[60:63], v[240:243]
    v_mfma_f32_16x16x32_bf16 v[244:247], v[84:87], v[60:63], v[244:247]
    v_mfma_f32_16x16x32_bf16 v[248:251], v[88:91], v[60:63], v[248:251]
    v_mfma_f32_16x16x32_bf16 v[252:255], v[92:95], v[60:63], v[252:255]
    s_cmp_eq_u32 s75, 0
    s_cbranch_scc1 L_slow
L_rdy:
    v_mfma_f32_16x16x32_bf16 v[144:147], v[64:67], v[100:103], v[144:147]
    s_add_u32 s79, s79, 16384
    v_cvt_pk_f16_f32 v192, v192, v193
    v_cvt_pk_f16_f32 v193, v194, v195
    v_mfma_f32_16x16x32_bf16 v[148:151], v[68:71], v[100:103], v[148:151]
    s_cmp_eq_u32 s79, 49152
    v_cvt_pk_f16_f32 v194, v196, v197
    v_cvt_pk_f16_f32 v195, v198, v199
    v_mfma_f32_16x16x32_bf16 v[152:155], v[72:75], v[100:103], v[152:155]
    ds_read_b64 v[56:57], v13 offset:512
    s_cselect_b32 s79, 0, s79
    v_or_b32 v193, 1, v193
    v_or_b32 v194, s23, v194
    v_mfma_f32_16x16x32_bf16 v[156:159], v[76:79], v[100:103], v[156:159]
    ds_read_b64 v[58:59], v13 offset:544
    v_add_u32 v8, s79, v6
    buffer_store_dwordx4 v[192:195], v12, s[68:71], s17 offen offset:0 sc0 sc1
    v_mfma_f32_16x16x32_bf16 v[160:163], v[64:67], v[104:107], v[160:163]
    ds_read_b64 v[60:61], v13 offset:576
    v_add_u32 v9, s79, v7
    v_mfma_f32_16x16x32_bf16 v[164:167], v[68:71], v[104:107], v[164:167]
    ds_read_b64 v[62:63], v13 offset:608
    v_mfma_f32_16x16x32_bf16 v[168:171], v[72:75], v[104:107], v[168:171]
    v_mfma_f32_16x16x32_bf16 v[172:175], v[76:79], v[104:107], v[172:175]
    v_mfma_f32_16x16x32_bf16 v[176:179], v[64:67], v[108:111], v[176:179]
    v_cvt_pk_f16_f32 v200, v200, v201
    v_cvt_pk_f16_f32 v201, v202, v203
    v_mfma_f32_16x16x32_bf16 v[180:183], v[68:71], v[108:111], v[180:183]
    v_cvt_pk_f16_f32 v202, v204, v205
    v_cvt_pk_f16_f32 v203, v206, v207
    v_mfma_f32_16x16x32_bf16 v[184:187], v[72:75], v[108:111], v[184:187]
    v_or_b32 v201, 1, v201
    v_or_b32 v202, s23, v202
    v_mfma_f32_16x16x32_bf16 v[188:191], v[76:79], v[108:111], v[188:191]
    buffer_store_dwordx4 v[200:203], v12, s[68:71], s17 offen offset:1024 sc0 sc1
    s_waitcnt lgkmcnt(7)
    v_mfma_f32_16x16x32_bf16 v[128:131], v[80:83], v[112:115], v[128:131]
    ds_read_b128 v[96:99], v8 offset:0
    v_mfma_f32_16x16x32_bf16 v[132:135], v[84:87], v[112:115], v[132:135]
    ds_read_b64_tr_b16 v[64:65], v2 offset:32768
    v_mfma_f32_16x16x32_bf16 v[136:139], v[88:91], v[112:115], v[136:139]
    ds_read_b64_tr_b16 v[66:67], v2 offset:33280
    v_mfma_f32_16x16x32_bf16 v[140:143], v[92:95], v[112:115], v[140:143]
    ds_read_b64_tr_b16 v[68:69], v3 offset:32768
    s_waitcnt lgkmcnt(10)
    v_mfma_f32_16x16x32_bf16 v[144:147], v[80:83], v[116:119], v[144:147]
    ds_read_b64_tr_b16 v[70:71], v3 offset:33280
    v_cvt_pk_f16_f32 v208, v208, v209
    v_cvt_pk_f16_f32 v209, v210, v211
    v_mfma_f32_16x16x32_bf16 v[148:151], v[84:87], v[116:119], v[148:151]
    ds_read_b64_tr_b16 v[72:73], v4 offset:32768
    v_cvt_pk_f16_f32 v210, v212, v213
    v_cvt_pk_f16_f32 v211, v214, v215
    v_mfma_f32_16x16x32_bf16 v[152:155], v[88:91], v[116:119], v[152:155]
    ds_read_b64_tr_b16 v[74:75], v4 offset:33280
    v_or_b32 v209, 1, v209
    v_or_b32 v210, s23, v210
    v_mfma_f32_16x16x32_bf16 v[156:159], v[92:95], v[116:119], v[156:159]
    ds_read_b64_tr_b16 v[76:77], v5 offset:32768
    buffer_store_dwordx4 v[208:211], v12, s[68:71], s17 offen offset:2048 sc0 sc1
    s_waitcnt lgkmcnt(13)
    v_mfma_f32_16x16x32_bf16 v[160:163], v[80:83], v[120:123], v[160:163]
    ds_read_b64_tr_b16 v[78:79], v5 offset:33280
    v_mfma_f32_16x16x32_bf16 v[164:167], v[84:87], v[120:123], v[164:167]
    ds_read_b128 v[100:103], v8 offset:2048
    v_mfma_f32_16x16x32_bf16 v[168:171], v[88:91], v[120:123], v[168:171]
    ds_read_b128 v[104:107], v8 offset:4096
    v_mfma_f32_16x16x32_bf16 v[172:175], v[92:95], v[120:123], v[172:175]
    ds_read_b128 v[108:111], v8 offset:6144
    s_waitcnt lgkmcnt(15)
    v_mfma_f32_16x16x32_bf16 v[176:179], v[80:83], v[124:127], v[176:179]
    v_cvt_pk_f16_f32 v216, v216, v217
    v_cvt_pk_f16_f32 v217, v218, v219
    v_mfma_f32_16x16x32_bf16 v[180:183], v[84:87], v[124:127], v[180:183]
    v_cvt_pk_f16_f32 v218, v220, v221
    v_cvt_pk_f16_f32 v219, v222, v223
    v_mfma_f32_16x16x32_bf16 v[184:187], v[88:91], v[124:127], v[184:187]
    v_or_b32 v217, 1, v217
    v_or_b32 v218, s23, v218
    v_mfma_f32_16x16x32_bf16 v[188:191], v[92:95], v[124:127], v[188:191]
    buffer_store_dwordx4 v[216:219], v12, s[68:71], s17 offen offset:3072 sc0 sc1
    s_waitcnt lgkmcnt(9)
    v_mfma_f32_16x16x32_bf16 v[128:131], v[64:67], v[96:99], v[128:131]
    s_barrier
    ds_read_b128 v[112:115], v9 offset:0
    s_waitcnt lgkmcnt(8)
    v_mfma_f32_16x16x32_bf16 v[132:135], v[68:71], v[96:99], v[132:135]
    ds_read_b64_tr_b16 v[80:81], v2 offset:49152
    s_waitcnt lgkmcnt(7)
    v_mfma_f32_16x16x32_bf16 v[136:139], v[72:75], v[96:99], v[136:139]
    ds_read_b64_tr_b16 v[82:83], v2 offset:49664
    s_waitcnt lgkmcnt(6)
    v_mfma_f32_16x16x32_bf16 v[140:143], v[76:79], v[96:99], v[140:143]
    ds_read_b64_tr_b16 v[84:85], v3 offset:49152
    s_waitcnt lgkmcnt(6)
    v_mfma_f32_16x16x32_bf16 v[144:147], v[64:67], v[100:103], v[144:147]
    ds_read_b64_tr_b16 v[86:87], v3 offset:49664
    v_cvt_pk_f16_f32 v224, v224, v225
    v_cvt_pk_f16_f32 v225, v226, v227
    v_mfma_f32_16x16x32_bf16 v[148:151], v[68:71], v[100:103], v[148:151]
    ds_read_b64_tr_b16 v[88:89], v4 offset:49152
    v_cvt_pk_f16_f32 v226, v228, v229
    v_cvt_pk_f16_f32 v227, v230, v231
    v_mfma_f32_16x16x32_bf16 v[152:155], v[72:75], v[100:103], v[152:155]
    ds_read_b64_tr_b16 v[90:91], v4 offset:49664
    v_or_b32 v225, 1, v225
    v_or_b32 v226, s23, v226
    v_mfma_f32_16x16x32_bf16 v[156:159], v[76:79], v[100:103], v[156:159]
    ds_read_b64_tr_b16 v[92:93], v5 offset:49152
    buffer_store_dwordx4 v[224:227], v12, s[68:71], s19 offen offset:0 sc0 sc1
    s_waitcnt lgkmcnt(9)
    v_mfma_f32_16x16x32_bf16 v[160:163], v[64:67], v[104:107], v[160:163]
    ds_read_b64_tr_b16 v[94:95], v5 offset:49664
    v_mfma_f32_16x16x32_bf16 v[164:167], v[68:71], v[104:107], v[164:167]
    ds_read_b128 v[116:119], v9 offset:2048
    v_mfma_f32_16x16x32_bf16 v[168:171], v[72:75], v[104:107], v[168:171]
    ds_read_b128 v[120:123], v9 offset:4096
    v_mfma_f32_16x16x32_bf16 v[172:175], v[76:79], v[104:107], v[172:175]
    ds_read_b128 v[124:127], v9 offset:6144
    s_add_u32 s79, s79, 16384
    s_waitcnt lgkmcnt(12)
    v_mfma_f32_16x16x32_bf16 v[176:179], v[64:67], v[108:111], v[176:179]
    s_cmp_eq_u32 s79, 49152
    v_cvt_pk_f16_f32 v232, v232, v233
    v_cvt_pk_f16_f32 v233, v234, v235
    v_mfma_f32_16x16x32_bf16 v[180:183], v[68:71], v[108:111], v[180:183]
    s_cselect_b32 s79, 0, s79
    v_cvt_pk_f16_f32 v234, v236, v237
    v_cvt_pk_f16_f32 v235, v238, v239
    v_mfma_f32_16x16x32_bf16 v[184:187], v[72:75], v[108:111], v[184:187]
    v_add_u32 v8, s79, v6
    v_or_b32 v233, 1, v233
    v_or_b32 v234, s23, v234
    v_mfma_f32_16x16x32_bf16 v[188:191], v[76:79], v[108:111], v[188:191]
    v_add_u32 v9, s79, v7
    buffer_store_dwordx4 v[232:235], v12, s[68:71], s19 offen offset:1024 sc0 sc1
    s_waitcnt lgkmcnt(9)
    v_mfma_f32_16x16x32_bf16 v[128:131], v[80:83], v[112:115], v[128:131]
    s_barrier
    ds_read_b128 v[96:99], v8 offset:0
    s_waitcnt lgkmcnt(8)
    v_mfma_f32_16x16x32_bf16 v[132:135], v[84:87], v[112:115], v[132:135]
    ds_read_b64_tr_b16 v[64:65], v2 offset:0
    v_lshlrev_b32 v48, 16, v56
    s_waitcnt lgkmcnt(7)
    v_mfma_f32_16x16x32_bf16 v[136:139], v[88:91], v[112:115], v[136:139]
    ds_read_b64_tr_b16 v[66:67], v2 offset:512
    v_and_b32 v49, s33, v56
    s_waitcnt lgkmcnt(6)
    v_mfma_f32_16x16x32_bf16 v[140:143], v[92:95], v[112:115], v[140:143]
    ds_read_b64_tr_b16 v[68:69], v3 offset:0
    v_lshlrev_b32 v50, 16, v57
    s_waitcnt lgkmcnt(6)
    v_mfma_f32_16x16x32_bf16 v[144:147], v[80:83], v[116:119], v[144:147]
    ds_read_b64_tr_b16 v[70:71], v3 offset:512
    v_and_b32 v51, s33, v57
    v_cvt_pk_f16_f32 v240, v240, v241
    v_cvt_pk_f16_f32 v241, v242, v243
    v_mfma_f32_16x16x32_bf16 v[148:151], v[84:87], v[116:119], v[148:151]
    ds_read_b64_tr_b16 v[72:73], v4 offset:0
    v_lshlrev_b32 v52, 16, v58
    v_cvt_pk_f16_f32 v242, v244, v245
    v_cvt_pk_f16_f32 v243, v246, v247
    v_mfma_f32_16x16x32_bf16 v[152:155], v[88:91], v[116:119], v[152:155]
    ds_read_b64_tr_b16 v[74:75], v4 offset:512
    v_and_b32 v53, s33, v58
    v_or_b32 v241, 1, v241
    v_or_b32 v242, s23, v242
    v_mfma_f32_16x16x32_bf16 v[156:159], v[92:95], v[116:119], v[156:159]
    ds_read_b64_tr_b16 v[76:77], v5 offset:0
    v_lshlrev_b32 v54, 16, v59
    buffer_store_dwordx4 v[240:243], v12, s[68:71], s19 offen offset:2048 sc0 sc1
    s_waitcnt lgkmcnt(9)
    v_mfma_f32_16x16x32_bf16 v[160:163], v[80:83], v[120:123], v[160:163]
    ds_read_b64_tr_b16 v[78:79], v5 offset:512
    v_and_b32 v55, s33, v59
    v_mfma_f32_16x16x32_bf16 v[164:167], v[84:87], v[120:123], v[164:167]
    ds_read_b128 v[100:103], v8 offset:2048
    v_mfma_f32_16x16x32_bf16 v[168:171], v[88:91], v[120:123], v[168:171]
    ds_read_b128 v[104:107], v8 offset:4096
    v_mfma_f32_16x16x32_bf16 v[172:175], v[92:95], v[120:123], v[172:175]
    ds_read_b128 v[108:111], v8 offset:6144
    s_waitcnt lgkmcnt(12)
    v_mfma_f32_16x16x32_bf16 v[176:179], v[80:83], v[124:127], v[176:179]
    v_cvt_pk_f16_f32 v248, v248, v249
    v_cvt_pk_f16_f32 v249, v250, v251
    v_mfma_f32_16x16x32_bf16 v[180:183], v[84:87], v[124:127], v[180:183]
    v_cvt_pk_f16_f32 v250, v252, v253
    v_cvt_pk_f16_f32 v251, v254, v255
    v_mfma_f32_16x16x32_bf16 v[184:187], v[88:91], v[124:127], v[184:187]
    v_or_b32 v249, 1, v249
    v_or_b32 v250, s23, v250
    v_mfma_f32_16x16x32_bf16 v[188:191], v[92:95], v[124:127], v[188:191]
    buffer_store_dwordx4 v[248:251], v12, s[68:71], s19 offen offset:3072 sc0 sc1
    s_waitcnt lgkmcnt(9)
    v_mfma_f32_16x16x32_bf16 v[128:131], v[64:67], v[96:99], v[128:131]
    ds_read_b128 v[112:115], v9 offset:0
    v_lshlrev_b32 v56, 16, v60
    s_waitcnt lgkmcnt(8)
    v_mfma_f32_16x16x32_bf16 v[132:135], v[68:71], v[96:99], v[132:135]
    ds_read_b64_tr_b16 v[80:81], v2 offset:16384
    v_and_b32 v57, s33, v60
    s_waitcnt lgkmcnt(7)
    v_mfma_f32_16x16x32_bf16 v[136:139], v[72:75], v[96:99], v[136:139]
    ds_read_b64_tr_b16 v[82:83], v2 offset:16896
    v_lshlrev_b32 v58, 16, v61
    s_waitcnt lgkmcnt(6)
    v_mfma_f32_16x16x32_bf16 v[140:143], v[76:79], v[96:99], v[140:143]
    ds_read_b64_tr_b16 v[84:85], v3 offset:16384
    v_and_b32 v59, s33, v61
    s_waitcnt lgkmcnt(6)
    v_mfma_f32_16x16x32_bf16 v[144:147], v[64:67], v[100:103], v[144:147]
    ds_read_b64_tr_b16 v[86:87], v3 offset:16896
    v_lshlrev_b32 v60, 16, v62
    buffer_load_dwordx4 v[196:199], v12, s[68:71], s16 offen offset:0 sc0 sc1
    v_mfma_f32_16x16x32_bf16 v[148:151], v[68:71], v[100:103], v[148:151]
    ds_read_b64_tr_b16 v[88:89], v4 offset:16384
    v_and_b32 v61, s33, v62
    v_mfma_f32_16x16x32_bf16 v[152:155], v[72:75], v[100:103], v[152:155]
    ds_read_b64_tr_b16 v[90:91], v4 offset:16896
    v_lshlrev_b32 v62, 16, v63
    v_mfma_f32_16x16x32_bf16 v[156:159], v[76:79], v[100:103], v[156:159]
    ds_read_b64_tr_b16 v[92:93], v5 offset:16384
    v_and_b32 v63, s33, v63
    s_waitcnt lgkmcnt(9)
    v_mfma_f32_16x16x32_bf16 v[160:163], v[64:67], v[104:107], v[160:163]
    ds_read_b64_tr_b16 v[94:95], v5 offset:16896
    buffer_load_dwordx4 v[204:207], v12, s[68:71], s16 offen offset:1024 sc0 sc1
    v_mfma_f32_16x16x32_bf16 v[164:167], v[68:71], v[104:107], v[164:167]
    ds_read_b128 v[116:119], v9 offset:2048
    v_mfma_f32_16x16x32_bf16 v[168:171], v[72:75], v[104:107], v[168:171]
    ds_read_b128 v[120:123], v9 offset:4096
    v_mfma_f32_16x16x32_bf16 v[172:175], v[76:79], v[104:107], v[172:175]
    ds_read_b128 v[124:127], v9 offset:6144
    s_waitcnt lgkmcnt(12)
    v_mfma_f32_16x16x32_bf16 v[176:179], v[64:67], v[108:111], v[176:179]
    buffer_load_dwordx4 v[212:215], v12, s[68:71], s16 offen offset:2048 sc0 sc1
    v_mfma_f32_16x16x32_bf16 v[180:183], v[68:71], v[108:111], v[180:183]
    v_mfma_f32_16x16x32_bf16 v[184:187], v[72:75], v[108:111], v[184:187]
    v_mfma_f32_16x16x32_bf16 v[188:191], v[76:79], v[108:111], v[188:191]
    s_waitcnt lgkmcnt(9)
    v_mfma_f32_16x16x32_bf16 v[128:131], v[80:83], v[112:115], v[128:131]
    buffer_load_dwordx4 v[220:223], v12, s[68:71], s16 offen offset:3072 sc0 sc1
    s_waitcnt lgkmcnt(7)
    v_mfma_f32_16x16x32_bf16 v[132:135], v[84:87], v[112:115], v[132:135]
    s_waitcnt lgkmcnt(5)
    v_mfma_f32_16x16x32_bf16 v[136:139], v[88:91], v[112:115], v[136:139]
    v_mov_b32 v72, 0xc0135761
    s_waitcnt lgkmcnt(3)
    v_mfma_f32_16x16x32_bf16 v[140:143], v[92:95], v[112:115], v[140:143]
    v_mov_b32 v73, 0xc0135761
    s_waitcnt lgkmcnt(2)
    v_mfma_f32_16x16x32_bf16 v[144:147], v[80:83], v[116:119], v[144:147]
    v_mov_b32 v74, 1.0
    v_mfma_f32_16x16x32_bf16 v[148:151], v[84:87], v[116:119], v[148:151]
    v_mov_b32 v75, 1.0
    v_mfma_f32_16x16x32_bf16 v[152:155], v[88:91], v[116:119], v[152:155]
    s_mov_b32 s24, 0xbdd2d3e8
    v_mfma_f32_16x16x32_bf16 v[156:159], v[92:95], v[116:119], v[156:159]
    s_mov_b32 s25, 0xbdd2d3e8
    s_waitcnt lgkmcnt(1)
    v_mfma_f32_16x16x32_bf16 v[160:163], v[80:83], v[120:123], v[160:163]
    s_mov_b32 s78, 0x20000
    v_mfma_f32_16x16x32_bf16 v[164:167], v[84:87], v[120:123], v[164:167]
    s_lshl_b32 s74, s3, 10
    v_mfma_f32_16x16x32_bf16 v[168:171], v[88:91], v[120:123], v[168:171]
    s_add_u32 s74, s74, 157696
    v_mfma_f32_16x16x32_bf16 v[172:175], v[92:95], v[120:123], v[172:175]
    v_lshlrev_b32 v13, 8, v11
    s_waitcnt lgkmcnt(0)
    v_mfma_f32_16x16x32_bf16 v[176:179], v[80:83], v[124:127], v[176:179]
    v_lshl_add_u32 v13, v10, 2, v13
    v_mfma_f32_16x16x32_bf16 v[180:183], v[84:87], v[124:127], v[180:183]
    v_add_u32 v13, s74, v13
    v_mfma_f32_16x16x32_bf16 v[184:187], v[88:91], v[124:127], v[184:187]
    v_mfma_f32_16x16x32_bf16 v[188:191], v[92:95], v[124:127], v[188:191]
    s_waitcnt vmcnt(3)
    v_bfi_b32 v76, s22, v197, v198
    v_bitop3_b32 v76, v76, s21, s21 bitop3:0x28
    v_cmp_ne_u32 vcc, 0, v76
L_chk0:
    s_cbranch_vccnz L_rt0
L_ok0:
    buffer_load_dwordx4 v[228:231], v12, s[68:71], s18 offen offset:0 sc0 sc1
    v_fma_mix_f32 v128, v196, 1.0, v128 op_sel:[0,0,0] op_sel_hi:[1,0,0]
    v_fma_mix_f32 v129, v196, 1.0, v129 op_sel:[1,0,0] op_sel_hi:[1,0,0]
    v_fma_mix_f32 v130, v197, 1.0, v130 op_sel:[0,0,0] op_sel_hi:[1,0,0]
    v_fma_mix_f32 v131, v197, 1.0, v131 op_sel:[1,0,0] op_sel_hi:[1,0,0]
    v_fma_mix_f32 v132, v198, 1.0, v132 op_sel:[0,0,0] op_sel_hi:[1,0,0]
    v_fma_mix_f32 v133, v198, 1.0, v133 op_sel:[1,0,0] op_sel_hi:[1,0,0]
    v_fma_mix_f32 v134, v199, 1.0, v134 op_sel:[0,0,0] op_sel_hi:[1,0,0]
    v_fma_mix_f32 v135, v199, 1.0, v135 op_sel:[1,0,0] op_sel_hi:[1,0,0]
    v_pk_mul_f32 v[64:65], v[128:129], v[128:129]
    v_pk_mul_f32 v[66:67], v[130:131], v[130:131]
    v_pk_mul_f32 v[68:69], v[132:133], v[132:133]
    v_pk_mul_f32 v[70:71], v[134:135], v[134:135]
    v_pk_fma_f32 v[64:65], v[64:65], s[24:25], v[72:73]
    v_pk_fma_f32 v[66:67], v[66:67], s[24:25], v[72:73]
    v_pk_fma_f32 v[68:69], v[68:69], s[24:25], v[72:73]
    v_pk_fma_f32 v[70:71], v[70:71], s[24:25], v[72:73]
    v_pk_mul_f32 v[64:65], v[64:65], v[128:129]
    v_pk_mul_f32 v[66:67], v[66:67], v[130:131]
    v_pk_mul_f32 v[68:69], v[68:69], v[132:133]
    v_pk_mul_f32 v[70:71], v[70:71], v[134:135]
    v_exp_f32 v64, v64
    v_exp_f32 v65, v65
    v_exp_f32 v66, v66
    v_exp_f32 v67, v67
    v_exp_f32 v68, v68
    v_exp_f32 v69, v69
    v_exp_f32 v70, v70
    v_exp_f32 v71, v71
    v_pk_mul_f32 v[128:129], v[128:129], v[48:49]
    v_pk_mul_f32 v[130:131], v[130:131], v[50:51]
    v_pk_mul_f32 v[132:133], v[132:133], v[52:53]
    v_pk_mul_f32 v[134:135], v[134:135], v[54:55]
    v_pk_add_f32 v[64:65], v[64:65], v[74:75]
    v_pk_add_f32 v[66:67], v[66:67], v[74:75]
    v_pk_add_f32 v[68:69], v[68:69], v[74:75]
    v_pk_add_f32 v[70:71], v[70:71], v[74:75]
    v_rcp_f32 v64, v64
    v_rcp_f32 v65, v65
    v_rcp_f32 v66, v66
    v_rcp_f32 v67, v67
    v_rcp_f32 v68, v68
    v_rcp_f32 v69, v69
    v_rcp_f32 v70, v70
    v_rcp_f32 v71, v71
    s_waitcnt vmcnt(3)
    v_bfi_b32 v76, s22, v205, v206
    v_bitop3_b32 v76, v76, s21, s21 bitop3:0x28
    v_cmp_ne_u32 vcc, 0, v76
    v_pk_mul_f32 v[96:97], v[128:129], v[64:65]
    v_pk_mul_f32 v[98:99], v[130:131], v[66:67]
    v_pk_fma_f32 v[96:97], v[132:133], v[68:69], v[96:97]
    v_pk_fma_f32 v[98:99], v[134:135], v[70:71], v[98:99]
L_chk1:
    s_cbranch_vccnz L_rt1
L_ok1:
    buffer_load_dwordx4 v[236:239], v12, s[68:71], s18 offen offset:1024 sc0 sc1
    v_fma_mix_f32 v136, v204, 1.0, v136 op_sel:[0,0,0] op_sel_hi:[1,0,0]
    v_fma_mix_f32 v137, v204, 1.0, v137 op_sel:[1,0,0] op_sel_hi:[1,0,0]
    v_fma_mix_f32 v138, v205, 1.0, v138 op_sel:[0,0,0] op_sel_hi:[1,0,0]
    v_fma_mix_f32 v139, v205, 1.0, v139 op_sel:[1,0,0] op_sel_hi:[1,0,0]
    v_fma_mix_f32 v140, v206, 1.0, v140 op_sel:[0,0,0] op_sel_hi:[1,0,0]
    v_fma_mix_f32 v141, v206, 1.0, v141 op_sel:[1,0,0] op_sel_hi:[1,0,0]
    v_fma_mix_f32 v142, v207, 1.0, v142 op_sel:[0,0,0] op_sel_hi:[1,0,0]
    v_fma_mix_f32 v143, v207, 1.0, v143 op_sel:[1,0,0] op_sel_hi:[1,0,0]
    v_pk_mul_f32 v[64:65], v[136:137], v[136:137]
    v_pk_mul_f32 v[66:67], v[138:139], v[138:139]
    v_pk_mul_f32 v[68:69], v[140:141], v[140:141]
    v_pk_mul_f32 v[70:71], v[142:143], v[142:143]
    v_pk_fma_f32 v[64:65], v[64:65], s[24:25], v[72:73]
    v_pk_fma_f32 v[66:67], v[66:67], s[24:25], v[72:73]
    v_pk_fma_f32 v[68:69], v[68:69], s[24:25], v[72:73]
    v_pk_fma_f32 v[70:71], v[70:71], s[24:25], v[72:73]
    v_pk_mul_f32 v[64:65], v[64:65], v[136:137]
    v_pk_mul_f32 v[66:67], v[66:67], v[138:139]
    v_pk_mul_f32 v[68:69], v[68:69], v[140:141]
    v_pk_mul_f32 v[70:71], v[70:71], v[142:143]
    v_exp_f32 v64, v64
    v_exp_f32 v65, v65
    v_exp_f32 v66, v66
    v_exp_f32 v67, v67
    v_exp_f32 v68, v68
    v_exp_f32 v69, v69
    v_exp_f32 v70, v70
    v_exp_f32 v71, v71
    v_pk_mul_f32 v[136:137], v[136:137], v[56:57]
    v_pk_mul_f32 v[138:139], v[138:139], v[58:59]
    v_pk_mul_f32 v[140:141], v[140:141], v[60:61]
    v_pk_mul_f32 v[142:143], v[142:143], v[62:63]
    v_pk_add_f32 v[64:65], v[64:65], v[74:75]
    v_pk_add_f32 v[66:67], v[66:67], v[74:75]
    v_pk_add_f32 v[68:69], v[68:69], v[74:75]
    v_pk_add_f32 v[70:71], v[70:71], v[74:75]
    v_rcp_f32 v64, v64
    v_rcp_f32 v65, v65
    v_rcp_f32 v66, v66
    v_rcp_f32 v67, v67
    v_rcp_f32 v68, v68
    v_rcp_f32 v69, v69
    v_rcp_f32 v70, v70
    v_rcp_f32 v71, v71
    s_waitcnt vmcnt(3)
    v_bfi_b32 v76, s22, v213, v214
    v_bitop3_b32 v76, v76, s21, s21 bitop3:0x28
    v_cmp_ne_u32 vcc, 0, v76
    v_pk_fma_f32 v[96:97], v[136:137], v[64:65], v[96:97]
    v_pk_fma_f32 v[98:99], v[138:139], v[66:67], v[98:99]
    v_pk_fma_f32 v[96:97], v[140:141], v[68:69], v[96:97]
    v_pk_fma_f32 v[98:99], v[142:143], v[70:71], v[98:99]
L_chk2:
    s_cbranch_vccnz L_rt2
L_ok2:
    buffer_load_dwordx4 v[244:247], v12, s[68:71], s18 offen offset:2048 sc0 sc1
    v_fma_mix_f32 v144, v212, 1.0, v144 op_sel:[0,0,0] op_sel_hi:[1,0,0]
    v_fma_mix_f32 v145, v212, 1.0, v145 op_sel:[1,0,0] op_sel_hi:[1,0,0]
    v_fma_mix_f32 v146, v213, 1.0, v146 op_sel:[0,0,0] op_sel_hi:[1,0,0]
    v_fma_mix_f32 v147, v213, 1.0, v147 op_sel:[1,0,0] op_sel_hi:[1,0,0]
    v_fma_mix_f32 v148, v214, 1.0, v148 op_sel:[0,0,0] op_sel_hi:[1,0,0]
    v_fma_mix_f32 v149, v214, 1.0, v149 op_sel:[1,0,0] op_sel_hi:[1,0,0]
    v_fma_mix_f32 v150, v215, 1.0, v150 op_sel:[0,0,0] op_sel_hi:[1,0,0]
    v_fma_mix_f32 v151, v215, 1.0, v151 op_sel:[1,0,0] op_sel_hi:[1,0,0]
    v_pk_mul_f32 v[64:65], v[144:145], v[144:145]
    v_pk_mul_f32 v[66:67], v[146:147], v[146:147]
    v_pk_mul_f32 v[68:69], v[148:149], v[148:149]
    v_pk_mul_f32 v[70:71], v[150:151], v[150:151]
    v_pk_fma_f32 v[64:65], v[64:65], s[24:25], v[72:73]
    v_pk_fma_f32 v[66:67], v[66:67], s[24:25], v[72:73]
    v_pk_fma_f32 v[68:69], v[68:69], s[24:25], v[72:73]
    v_pk_fma_f32 v[70:71], v[70:71], s[24:25], v[72:73]
    v_pk_mul_f32 v[64:65], v[64:65], v[144:145]
    v_pk_mul_f32 v[66:67], v[66:67], v[146:147]
    v_pk_mul_f32 v[68:69], v[68:69], v[148:149]
    v_pk_mul_f32 v[70:71], v[70:71], v[150:151]
    v_exp_f32 v64, v64
    v_exp_f32 v65, v65
    v_exp_f32 v66, v66
    v_exp_f32 v67, v67
    v_exp_f32 v68, v68
    v_exp_f32 v69, v69
    v_exp_f32 v70, v70
    v_exp_f32 v71, v71
    v_pk_mul_f32 v[144:145], v[144:145], v[48:49]
    v_pk_mul_f32 v[146:147], v[146:147], v[50:51]
    v_pk_mul_f32 v[148:149], v[148:149], v[52:53]
    v_pk_mul_f32 v[150:151], v[150:151], v[54:55]
    v_pk_add_f32 v[64:65], v[64:65], v[74:75]
    v_pk_add_f32 v[66:67], v[66:67], v[74:75]
    v_pk_add_f32 v[68:69], v[68:69], v[74:75]
    v_pk_add_f32 v[70:71], v[70:71], v[74:75]
    v_rcp_f32 v64, v64
    v_rcp_f32 v65, v65
    v_rcp_f32 v66, v66
    v_rcp_f32 v67, v67
    v_rcp_f32 v68, v68
    v_rcp_f32 v69, v69
    v_rcp_f32 v70, v70
    v_rcp_f32 v71, v71
    s_waitcnt vmcnt(3)
    v_bfi_b32 v76, s22, v221, v222
    v_bitop3_b32 v76, v76, s21, s21 bitop3:0x28
    v_cmp_ne_u32 vcc, 0, v76
    v_pk_mul_f32 v[100:101], v[144:145], v[64:65]
    v_pk_mul_f32 v[102:103], v[146:147], v[66:67]
    v_pk_fma_f32 v[100:101], v[148:149], v[68:69], v[100:101]
    v_pk_fma_f32 v[102:103], v[150:151], v[70:71], v[102:103]
L_chk3:
    s_cbranch_vccnz L_rt3
L_ok3:
    buffer_load_dwordx4 v[252:255], v12, s[68:71], s18 offen offset:3072 sc0 sc1
    v_fma_mix_f32 v152, v220, 1.0, v152 op_sel:[0,0,0] op_sel_hi:[1,0,0]
    v_fma_mix_f32 v153, v220, 1.0, v153 op_sel:[1,0,0] op_sel_hi:[1,0,0]
    v_fma_mix_f32 v154, v221, 1.0, v154 op_sel:[0,0,0] op_sel_hi:[1,0,0]
    v_fma_mix_f32 v155, v221, 1.0, v155 op_sel:[1,0,0] op_sel_hi:[1,0,0]
    v_fma_mix_f32 v156, v222, 1.0, v156 op_sel:[0,0,0] op_sel_hi:[1,0,0]
    v_fma_mix_f32 v157, v222, 1.0, v157 op_sel:[1,0,0] op_sel_hi:[1,0,0]
    v_fma_mix_f32 v158, v223, 1.0, v158 op_sel:[0,0,0] op_sel_hi:[1,0,0]
    v_fma_mix_f32 v159, v223, 1.0, v159 op_sel:[1,0,0] op_sel_hi:[1,0,0]
    v_pk_mul_f32 v[64:65], v[152:153], v[152:153]
    v_pk_mul_f32 v[66:67], v[154:155], v[154:155]
    v_pk_mul_f32 v[68:69], v[156:157], v[156:157]
    v_pk_mul_f32 v[70:71], v[158:159], v[158:159]
    v_pk_fma_f32 v[64:65], v[64:65], s[24:25], v[72:73]
    v_pk_fma_f32 v[66:67], v[66:67], s[24:25], v[72:73]
    v_pk_fma_f32 v[68:69], v[68:69], s[24:25], v[72:73]
    v_pk_fma_f32 v[70:71], v[70:71], s[24:25], v[72:73]
    v_pk_mul_f32 v[64:65], v[64:65], v[152:153]
    v_pk_mul_f32 v[66:67], v[66:67], v[154:155]
    v_pk_mul_f32 v[68:69], v[68:69], v[156:157]
    v_pk_mul_f32 v[70:71], v[70:71], v[158:159]
    v_exp_f32 v64, v64
    v_exp_f32 v65, v65
    v_exp_f32 v66, v66
    v_exp_f32 v67, v67
    v_exp_f32 v68, v68
    v_exp_f32 v69, v69
    v_exp_f32 v70, v70
    v_exp_f32 v71, v71
    v_pk_mul_f32 v[152:153], v[152:153], v[56:57]
    v_pk_mul_f32 v[154:155], v[154:155], v[58:59]
    v_pk_mul_f32 v[156:157], v[156:157], v[60:61]
    v_pk_mul_f32 v[158:159], v[158:159], v[62:63]
    v_pk_add_f32 v[64:65], v[64:65], v[74:75]
    v_pk_add_f32 v[66:67], v[66:67], v[74:75]
    v_pk_add_f32 v[68:69], v[68:69], v[74:75]
    v_pk_add_f32 v[70:71], v[70:71], v[74:75]
    v_rcp_f32 v64, v64
    v_rcp_f32 v65, v65
    v_rcp_f32 v66, v66
    v_rcp_f32 v67, v67
    v_rcp_f32 v68, v68
    v_rcp_f32 v69, v69
    v_rcp_f32 v70, v70
    v_rcp_f32 v71, v71
    s_waitcnt vmcnt(3)
    v_bfi_b32 v76, s22, v229, v230
    v_bitop3_b32 v76, v76, s21, s21 bitop3:0x28
    v_cmp_ne_u32 vcc, 0, v76
    v_pk_fma_f32 v[100:101], v[152:153], v[64:65], v[100:101]
    v_pk_fma_f32 v[102:103], v[154:155], v[66:67], v[102:103]
    v_pk_fma_f32 v[100:101], v[156:157], v[68:69], v[100:101]
    v_pk_fma_f32 v[102:103], v[158:159], v[70:71], v[102:103]
L_chk4:
    s_cbranch_vccnz L_rt4
L_ok4:
    v_fma_mix_f32 v160, v228, 1.0, v160 op_sel:[0,0,0] op_sel_hi:[1,0,0]
    v_fma_mix_f32 v161, v228, 1.0, v161 op_sel:[1,0,0] op_sel_hi:[1,0,0]
    v_fma_mix_f32 v162, v229, 1.0, v162 op_sel:[0,0,0] op_sel_hi:[1,0,0]
    v_fma_mix_f32 v163, v229, 1.0, v163 op_sel:[1,0,0] op_sel_hi:[1,0,0]
    v_fma_mix_f32 v164, v230, 1.0, v164 op_sel:[0,0,0] op_sel_hi:[1,0,0]
    v_fma_mix_f32 v165, v230, 1.0, v165 op_sel:[1,0,0] op_sel_hi:[1,0,0]
    v_fma_mix_f32 v166, v231, 1.0, v166 op_sel:[0,0,0] op_sel_hi:[1,0,0]
    v_fma_mix_f32 v167, v231, 1.0, v167 op_sel:[1,0,0] op_sel_hi:[1,0,0]
    v_pk_mul_f32 v[64:65], v[160:161], v[160:161]
    v_pk_mul_f32 v[66:67], v[162:163], v[162:163]
    v_pk_mul_f32 v[68:69], v[164:165], v[164:165]
    v_pk_mul_f32 v[70:71], v[166:167], v[166:167]
    v_pk_fma_f32 v[64:65], v[64:65], s[24:25], v[72:73]
    v_pk_fma_f32 v[66:67], v[66:67], s[24:25], v[72:73]
    v_pk_fma_f32 v[68:69], v[68:69], s[24:25], v[72:73]
    v_pk_fma_f32 v[70:71], v[70:71], s[24:25], v[72:73]
    v_pk_mul_f32 v[64:65], v[64:65], v[160:161]
    v_pk_mul_f32 v[66:67], v[66:67], v[162:163]
    v_pk_mul_f32 v[68:69], v[68:69], v[164:165]
    v_pk_mul_f32 v[70:71], v[70:71], v[166:167]
    v_exp_f32 v64, v64
    v_exp_f32 v65, v65
    v_exp_f32 v66, v66
    v_exp_f32 v67, v67
    v_exp_f32 v68, v68
    v_exp_f32 v69, v69
    v_exp_f32 v70, v70
    v_exp_f32 v71, v71
    v_pk_mul_f32 v[160:161], v[160:161], v[48:49]
    v_pk_mul_f32 v[162:163], v[162:163], v[50:51]
    v_pk_mul_f32 v[164:165], v[164:165], v[52:53]
    v_pk_mul_f32 v[166:167], v[166:167], v[54:55]
    v_pk_add_f32 v[64:65], v[64:65], v[74:75]
    v_pk_add_f32 v[66:67], v[66:67], v[74:75]
    v_pk_add_f32 v[68:69], v[68:69], v[74:75]
    v_pk_add_f32 v[70:71], v[70:71], v[74:75]
    v_rcp_f32 v64, v64
    v_rcp_f32 v65, v65
    v_rcp_f32 v66, v66
    v_rcp_f32 v67, v67
    v_rcp_f32 v68, v68
    v_rcp_f32 v69, v69
    v_rcp_f32 v70, v70
    v_rcp_f32 v71, v71
    s_waitcnt vmcnt(2)
    v_bfi_b32 v76, s22, v237, v238
    v_bitop3_b32 v76, v76, s21, s21 bitop3:0x28
    v_cmp_ne_u32 vcc, 0, v76
    v_pk_mul_f32 v[104:105], v[160:161], v[64:65]
    v_pk_mul_f32 v[106:107], v[162:163], v[66:67]
    v_pk_fma_f32 v[104:105], v[164:165], v[68:69], v[104:105]
    v_pk_fma_f32 v[106:107], v[166:167], v[70:71], v[106:107]
L_chk5:
    s_cbranch_vccnz L_rt5
L_ok5:
    v_fma_mix_f32 v168, v236, 1.0, v168 op_sel:[0,0,0] op_sel_hi:[1,0,0]
    v_fma_mix_f32 v169, v236, 1.0, v169 op_sel:[1,0,0] op_sel_hi:[1,0,0]
    v_fma_mix_f32 v170, v237, 1.0, v170 op_sel:[0,0,0] op_sel_hi:[1,0,0]
    v_fma_mix_f32 v171, v237, 1.0, v171 op_sel:[1,0,0] op_sel_hi:[1,0,0]
    v_fma_mix_f32 v172, v238, 1.0, v172 op_sel:[0,0,0] op_sel_hi:[1,0,0]
    v_fma_mix_f32 v173, v238, 1.0, v173 op_sel:[1,0,0] op_sel_hi:[1,0,0]
    v_fma_mix_f32 v174, v239, 1.0, v174 op_sel:[0,0,0] op_sel_hi:[1,0,0]
    v_fma_mix_f32 v175, v239, 1.0, v175 op_sel:[1,0,0] op_sel_hi:[1,0,0]
    v_pk_mul_f32 v[64:65], v[168:169], v[168:169]
    v_pk_mul_f32 v[66:67], v[170:171], v[170:171]
    v_pk_mul_f32 v[68:69], v[172:173], v[172:173]
    v_pk_mul_f32 v[70:71], v[174:175], v[174:175]
    v_pk_fma_f32 v[64:65], v[64:65], s[24:25], v[72:73]
    v_pk_fma_f32 v[66:67], v[66:67], s[24:25], v[72:73]
    v_pk_fma_f32 v[68:69], v[68:69], s[24:25], v[72:73]
    v_pk_fma_f32 v[70:71], v[70:71], s[24:25], v[72:73]
    v_pk_mul_f32 v[64:65], v[64:65], v[168:169]
    v_pk_mul_f32 v[66:67], v[66:67], v[170:171]
    v_pk_mul_f32 v[68:69], v[68:69], v[172:173]
    v_pk_mul_f32 v[70:71], v[70:71], v[174:175]
    v_exp_f32 v64, v64
    v_exp_f32 v65, v65
    v_exp_f32 v66, v66
    v_exp_f32 v67, v67
    v_exp_f32 v68, v68
    v_exp_f32 v69, v69
    v_exp_f32 v70, v70
    v_exp_f32 v71, v71
    v_pk_mul_f32 v[168:169], v[168:169], v[56:57]
    v_pk_mul_f32 v[170:171], v[170:171], v[58:59]
    v_pk_mul_f32 v[172:173], v[172:173], v[60:61]
    v_pk_mul_f32 v[174:175], v[174:175], v[62:63]
    v_pk_add_f32 v[64:65], v[64:65], v[74:75]
    v_pk_add_f32 v[66:67], v[66:67], v[74:75]
    v_pk_add_f32 v[68:69], v[68:69], v[74:75]
    v_pk_add_f32 v[70:71], v[70:71], v[74:75]
    v_rcp_f32 v64, v64
    v_rcp_f32 v65, v65
    v_rcp_f32 v66, v66
    v_rcp_f32 v67, v67
    v_rcp_f32 v68, v68
    v_rcp_f32 v69, v69
    v_rcp_f32 v70, v70
    v_rcp_f32 v71, v71
    s_waitcnt vmcnt(1)
    v_bfi_b32 v76, s22, v245, v246
    v_bitop3_b32 v76, v76, s21, s21 bitop3:0x28
    v_cmp_ne_u32 vcc, 0, v76
    v_pk_fma_f32 v[104:105], v[168:169], v[64:65], v[104:105]
    v_pk_fma_f32 v[106:107], v[170:171], v[66:67], v[106:107]
    v_pk_fma_f32 v[104:105], v[172:173], v[68:69], v[104:105]
    v_pk_fma_f32 v[106:107], v[174:175], v[70:71], v[106:107]
L_chk6:
    s_cbranch_vccnz L_rt6
L_ok6:
    v_fma_mix_f32 v176, v244, 1.0, v176 op_sel:[0,0,0] op_sel_hi:[1,0,0]
    v_fma_mix_f32 v177, v244, 1.0, v177 op_sel:[1,0,0] op_sel_hi:[1,0,0]
    v_fma_mix_f32 v178, v245, 1.0, v178 op_sel:[0,0,0] op_sel_hi:[1,0,0]
    v_fma_mix_f32 v179, v245, 1.0, v179 op_sel:[1,0,0] op_sel_hi:[1,0,0]
    v_fma_mix_f32 v180, v246, 1.0, v180 op_sel:[0,0,0] op_sel_hi:[1,0,0]
    v_fma_mix_f32 v181, v246, 1.0, v181 op_sel:[1,0,0] op_sel_hi:[1,0,0]
    v_fma_mix_f32 v182, v247, 1.0, v182 op_sel:[0,0,0] op_sel_hi:[1,0,0]
    v_fma_mix_f32 v183, v247, 1.0, v183 op_sel:[1,0,0] op_sel_hi:[1,0,0]
    v_pk_mul_f32 v[64:65], v[176:177], v[176:177]
    v_pk_mul_f32 v[66:67], v[178:179], v[178:179]
    v_pk_mul_f32 v[68:69], v[180:181], v[180:181]
    v_pk_mul_f32 v[70:71], v[182:183], v[182:183]
    v_pk_fma_f32 v[64:65], v[64:65], s[24:25], v[72:73]
    v_pk_fma_f32 v[66:67], v[66:67], s[24:25], v[72:73]
    v_pk_fma_f32 v[68:69], v[68:69], s[24:25], v[72:73]
    v_pk_fma_f32 v[70:71], v[70:71], s[24:25], v[72:73]
    v_pk_mul_f32 v[64:65], v[64:65], v[176:177]
    v_pk_mul_f32 v[66:67], v[66:67], v[178:179]
    v_pk_mul_f32 v[68:69], v[68:69], v[180:181]
    v_pk_mul_f32 v[70:71], v[70:71], v[182:183]
    v_exp_f32 v64, v64
    v_exp_f32 v65, v65
    v_exp_f32 v66, v66
    v_exp_f32 v67, v67
    v_exp_f32 v68, v68
    v_exp_f32 v69, v69
    v_exp_f32 v70, v70
    v_exp_f32 v71, v71
    v_pk_mul_f32 v[176:177], v[176:177], v[48:49]
    v_pk_mul_f32 v[178:179], v[178:179], v[50:51]
    v_pk_mul_f32 v[180:181], v[180:181], v[52:53]
    v_pk_mul_f32 v[182:183], v[182:183], v[54:55]
    v_pk_add_f32 v[64:65], v[64:65], v[74:75]
    v_pk_add_f32 v[66:67], v[66:67], v[74:75]
    v_pk_add_f32 v[68:69], v[68:69], v[74:75]
    v_pk_add_f32 v[70:71], v[70:71], v[74:75]
    v_rcp_f32 v64, v64
    v_rcp_f32 v65, v65
    v_rcp_f32 v66, v66
    v_rcp_f32 v67, v67
    v_rcp_f32 v68, v68
    v_rcp_f32 v69, v69
    v_rcp_f32 v70, v70
    v_rcp_f32 v71, v71
    s_waitcnt vmcnt(0)
    v_bfi_b32 v76, s22, v253, v254
    v_bitop3_b32 v76, v76, s21, s21 bitop3:0x28
    v_cmp_ne_u32 vcc, 0, v76
    v_pk_mul_f32 v[108:109], v[176:177], v[64:65]
    v_pk_mul_f32 v[110:111], v[178:179], v[66:67]
    v_pk_fma_f32 v[108:109], v[180:181], v[68:69], v[108:109]
    v_pk_fma_f32 v[110:111], v[182:183], v[70:71], v[110:111]
L_chk7:
    s_cbranch_vccnz L_rt7
L_ok7:
    v_fma_mix_f32 v184, v252, 1.0, v184 op_sel:[0,0,0] op_sel_hi:[1,0,0]
    v_fma_mix_f32 v185, v252, 1.0, v185 op_sel:[1,0,0] op_sel_hi:[1,0,0]
    v_fma_mix_f32 v186, v253, 1.0, v186 op_sel:[0,0,0] op_sel_hi:[1,0,0]
    v_fma_mix_f32 v187, v253, 1.0, v187 op_sel:[1,0,0] op_sel_hi:[1,0,0]
    v_fma_mix_f32 v188, v254, 1.0, v188 op_sel:[0,0,0] op_sel_hi:[1,0,0]
    v_fma_mix_f32 v189, v254, 1.0, v189 op_sel:[1,0,0] op_sel_hi:[1,0,0]
    v_fma_mix_f32 v190, v255, 1.0, v190 op_sel:[0,0,0] op_sel_hi:[1,0,0]
    v_fma_mix_f32 v191, v255, 1.0, v191 op_sel:[1,0,0] op_sel_hi:[1,0,0]
    v_pk_mul_f32 v[64:65], v[184:185], v[184:185]
    v_pk_mul_f32 v[66:67], v[186:187], v[186:187]
    v_pk_mul_f32 v[68:69], v[188:189], v[188:189]
    v_pk_mul_f32 v[70:71], v[190:191], v[190:191]
    v_pk_fma_f32 v[64:65], v[64:65], s[24:25], v[72:73]
    v_pk_fma_f32 v[66:67], v[66:67], s[24:25], v[72:73]
    v_pk_fma_f32 v[68:69], v[68:69], s[24:25], v[72:73]
    v_pk_fma_f32 v[70:71], v[70:71], s[24:25], v[72:73]
    v_pk_mul_f32 v[64:65], v[64:65], v[184:185]
    v_pk_mul_f32 v[66:67], v[66:67], v[186:187]
    v_pk_mul_f32 v[68:69], v[68:69], v[188:189]
    v_pk_mul_f32 v[70:71], v[70:71], v[190:191]
    v_exp_f32 v64, v64
    v_exp_f32 v65, v65
    v_exp_f32 v66, v66
    v_exp_f32 v67, v67
    v_exp_f32 v68, v68
    v_exp_f32 v69, v69
    v_exp_f32 v70, v70
    v_exp_f32 v71, v71
    v_pk_mul_f32 v[184:185], v[184:185], v[56:57]
    v_pk_mul_f32 v[186:187], v[186:187], v[58:59]
    v_pk_mul_f32 v[188:189], v[188:189], v[60:61]
    v_pk_mul_f32 v[190:191], v[190:191], v[62:63]
    v_pk_add_f32 v[64:65], v[64:65], v[74:75]
    v_pk_add_f32 v[66:67], v[66:67], v[74:75]
    v_pk_add_f32 v[68:69], v[68:69], v[74:75]
    v_pk_add_f32 v[70:71], v[70:71], v[74:75]
    v_rcp_f32 v64, v64
    v_rcp_f32 v65, v65
    v_rcp_f32 v66, v66
    v_rcp_f32 v67, v67
    v_rcp_f32 v68, v68
    v_rcp_f32 v69, v69
    v_rcp_f32 v70, v70
    v_rcp_f32 v71, v71
    s_nop 0
    v_pk_fma_f32 v[108:109], v[184:185], v[64:65], v[108:109]
    v_pk_fma_f32 v[110:111], v[186:187], v[66:67], v[110:111]
    v_pk_fma_f32 v[108:109], v[188:189], v[68:69], v[108:109]
    v_pk_fma_f32 v[110:111], v[190:191], v[70:71], v[110:111]
    v_pk_add_f32 v[96:97], v[96:97], v[98:99]
    v_pk_add_f32 v[100:101], v[100:101], v[102:103]
    v_pk_add_f32 v[104:105], v[104:105], v[106:107]
    v_pk_add_f32 v[108:109], v[108:109], v[110:111]
    v_add_f32 v16, v96, v97
    v_add_f32 v17, v100, v101
    v_add_f32 v18, v104, v105
    v_add_f32 v19, v108, v109
    ds_write_b32 v13, v16 offset:0
    ds_write_b32 v13, v17 offset:64
    ds_write_b32 v13, v18 offset:128
    ds_write_b32 v13, v19 offset:192
    s_waitcnt lgkmcnt(0)
    s_barrier
    s_cmp_lg_u32 s3, 0
    s_cbranch_scc1 L_end
    v_lshlrev_b32 v13, 2, v0
    v_add_u32 v13, 157696, v13
    ds_read_b32 v16, v13 offset:0
    ds_read_b32 v17, v13 offset:256
    ds_read_b32 v18, v13 offset:512
    ds_read_b32 v19, v13 offset:768
    ds_read_b32 v20, v13 offset:1024
    ds_read_b32 v21, v13 offset:1280
    ds_read_b32 v22, v13 offset:1536
    ds_read_b32 v23, v13 offset:1792
    ds_read_b32 v24, v13 offset:2048
    ds_read_b32 v25, v13 offset:2304
    ds_read_b32 v26, v13 offset:2560
    ds_read_b32 v27, v13 offset:2816
    ds_read_b32 v28, v13 offset:3072
    ds_read_b32 v29, v13 offset:3328
    ds_read_b32 v30, v13 offset:3584
    ds_read_b32 v31, v13 offset:3840
    ds_read_b32 v32, v13 offset:4096
    s_lshl_b32 s74, s73, 6
    s_add_u32 s74, s74, s72
    s_lshl_b32 s74, s74, 1
    v_lshlrev_b32 v13, 1, v0
    s_waitcnt lgkmcnt(0)
    v_add_f32 v16, v16, v24
    v_add_f32 v17, v17, v25
    v_add_f32 v18, v18, v26
    v_add_f32 v19, v19, v27
    v_add_f32 v20, v20, v28
    v_add_f32 v21, v21, v29
    v_add_f32 v22, v22, v30
    v_add_f32 v23, v23, v31
    v_add_f32 v16, v16, v20
    v_add_f32 v17, v17, v21
    v_add_f32 v18, v18, v22
    v_add_f32 v19, v19, v23
    v_add_f32 v16, v16, v17
    v_add_f32 v18, v18, v19
    v_add_f32 v16, v16, v32
    v_add_f32 v16, v16, v18
    v_cvt_pk_bf16_f32 v16, v16, v16
    buffer_store_short v16, v13, s[60:63], s74 offen
    s_endpgm
L_rt0:
    s_sub_u32 s78, s78, 1
    s_cbranch_scc1 L_ok0
    s_waitcnt vmcnt(0)
    buffer_load_dwordx4 v[196:199], v12, s[68:71], s16 offen offset:0 sc0 sc1
    buffer_load_dwordx4 v[204:207], v12, s[68:71], s16 offen offset:1024 sc0 sc1
    buffer_load_dwordx4 v[212:215], v12, s[68:71], s16 offen offset:2048 sc0 sc1
    buffer_load_dwordx4 v[220:223], v12, s[68:71], s16 offen offset:3072 sc0 sc1
    s_waitcnt vmcnt(0)
    v_bfi_b32 v76, s22, v197, v198
    v_bitop3_b32 v76, v76, s21, s21 bitop3:0x28
    v_cmp_ne_u32 vcc, 0, v76
    s_branch L_chk0
L_rt1:
    s_sub_u32 s78, s78, 1
    s_cbranch_scc1 L_ok1
    s_waitcnt vmcnt(0)
    buffer_load_dwordx4 v[204:207], v12, s[68:71], s16 offen offset:1024 sc0 sc1
    buffer_load_dwordx4 v[212:215], v12, s[68:71], s16 offen offset:2048 sc0 sc1
    buffer_load_dwordx4 v[220:223], v12, s[68:71], s16 offen offset:3072 sc0 sc1
    buffer_load_dwordx4 v[228:231], v12, s[68:71], s18 offen offset:0 sc0 sc1
    s_waitcnt vmcnt(0)
    v_bfi_b32 v76, s22, v205, v206
    v_bitop3_b32 v76, v76, s21, s21 bitop3:0x28
    v_cmp_ne_u32 vcc, 0, v76
    s_branch L_chk1
L_rt2:
    s_sub_u32 s78, s78, 1
    s_cbranch_scc1 L_ok2
    s_waitcnt vmcnt(0)
    buffer_load_dwordx4 v[212:215], v12, s[68:71], s16 offen offset:2048 sc0 sc1
    buffer_load_dwordx4 v[220:223], v12, s[68:71], s16 offen offset:3072 sc0 sc1
    buffer_load_dwordx4 v[228:231], v12, s[68:71], s18 offen offset:0 sc0 sc1
    buffer_load_dwordx4 v[236:239], v12, s[68:71], s18 offen offset:1024 sc0 sc1
    s_waitcnt vmcnt(0)
    v_bfi_b32 v76, s22, v213, v214
    v_bitop3_b32 v76, v76, s21, s21 bitop3:0x28
    v_cmp_ne_u32 vcc, 0, v76
    s_branch L_chk2
L_rt3:
    s_sub_u32 s78, s78, 1
    s_cbranch_scc1 L_ok3
    s_waitcnt vmcnt(0)
    buffer_load_dwordx4 v[220:223], v12, s[68:71], s16 offen offset:3072 sc0 sc1
    buffer_load_dwordx4 v[228:231], v12, s[68:71], s18 offen offset:0 sc0 sc1
    buffer_load_dwordx4 v[236:239], v12, s[68:71], s18 offen offset:1024 sc0 sc1
    buffer_load_dwordx4 v[244:247], v12, s[68:71], s18 offen offset:2048 sc0 sc1
    s_waitcnt vmcnt(0)
    v_bfi_b32 v76, s22, v221, v222
    v_bitop3_b32 v76, v76, s21, s21 bitop3:0x28
    v_cmp_ne_u32 vcc, 0, v76
    s_branch L_chk3
L_rt4:
    s_sub_u32 s78, s78, 1
    s_cbranch_scc1 L_ok4
    s_waitcnt vmcnt(0)
    buffer_load_dwordx4 v[228:231], v12, s[68:71], s18 offen offset:0 sc0 sc1
    buffer_load_dwordx4 v[236:239], v12, s[68:71], s18 offen offset:1024 sc0 sc1
    buffer_load_dwordx4 v[244:247], v12, s[68:71], s18 offen offset:2048 sc0 sc1
    buffer_load_dwordx4 v[252:255], v12, s[68:71], s18 offen offset:3072 sc0 sc1
    s_waitcnt vmcnt(0)
    v_bfi_b32 v76, s22, v229, v230
    v_bitop3_b32 v76, v76, s21, s21 bitop3:0x28
    v_cmp_ne_u32 vcc, 0, v76
    s_branch L_chk4
L_rt5:
    s_sub_u32 s78, s78, 1
    s_cbranch_scc1 L_ok5
    s_waitcnt vmcnt(0)
    buffer_load_dwordx4 v[236:239], v12, s[68:71], s18 offen offset:1024 sc0 sc1
    buffer_load_dwordx4 v[244:247], v12, s[68:71], s18 offen offset:2048 sc0 sc1
    buffer_load_dwordx4 v[252:255], v12, s[68:71], s18 offen offset:3072 sc0 sc1
    s_waitcnt vmcnt(0)
    v_bfi_b32 v76, s22, v237, v238
    v_bitop3_b32 v76, v76, s21, s21 bitop3:0x28
    v_cmp_ne_u32 vcc, 0, v76
    s_branch L_chk5
L_rt6:
    s_sub_u32 s78, s78, 1
    s_cbranch_scc1 L_ok6
    s_waitcnt vmcnt(0)
    buffer_load_dwordx4 v[244:247], v12, s[68:71], s18 offen offset:2048 sc0 sc1
    buffer_load_dwordx4 v[252:255], v12, s[68:71], s18 offen offset:3072 sc0 sc1
    s_waitcnt vmcnt(0)
    v_bfi_b32 v76, s22, v245, v246
    v_bitop3_b32 v76, v76, s21, s21 bitop3:0x28
    v_cmp_ne_u32 vcc, 0, v76
    s_branch L_chk6
L_rt7:
    s_sub_u32 s78, s78, 1
    s_cbranch_scc1 L_ok7
    s_waitcnt vmcnt(0)
    buffer_load_dwordx4 v[252:255], v12, s[68:71], s18 offen offset:3072 sc0 sc1
    s_waitcnt vmcnt(0)
    v_bfi_b32 v76, s22, v253, v254
    v_bitop3_b32 v76, v76, s21, s21 bitop3:0x28
    v_cmp_ne_u32 vcc, 0, v76
    s_branch L_chk7
L_slow:
    s_mov_b32 s78, 0x20000
    s_mov_b32 s20, 1
L_slp:
    buffer_load_ubyte v14, off, s[64:67], s83 sc0 sc1
    s_waitcnt vmcnt(0)
    v_readfirstlane_b32 s75, v14
    s_nop 3
    s_cmp_lg_u32 s75, 0
    s_cbranch_scc1 L_rdy
    s_sleep 2
    s_sub_u32 s78, s78, 1
    s_cbranch_scc0 L_slp
    s_branch L_rdy
.p2align 6
L_event:
    s_cmp_eq_u32 s78, 1
    s_cbranch_scc0 L_ev1
    buffer_load_ubyte v14, off, s[64:67], s83 sc0 sc1
    s_branch L_evret
L_ev1:
    s_cmp_eq_u32 s26, 2
    s_cbranch_scc0 L_ev2
    s_mov_b64 exec, 1
    buffer_store_byte v15, off, s[64:67], s2 sc0 sc1
    s_mov_b64 exec, -1
    s_mov_b32 s81, 1
    s_branch L_evret
L_ev2:
    s_cmp_eq_u32 s26, 1
    s_cbranch_scc1 L_ev3
    buffer_store_dwordx4 v[20:23], v12, s[68:71], s16 offen offset:0 sc0 sc1
    buffer_store_dwordx4 v[20:23], v12, s[68:71], s16 offen offset:1024 sc0 sc1
    buffer_store_dwordx4 v[20:23], v12, s[68:71], s16 offen offset:2048 sc0 sc1
    buffer_store_dwordx4 v[20:23], v12, s[68:71], s16 offen offset:3072 sc0 sc1
    buffer_store_dwordx4 v[20:23], v12, s[68:71], s18 offen offset:0 sc0 sc1
    buffer_store_dwordx4 v[20:23], v12, s[68:71], s18 offen offset:1024 sc0 sc1
    buffer_store_dwordx4 v[20:23], v12, s[68:71], s18 offen offset:2048 sc0 sc1
    buffer_store_dwordx4 v[20:23], v12, s[68:71], s18 offen offset:3072 sc0 sc1
    s_sub_u32 s81, s78, 3
    s_mov_b32 s26, 1
    s_branch L_evret
L_ev3:
    s_sub_u32 s74, s78, 1
    s_waitcnt vmcnt(0)
    s_mov_b32 s26, 2
    s_cmp_eq_u32 s3, 0
    s_cselect_b32 s81, s74, 1
    s_branch L_evret
L_codeend:
.section .rodata,"a"
.p2align 6
.amdhsa_kernel standalone__deep_cross_pnn__recsys_kernel
  .amdhsa_next_free_vgpr 256
  .amdhsa_next_free_sgpr 102
  .amdhsa_accum_offset 256
  .amdhsa_group_segment_fixed_size 0
  .amdhsa_kernarg_size 80
  .amdhsa_user_sgpr_count 2
  .amdhsa_user_sgpr_kernarg_segment_ptr 1
  .amdhsa_system_sgpr_workgroup_id_x 1
.end_amdhsa_kernel
```
